```python
import torch

def _softmax(x, axis=-1):
    return torch.softmax(x, dim=axis)
def _gelu(x):
    return torch.nn.functional.gelu(x, approximate="tanh")
def _silu(x):
    return torch.nn.functional.silu(x)
def _sigmoid(x):
    return torch.sigmoid(x)
def _layernorm(x, axis=-1, eps=1e-5):
    m = x.mean(dim=axis, keepdim=True)
    v = x.var(dim=axis, keepdim=True, unbiased=False)
    return (x - m) / torch.sqrt(v + eps)
def _scatter_add(tgt, idx, src, axis=0):
    return tgt.clone().index_add_(axis, idx, src)
def _segment_sum(src, seg, n):
    out = torch.zeros((n,) + src.shape[1:], dtype=src.dtype)
    return out.index_add_(0, seg, src)
def _pad(x, pw):
    flat = tuple(v for pair in reversed(pw) for v in pair)
    return torch.nn.functional.pad(x, flat)

kernel_name = 'gated_mix__mha_block__glu_gated_reglu__prompt'

def setup_inputs():

    _w = (lambda a: (lambda t: t.to(torch.bfloat16) if t.is_floating_point() else t)(torch.as_tensor(a)))
    def _A_setup():
        B, S, D, H = 1, 2048, 448, 16
        return {
            "x": _w((lambda *s: torch.randn(*s, dtype=torch.bfloat16) * 0.05)(B, S, D)),
            "wqkv": _w((lambda *s: torch.randn(*s, dtype=torch.bfloat16) * 0.8)(D, 3 * D)),
            "wo": _w((lambda *s: torch.randn(*s, dtype=torch.bfloat16) * 0.05)(D, D)),
        }
    _A_in = _A_setup()

    def _B_setup():
        B, S, D, F = 1, 2048, 448, 1792
        return {
            "x": _w((lambda *s: torch.randn(*s, dtype=torch.bfloat16) * 0.05)(B, S, D)),
            "W_gate": _w((lambda *s: torch.randn(*s, dtype=torch.bfloat16) * 1.6)(D, F) * (2.0 / D) ** 0.5),
            "W_up": _w((lambda *s: torch.randn(*s, dtype=torch.bfloat16) * 1.6)(D, F) * (2.0 / D) ** 0.5),
            "W_down": _w((lambda *s: torch.randn(*s, dtype=torch.bfloat16) * 1.6)(F, D) * (1.0 / F) ** 0.5),
        }
    _B_in = _B_setup()

    return {
        "A_x": _A_in["x"],
        "A_wqkv": _A_in["wqkv"],
        "A_wo": _A_in["wo"],
        "B_x": _B_in["x"],
        "B_W_gate": _B_in["W_gate"],
        "B_W_up": _B_in["W_up"],
        "B_W_down": _B_in["W_down"],
        "gate_w": _w((lambda *s: torch.randn(*s, dtype=torch.bfloat16) * 0.05)(448) * 16.0),
    }

def reference(A_x, A_wqkv, A_wo, B_x, B_W_gate, B_W_up, B_W_down, gate_w):
    def _A_ref(x, wqkv, wo):
        B, S, D = x.shape
        H = 16
        Dh = D // H
        qkv = (lambda x, *d: x.permute(*d))((x @ wqkv).reshape(B, S, 3, H, Dh), 2, 0, 3, 1, 4)
        q, k, v = qkv[0], qkv[1], qkv[2]
        scores = torch.einsum("bhqd,bhkd->bhqk", q, k) * (Dh ** -0.5)
        p = _softmax(scores, axis=-1)
        o = torch.einsum("bhqk,bhkd->bhqd", p, v)
        return (lambda x, *d: x.permute(*d))(o, 0, 2, 1, 3).reshape(B, S, D) @ wo

    def _B_ref(x, W_gate, W_up, W_down):
        gate = torch.einsum("bsd,df->bsf", x, W_gate)
        up = torch.einsum("bsd,df->bsf", x, W_up)
        gate = gate * (lambda x, dt: x.to(dt))(gate > 0, gate.dtype)
        h = gate * up
        return torch.einsum("bsf,fd->bsd", h, W_down)

    x = A_x
    g = _sigmoid((x * gate_w).sum(-1, keepdims=True))
    a = _A_ref(x, A_wqkv, A_wo)
    b = _B_ref(x, B_W_gate, B_W_up, B_W_down)
    return g * a + (1 - g) * b
```

```asm
; @launch grid=(256,1,1) block=(512,1,1) lds=163840
.amdgcn_target "amdgcn-amd-amdhsa--gfx950"
.text
.globl gated_mix__mha_block__glu_gated_reglu__prompt_kernel
.p2align 8
.type gated_mix__mha_block__glu_gated_reglu__prompt_kernel,@function
gated_mix__mha_block__glu_gated_reglu__prompt_kernel:
    s_load_dwordx2 s[8:9], s[0:1], 0
    s_load_dwordx2 s[12:13], s[0:1], 8
    s_load_dwordx2 s[16:17], s[0:1], 32
    s_load_dwordx2 s[20:21], s[0:1], 40
    s_cmp_ge_u32 s2, 256
    s_cbranch_scc1 K_END
    v_lshrrev_b32 v1, 6, v0
    s_mov_b32 s10, 1835008
    s_mov_b32 s11, 0x00020000
    v_readfirstlane_b32 s3, v1
    v_and_b32 v1, 63, v0
    s_and_b32 s4, s2, 1
    s_lshl_b32 s4, s4, 3
    s_bfe_u32 s5, s2, 0x30003
    s_add_u32 s32, s4, s5
    s_lshr_b32 s7, s2, 6
    v_lshrrev_b32 v20, 3, v1
    v_lshrrev_b32 v21, 4, v1
    v_and_b32 v22, 7, v1
    s_cmp_lt_u32 s3, 4
    s_cbranch_scc1 K_COMP
    s_sub_u32 s35, s3, 4
    s_lshl_b32 s36, s32, 2
    s_add_u32 s36, s36, s35
    s_mul_i32 s36, s36, 28672
    v_mul_u32_u24 v24, 896, v20
    v_xor_b32 v23, v22, v21
    v_add_u32 v24, s36, v24
    v_lshl_add_u32 v4, v23, 4, v24
    v_xor_b32 v5, 64, v4
    v_add_u32 v5, 7168, v5
    v_add_u32 v6, 14336, v4
    v_add_u32 v7, 14336, v5
    s_lshl_b32 s42, s35, 12
    s_mov_b32 s44, 0
    s_waitcnt lgkmcnt(0)
    s_add_u32 m0, s42, 0
    s_nop 0
    buffer_load_dwordx4 v4, s[8:11], s44 offen lds
    s_add_u32 m0, s42, 1024
    s_nop 0
    buffer_load_dwordx4 v5, s[8:11], s44 offen lds
    s_add_u32 m0, s42, 2048
    s_nop 0
    buffer_load_dwordx4 v6, s[8:11], s44 offen lds
    s_add_u32 m0, s42, 3072
    s_nop 0
    buffer_load_dwordx4 v7, s[8:11], s44 offen lds
    s_bfe_u32 s5, s2, 0x30003
    s_lshl_b32 s4, s7, 1
    s_add_u32 s75, s5, s4
    s_cmp_ge_u32 s75, 6
    s_cselect_b32 s4, 6, 0
    s_sub_u32 s75, s75, s4
    s_cmp_ge_u32 s75, 6
    s_cselect_b32 s4, 6, 0
    s_sub_u32 s75, s75, s4
    s_lshl_b32 s44, s75, 7
    s_add_u32 s44, s44, 128
    s_add_u32 m0, s42, 16384
    s_nop 0
    buffer_load_dwordx4 v4, s[8:11], s44 offen lds
    s_add_u32 m0, s42, 17408
    s_nop 0
    buffer_load_dwordx4 v5, s[8:11], s44 offen lds
    s_add_u32 m0, s42, 18432
    s_nop 0
    buffer_load_dwordx4 v6, s[8:11], s44 offen lds
    s_add_u32 m0, s42, 19456
    s_nop 0
    buffer_load_dwordx4 v7, s[8:11], s44 offen lds
    s_branch K_LOAD
K_COMP:
    s_mov_b32 s14, 1204224
    s_mov_b32 s18, 1605632
    s_mov_b32 s22, s18
    s_mov_b32 s15, s11
    s_mov_b32 s19, s11
    s_mov_b32 s23, s11
    v_lshlrev_b32 v2, 4, v1
    s_bfe_u32 s6, s2, 0x20001
    s_lshl_b32 s4, s6, 2
    s_add_u32 s33, s4, s7
    s_cmp_eq_u32 s7, 3
    s_cbranch_scc1 K_COMP_II
    s_mul_i32 s4, s6, 3
    s_add_u32 s4, s4, s7
    s_lshl_b32 s72, s4, 1
    s_add_u32 s73, s72, 1
    s_cmp_lt_u32 s4, 5
    s_cselect_b32 s5, 6, 12
    s_cmp_lt_u32 s4, 10
    s_cselect_b32 s5, s5, 24
    s_add_u32 s34, s72, s5
    s_mul_i32 s38, s34, 56
    s_lshl_b32 s37, s3, 3
    v_and_b32 v25, 1, v21
    v_lshlrev_b32 v25, 2, v25
    v_add_u32 v26, s37, v20
    v_xor_b32 v23, v22, v25
    v_mul_u32_u24 v24, 2688, v26
    v_lshl_add_u32 v8, v23, 4, v24
    v_add_u32 v8, s38, v8
    v_mul_u32_u24 v24, 3584, v26
    v_add_u32 v23, 0, v25
    v_xor_b32 v23, v22, v23
    v_lshl_add_u32 v11, v23, 4, v24
    v_add_u32 v23, 2, v25
    v_xor_b32 v23, v22, v23
    v_lshl_add_u32 v12, v23, 4, v24
    s_lshl_b32 s40, s3, 10
    s_lshl_b32 s41, s72, 7
    s_waitcnt lgkmcnt(0)
    s_add_u32 m0, s40, 114688
    s_nop 0
    buffer_load_dwordx4 v8, s[12:15], 0 offen lds
    s_add_u32 m0, s40, 118784
    s_nop 0
    buffer_load_dwordx4 v11, s[16:19], s41 offen lds
    s_add_u32 m0, s40, 122880
    s_nop 0
    buffer_load_dwordx4 v12, s[20:23], s41 offen lds
    s_mov_b32 s44, 86016
    s_add_u32 m0, s40, 126976
    s_nop 0
    buffer_load_dwordx4 v8, s[12:15], s44 offen lds
    s_add_u32 s41, s41, 114688
    s_add_u32 m0, s40, 131072
    s_nop 0
    buffer_load_dwordx4 v11, s[16:19], s41 offen lds
    s_add_u32 m0, s40, 135168
    s_nop 0
    buffer_load_dwordx4 v12, s[20:23], s41 offen lds
    s_getpc_b64 s[40:41]
K_PCI:
    s_sub_u32 s40, s40, K_PCI-gated_mix__mha_block__glu_gated_reglu__prompt_kernel
    s_subb_u32 s41, s41, 0
    s_lshr_b32 s4, s2, 3
    s_lshl_b32 s4, s4, 2
    s_add_u32 s4, s4, s3
    s_mul_i32 s4, s4, 640
    v_min_u32 v29, 9, v1
    v_lshlrev_b32 v29, 6, v29
    v_add_u32 v29, s4, v29
    v_min_u32 v29, K_END-gated_mix__mha_block__glu_gated_reglu__prompt_kernel, v29
    global_load_dword v255, v29, s[40:41]
    s_load_dwordx2 s[24:25], s[0:1], 80
    s_load_dwordx2 s[56:57], s[0:1], 48
    s_load_dwordx2 s[60:61], s[0:1], 16
    s_load_dwordx2 s[68:69], s[0:1], 72
    s_or_b32 s44, s2, s3
    s_cbranch_scc1 K_NN
    s_memrealtime s[46:47]
    s_mov_b32 s70, 256
    s_mov_b32 s71, 0x00020000
    s_waitcnt lgkmcnt(0)
    s_or_b32 s46, s46, 1
    v_mov_b32 v30, s46
    v_mov_b32 v31, 0
    s_mov_b64 exec, 1
    buffer_store_dword v30, v31, s[68:71], 0 offen sc1
    s_mov_b64 exec, -1
K_NN:
    s_lshr_b32 s35, s3, 1
    s_and_b32 s36, s3, 1
    v_and_b32 v20, 31, v1
    v_lshrrev_b32 v21, 5, v1
    v_bfe_u32 v22, v1, 1, 3
    s_lshl_b32 s37, s35, 13
    v_lshlrev_b32 v23, 7, v20
    v_add_u32 v23, s37, v23
    v_xor_b32 v24, v21, v22
    v_lshl_add_u32 v4, v24, 4, v23
    v_xor_b32 v5, 32, v4
    v_xor_b32 v6, 64, v4
    v_xor_b32 v7, 96, v4
    v_bfe_u32 v24, v1, 4, 1
    v_bfe_u32 v25, v1, 2, 2
    v_and_b32 v26, 3, v1
    v_lshl_add_u32 v27, v21, 3, v25
    v_bfe_u32 v29, v25, 1, 1
    v_lshlrev_b32 v28, 5, v24
    v_lshl_add_u32 v28, v26, 3, v28
    v_lshlrev_b32 v30, 6, v29
    s_mul_i32 s37, s36, 56
    v_add_u32 v28, s37, v28
    v_xor_b32 v28, v28, v30
    v_lshl_add_u32 v12, v27, 7, v28
    v_add_u32 v12, 114688, v12
    v_lshlrev_b32 v29, 2, v29
    v_lshl_add_u32 v29, v24, 1, v29
    v_lshrrev_b32 v30, 1, v26
    s_lshl_b32 s37, s36, 2
    v_add_u32 v30, s37, v30
    v_and_b32 v31, 1, v26
    v_lshlrev_b32 v31, 3, v31
    v_lshl_add_u32 v31, v27, 7, v31
    v_lshl_add_u32 v31, v24, 12, v31
    v_add_u32 v31, 114688, v31
    v_add_u32 v28, 0, v30
    v_xor_b32 v28, v28, v29
    v_lshl_add_u32 v15, v28, 4, v31
    v_add_u32 v28, 2, v30
    v_xor_b32 v28, v28, v29
    v_lshl_add_u32 v16, v28, 4, v31
    s_cmp_ge_u32 s34, 32
    s_cbranch_scc1 K_CB
    s_branch K_CA
K_COMP_II:
    s_add_u32 s73, s6, 24
    s_mov_b32 s72, 0
    s_lshl_b32 s34, s6, 4
    s_cmp_eq_u32 s6, 3
    s_cselect_b32 s34, 38, s34
    s_mul_i32 s38, s34, 56
    s_lshl_b32 s37, s3, 3
    v_and_b32 v25, 1, v21
    v_lshlrev_b32 v25, 2, v25
    v_add_u32 v26, s37, v20
    s_lshl_b32 s39, s3, 6
    v_add_u32 v27, s39, v1
    v_add_u32 v23, 0, v27
    v_mul_u32_u24 v24, 2731, v23
    v_lshrrev_b32 v24, 16, v24
    v_mul_u32_u24 v28, 24, v24
    v_sub_u32 v28, v23, v28
    v_lshlrev_b32 v29, 1, v24
    v_and_b32 v29, 4, v29
    v_xor_b32 v28, v28, v29
    v_min_u32 v28, 21, v28
    v_mul_u32_u24 v24, 2688, v24
    v_lshl_add_u32 v8, v28, 4, v24
    v_add_u32 v8, s38, v8
    v_add_u32 v23, 256, v27
    v_mul_u32_u24 v24, 2731, v23
    v_lshrrev_b32 v24, 16, v24
    v_mul_u32_u24 v28, 24, v24
    v_sub_u32 v28, v23, v28
    v_lshlrev_b32 v29, 1, v24
    v_and_b32 v29, 4, v29
    v_xor_b32 v28, v28, v29
    v_min_u32 v28, 21, v28
    v_mul_u32_u24 v24, 2688, v24
    v_lshl_add_u32 v9, v28, 4, v24
    v_add_u32 v9, s38, v9
    v_add_u32 v23, 512, v27
    v_mul_u32_u24 v24, 2731, v23
    v_lshrrev_b32 v24, 16, v24
    v_mul_u32_u24 v28, 24, v24
    v_sub_u32 v28, v23, v28
    v_lshlrev_b32 v29, 1, v24
    v_and_b32 v29, 4, v29
    v_xor_b32 v28, v28, v29
    v_min_u32 v28, 21, v28
    v_mul_u32_u24 v24, 2688, v24
    v_lshl_add_u32 v10, v28, 4, v24
    v_add_u32 v10, s38, v10
    s_lshl_b32 s40, s3, 10
    s_waitcnt lgkmcnt(0)
    s_add_u32 m0, s40, 114688
    s_nop 0
    buffer_load_dwordx4 v8, s[12:15], 0 offen lds
    s_add_u32 m0, s40, 118784
    s_nop 0
    buffer_load_dwordx4 v9, s[12:15], 0 offen lds
    s_add_u32 m0, s40, 122880
    s_nop 0
    buffer_load_dwordx4 v10, s[12:15], 0 offen lds
    s_mov_b32 s44, 86016
    s_add_u32 m0, s40, 126976
    s_nop 0
    buffer_load_dwordx4 v8, s[12:15], s44 offen lds
    s_add_u32 m0, s40, 131072
    s_nop 0
    buffer_load_dwordx4 v9, s[12:15], s44 offen lds
    s_add_u32 m0, s40, 135168
    s_nop 0
    buffer_load_dwordx4 v10, s[12:15], s44 offen lds
    s_getpc_b64 s[40:41]
K_PCII:
    s_sub_u32 s40, s40, K_PCII-gated_mix__mha_block__glu_gated_reglu__prompt_kernel
    s_subb_u32 s41, s41, 0
    s_lshr_b32 s4, s2, 3
    s_lshl_b32 s4, s4, 2
    s_add_u32 s4, s4, s3
    s_mul_i32 s4, s4, 640
    v_min_u32 v29, 9, v1
    v_lshlrev_b32 v29, 6, v29
    v_add_u32 v29, s4, v29
    v_min_u32 v29, K_END-gated_mix__mha_block__glu_gated_reglu__prompt_kernel, v29
    global_load_dword v255, v29, s[40:41]
    s_load_dwordx2 s[24:25], s[0:1], 80
    s_load_dwordx2 s[56:57], s[0:1], 48
    s_load_dwordx2 s[60:61], s[0:1], 16
    s_load_dwordx2 s[68:69], s[0:1], 72
    s_lshr_b32 s35, s3, 1
    s_and_b32 s36, s3, 1
    v_and_b32 v20, 31, v1
    v_lshrrev_b32 v21, 5, v1
    v_bfe_u32 v22, v1, 1, 3
    s_lshl_b32 s37, s35, 13
    v_lshlrev_b32 v23, 7, v20
    v_add_u32 v23, s37, v23
    v_xor_b32 v24, v21, v22
    v_lshl_add_u32 v4, v24, 4, v23
    v_xor_b32 v5, 32, v4
    v_xor_b32 v6, 64, v4
    v_xor_b32 v7, 96, v4
    v_bfe_u32 v24, v1, 4, 1
    v_bfe_u32 v25, v1, 2, 2
    v_and_b32 v26, 3, v1
    v_lshl_add_u32 v27, v21, 3, v25
    v_bfe_u32 v29, v25, 1, 1
    v_lshlrev_b32 v28, 5, v24
    v_lshl_add_u32 v28, v26, 3, v28
    v_lshlrev_b32 v30, 6, v29
    s_mul_i32 s37, s36, 168
    v_add_u32 v28, s37, v28
    v_mul_u32_u24 v31, 384, v27
    v_add_u32 v31, 114688, v31
    v_add_u32 v18, 0, v28
    v_xor_b32 v18, v18, v30
    v_add_u32 v12, v18, v31
    v_add_u32 v18, 56, v28
    v_xor_b32 v18, v18, v30
    v_add_u32 v13, v18, v31
    v_add_u32 v18, 112, v28
    v_xor_b32 v18, v18, v30
    v_add_u32 v14, v18, v31
    s_cmp_ge_u32 s34, 32
    s_cbranch_scc1 K_CD
    s_branch K_CC
K_LOAD:
    s_mov_b32 s14, 1204224
    s_mov_b32 s18, 1605632
    s_mov_b32 s22, s18
    s_mov_b32 s15, s11
    s_mov_b32 s19, s11
    s_mov_b32 s23, s11
    v_lshlrev_b32 v2, 4, v1
    s_bfe_u32 s6, s2, 0x20001
    s_lshl_b32 s4, s6, 2
    s_add_u32 s33, s4, s7
    s_cmp_eq_u32 s7, 3
    s_cbranch_scc1 K_LII
    s_mul_i32 s4, s6, 3
    s_add_u32 s4, s4, s7
    s_lshl_b32 s72, s4, 1
    s_add_u32 s73, s72, 1
    s_cmp_lt_u32 s4, 5
    s_cselect_b32 s5, 6, 12
    s_cmp_lt_u32 s4, 10
    s_cselect_b32 s5, s5, 24
    s_add_u32 s34, s72, s5
    s_mul_i32 s38, s34, 56
    s_lshl_b32 s37, s35, 3
    v_and_b32 v25, 1, v21
    v_lshlrev_b32 v25, 2, v25
    v_add_u32 v26, s37, v20
    v_xor_b32 v23, v22, v25
    v_mul_u32_u24 v24, 2688, v26
    v_lshl_add_u32 v8, v23, 4, v24
    v_add_u32 v8, s38, v8
    v_mul_u32_u24 v24, 3584, v26
    v_add_u32 v23, 0, v25
    v_xor_b32 v23, v22, v23
    v_lshl_add_u32 v11, v23, 4, v24
    v_add_u32 v23, 2, v25
    v_xor_b32 v23, v22, v23
    v_lshl_add_u32 v12, v23, 4, v24
    s_mov_b32 s48, 0
    s_add_u32 s49, s75, 1
    s_cmp_ge_u32 s49, 7
    s_cselect_b32 s4, 6, 0
    s_sub_u32 s49, s49, s4
    s_add_u32 s50, s75, 2
    s_cmp_ge_u32 s50, 7
    s_cselect_b32 s4, 6, 0
    s_sub_u32 s50, s50, s4
    s_add_u32 s51, s75, 3
    s_cmp_ge_u32 s51, 7
    s_cselect_b32 s4, 6, 0
    s_sub_u32 s51, s51, s4
    s_add_u32 s52, s75, 4
    s_cmp_ge_u32 s52, 7
    s_cselect_b32 s4, 6, 0
    s_sub_u32 s52, s52, s4
    s_add_u32 s53, s75, 5
    s_cmp_ge_u32 s53, 7
    s_cselect_b32 s4, 6, 0
    s_sub_u32 s53, s53, s4
    s_add_u32 s54, s75, 6
    s_cmp_ge_u32 s54, 7
    s_cselect_b32 s4, 6, 0
    s_sub_u32 s54, s54, s4
    s_lshl_b32 s40, s35, 10
    s_lshl_b32 s72, s72, 7
    s_lshl_b32 s73, s73, 7
    s_mul_i32 s44, s49, 172032
    s_add_u32 m0, s40, 139264
    s_nop 0
    buffer_load_dwordx4 v8, s[12:15], s44 offen lds
    s_mul_i32 s44, s49, 229376
    s_add_u32 s44, s44, s72
    s_add_u32 m0, s40, 143360
    s_nop 0
    buffer_load_dwordx4 v11, s[16:19], s44 offen lds
    s_add_u32 m0, s40, 147456
    s_nop 0
    buffer_load_dwordx4 v12, s[20:23], s44 offen lds
    s_mul_i32 s44, s49, 172032
    s_add_u32 s44, s44, 86016
    s_add_u32 m0, s40, 151552
    s_nop 0
    buffer_load_dwordx4 v8, s[12:15], s44 offen lds
    s_mul_i32 s44, s49, 229376
    s_add_u32 s44, s44, s72
    s_add_u32 s44, s44, 114688
    s_add_u32 m0, s40, 155648
    s_nop 0
    buffer_load_dwordx4 v11, s[16:19], s44 offen lds
    s_add_u32 m0, s40, 159744
    s_nop 0
    buffer_load_dwordx4 v12, s[20:23], s44 offen lds
    s_waitcnt vmcnt(10)
    s_barrier
    s_waitcnt vmcnt(10)
    s_barrier
    s_lshl_b32 s44, s50, 7
    s_add_u32 m0, s42, 32768
    s_nop 0
    buffer_load_dwordx4 v4, s[8:11], s44 offen lds
    s_add_u32 m0, s42, 33792
    s_nop 0
    buffer_load_dwordx4 v5, s[8:11], s44 offen lds
    s_add_u32 m0, s42, 34816
    s_nop 0
    buffer_load_dwordx4 v6, s[8:11], s44 offen lds
    s_add_u32 m0, s42, 35840
    s_nop 0
    buffer_load_dwordx4 v7, s[8:11], s44 offen lds
    s_mul_i32 s44, s50, 172032
    s_add_u32 m0, s40, 114688
    s_nop 0
    buffer_load_dwordx4 v8, s[12:15], s44 offen lds
    s_mul_i32 s44, s50, 229376
    s_add_u32 s44, s44, s72
    s_add_u32 m0, s40, 118784
    s_nop 0
    buffer_load_dwordx4 v11, s[16:19], s44 offen lds
    s_add_u32 m0, s40, 122880
    s_nop 0
    buffer_load_dwordx4 v12, s[20:23], s44 offen lds
    s_load_dwordx2 s[28:29], s[0:1], 56
    s_load_dwordx2 s[24:25], s[0:1], 80
    s_load_dwordx2 s[56:57], s[0:1], 48
    s_load_dwordx2 s[60:61], s[0:1], 16
    s_load_dwordx2 s[64:65], s[0:1], 64
    s_load_dwordx2 s[68:69], s[0:1], 72
    s_mov_b32 s30, 896
    s_mov_b32 s31, 0x00020000
    s_mov_b32 s26, 17498112
    s_mov_b32 s27, 0x00020000
    s_mov_b32 s58, 1605632
    s_mov_b32 s59, 0x00020000
    s_mov_b32 s62, 401408
    s_mov_b32 s63, 0x00020000
    s_mov_b32 s66, 1835008
    s_mov_b32 s67, 0x00020000
    s_mov_b32 s70, 256
    s_mov_b32 s71, 0x00020000
    s_waitcnt vmcnt(10)
    s_barrier
    s_mul_i32 s44, s50, 172032
    s_add_u32 s44, s44, 86016
    s_add_u32 m0, s40, 126976
    s_nop 0
    buffer_load_dwordx4 v8, s[12:15], s44 offen lds
    s_mul_i32 s44, s50, 229376
    s_add_u32 s44, s44, s72
    s_add_u32 s44, s44, 114688
    s_add_u32 m0, s40, 131072
    s_nop 0
    buffer_load_dwordx4 v11, s[16:19], s44 offen lds
    s_add_u32 m0, s40, 135168
    s_nop 0
    buffer_load_dwordx4 v12, s[20:23], s44 offen lds
    s_waitcnt lgkmcnt(0)
    s_waitcnt vmcnt(10)
    s_barrier
    s_lshl_b32 s44, s51, 7
    s_add_u32 m0, s42, 49152
    s_nop 0
    buffer_load_dwordx4 v4, s[8:11], s44 offen lds
    s_add_u32 m0, s42, 50176
    s_nop 0
    buffer_load_dwordx4 v5, s[8:11], s44 offen lds
    s_add_u32 m0, s42, 51200
    s_nop 0
    buffer_load_dwordx4 v6, s[8:11], s44 offen lds
    s_add_u32 m0, s42, 52224
    s_nop 0
    buffer_load_dwordx4 v7, s[8:11], s44 offen lds
    s_mul_i32 s44, s51, 172032
    s_add_u32 m0, s40, 139264
    s_nop 0
    buffer_load_dwordx4 v8, s[12:15], s44 offen lds
    s_mul_i32 s44, s51, 229376
    s_add_u32 s44, s44, s72
    s_add_u32 m0, s40, 143360
    s_nop 0
    buffer_load_dwordx4 v11, s[16:19], s44 offen lds
    s_add_u32 m0, s40, 147456
    s_nop 0
    buffer_load_dwordx4 v12, s[20:23], s44 offen lds
    v_mov_b32 v31, 0
    buffer_load_dword v30, v31, s[68:71], 0 offen sc1
    s_lshl_b32 s36, s32, 7
    s_lshl_b32 s37, s33, 3
    s_add_u32 s36, s36, s37
    s_lshl_b32 s37, s35, 1
    s_add_u32 s36, s36, s37
    s_mul_i32 s37, s36, 896
    s_add_u32 s38, s37, 896
    v_mov_b32 v21, 2147479552
    v_cmp_gt_u32 vcc, 56, v1
    s_nop 1
    v_cndmask_b32 v20, v21, v2, vcc
    buffer_load_dwordx4 v[32:35], v20, s[28:31], 0 offen
    buffer_load_dwordx4 v[36:39], v20, s[8:11], s37 offen
    buffer_load_dwordx4 v[40:43], v20, s[8:11], s38 offen
    s_waitcnt vmcnt(14)
    s_barrier
    s_mul_i32 s44, s51, 172032
    s_add_u32 s44, s44, 86016
    s_add_u32 m0, s40, 151552
    s_nop 0
    buffer_load_dwordx4 v8, s[12:15], s44 offen lds
    s_mul_i32 s44, s51, 229376
    s_add_u32 s44, s44, s72
    s_add_u32 s44, s44, 114688
    s_add_u32 m0, s40, 155648
    s_nop 0
    buffer_load_dwordx4 v11, s[16:19], s44 offen lds
    s_add_u32 m0, s40, 159744
    s_nop 0
    buffer_load_dwordx4 v12, s[20:23], s44 offen lds
    s_waitcnt vmcnt(14)
    s_barrier
    s_lshl_b32 s44, s52, 7
    s_add_u32 m0, s42, 65536
    s_nop 0
    buffer_load_dwordx4 v4, s[8:11], s44 offen lds
    s_add_u32 m0, s42, 66560
    s_nop 0
    buffer_load_dwordx4 v5, s[8:11], s44 offen lds
    s_add_u32 m0, s42, 67584
    s_nop 0
    buffer_load_dwordx4 v6, s[8:11], s44 offen lds
    s_add_u32 m0, s42, 68608
    s_nop 0
    buffer_load_dwordx4 v7, s[8:11], s44 offen lds
    s_mul_i32 s44, s52, 172032
    s_add_u32 m0, s40, 114688
    s_nop 0
    buffer_load_dwordx4 v8, s[12:15], s44 offen lds
    s_mul_i32 s44, s52, 229376
    s_add_u32 s44, s44, s72
    s_add_u32 m0, s40, 118784
    s_nop 0
    buffer_load_dwordx4 v11, s[16:19], s44 offen lds
    s_add_u32 m0, s40, 122880
    s_nop 0
    buffer_load_dwordx4 v12, s[20:23], s44 offen lds
    s_waitcnt vmcnt(10)
    s_mov_b32 s47, 1048576
LDI_NONCE:
    v_readfirstlane_b32 s74, v30
    s_nop 0
    s_cmp_lg_u32 s74, 0
    s_cbranch_scc1 LDI_NONCE_OK
    s_sleep 2
    buffer_load_dword v30, v31, s[68:71], 0 offen sc1
    s_waitcnt vmcnt(0)
    s_sub_u32 s47, s47, 1
    s_cmp_lg_u32 s47, 0
    s_cbranch_scc1 LDI_NONCE
LDI_NONCE_OK:
    v_mov_b32 v30, s74
    s_mov_b32 s39, 0xffff0000
    v_lshlrev_b32 v48, 16, v32
    v_and_b32 v49, s39, v32
    v_lshlrev_b32 v50, 16, v33
    v_and_b32 v51, s39, v33
    v_lshlrev_b32 v52, 16, v34
    v_and_b32 v53, s39, v34
    v_lshlrev_b32 v54, 16, v35
    v_and_b32 v55, s39, v35
    v_lshlrev_b32 v56, 16, v36
    v_and_b32 v57, s39, v36
    v_lshlrev_b32 v58, 16, v37
    v_and_b32 v59, s39, v37
    v_lshlrev_b32 v60, 16, v38
    v_and_b32 v61, s39, v38
    v_lshlrev_b32 v62, 16, v39
    v_and_b32 v63, s39, v39
    v_lshlrev_b32 v64, 16, v40
    v_and_b32 v65, s39, v40
    v_lshlrev_b32 v66, 16, v41
    v_and_b32 v67, s39, v41
    v_lshlrev_b32 v68, 16, v42
    v_and_b32 v69, s39, v42
    v_lshlrev_b32 v70, 16, v43
    s_waitcnt vmcnt(14)
    s_barrier
    s_mul_i32 s44, s52, 172032
    s_add_u32 s44, s44, 86016
    s_add_u32 m0, s40, 126976
    s_nop 0
    buffer_load_dwordx4 v8, s[12:15], s44 offen lds
    s_mul_i32 s44, s52, 229376
    s_add_u32 s44, s44, s72
    s_add_u32 s44, s44, 114688
    s_add_u32 m0, s40, 131072
    s_nop 0
    buffer_load_dwordx4 v11, s[16:19], s44 offen lds
    s_add_u32 m0, s40, 135168
    s_nop 0
    buffer_load_dwordx4 v12, s[20:23], s44 offen lds
    v_and_b32 v71, s39, v43
    v_mul_f32 v44, v48, v56
    v_mul_f32 v45, v48, v64
    v_fmac_f32 v44, v49, v57
    v_fmac_f32 v45, v49, v65
    v_fmac_f32 v44, v50, v58
    v_fmac_f32 v45, v50, v66
    v_fmac_f32 v44, v51, v59
    v_fmac_f32 v45, v51, v67
    v_fmac_f32 v44, v52, v60
    v_fmac_f32 v45, v52, v68
    v_fmac_f32 v44, v53, v61
    v_fmac_f32 v45, v53, v69
    v_fmac_f32 v44, v54, v62
    v_fmac_f32 v45, v54, v70
    v_fmac_f32 v44, v55, v63
    v_fmac_f32 v45, v55, v71
    s_nop 1
    v_add_f32_dpp v44, v44, v44 row_shr:1 row_mask:0xf bank_mask:0xf bound_ctrl:0
    v_add_f32_dpp v45, v45, v45 row_shr:1 row_mask:0xf bank_mask:0xf bound_ctrl:0
    s_nop 1
    v_add_f32_dpp v44, v44, v44 row_shr:2 row_mask:0xf bank_mask:0xf bound_ctrl:0
    v_add_f32_dpp v45, v45, v45 row_shr:2 row_mask:0xf bank_mask:0xf bound_ctrl:0
    s_nop 1
    s_waitcnt vmcnt(10)
    s_barrier
    s_lshl_b32 s44, s53, 7
    s_add_u32 m0, s42, 81920
    s_nop 0
    buffer_load_dwordx4 v4, s[8:11], s44 offen lds
    s_add_u32 m0, s42, 82944
    s_nop 0
    buffer_load_dwordx4 v5, s[8:11], s44 offen lds
    s_add_u32 m0, s42, 83968
    s_nop 0
    buffer_load_dwordx4 v6, s[8:11], s44 offen lds
    s_add_u32 m0, s42, 84992
    s_nop 0
    buffer_load_dwordx4 v7, s[8:11], s44 offen lds
    s_mul_i32 s44, s53, 172032
    s_add_u32 m0, s40, 139264
    s_nop 0
    buffer_load_dwordx4 v8, s[12:15], s44 offen lds
    s_mul_i32 s44, s53, 229376
    s_add_u32 s44, s44, s72
    s_add_u32 m0, s40, 143360
    s_nop 0
    buffer_load_dwordx4 v11, s[16:19], s44 offen lds
    s_add_u32 m0, s40, 147456
    s_nop 0
    buffer_load_dwordx4 v12, s[20:23], s44 offen lds
    v_add_f32_dpp v44, v44, v44 row_shr:4 row_mask:0xf bank_mask:0xf bound_ctrl:0
    v_add_f32_dpp v45, v45, v45 row_shr:4 row_mask:0xf bank_mask:0xf bound_ctrl:0
    s_nop 1
    v_add_f32_dpp v44, v44, v44 row_shr:8 row_mask:0xf bank_mask:0xf bound_ctrl:0
    v_add_f32_dpp v45, v45, v45 row_shr:8 row_mask:0xf bank_mask:0xf bound_ctrl:0
    s_nop 1
    v_add_f32_dpp v44, v44, v44 row_bcast:15 row_mask:0xa bank_mask:0xf bound_ctrl:0
    v_add_f32_dpp v45, v45, v45 row_bcast:15 row_mask:0xa bank_mask:0xf bound_ctrl:0
    s_nop 1
    v_add_f32_dpp v44, v44, v44 row_bcast:31 row_mask:0xc bank_mask:0xf bound_ctrl:0
    v_add_f32_dpp v45, v45, v45 row_bcast:31 row_mask:0xc bank_mask:0xf bound_ctrl:0
    v_mov_b32 v46, 0xc2a00000
    s_mov_b32 s39, 0x42200000
    v_med3_f32 v44, v44, s39, v46
    v_med3_f32 v45, v45, s39, v46
    s_mov_b32 s39, 0x3fb8aa3b
    v_mul_f32 v44, s39, v44
    v_mul_f32 v45, s39, v45
    v_exp_f32 v44, v44
    v_exp_f32 v45, v45
    s_nop 0
    v_add_f32 v46, 1.0, v44
    v_add_f32 v47, 1.0, v45
    v_rcp_f32 v46, v46
    s_waitcnt vmcnt(10)
    s_barrier
    s_mul_i32 s44, s53, 172032
    s_add_u32 s44, s44, 86016
    s_add_u32 m0, s40, 151552
    s_nop 0
    buffer_load_dwordx4 v8, s[12:15], s44 offen lds
    s_mul_i32 s44, s53, 229376
    s_add_u32 s44, s44, s72
    s_add_u32 s44, s44, 114688
    s_add_u32 m0, s40, 155648
    s_nop 0
    buffer_load_dwordx4 v11, s[16:19], s44 offen lds
    s_add_u32 m0, s40, 159744
    s_nop 0
    buffer_load_dwordx4 v12, s[20:23], s44 offen lds
    v_rcp_f32 v47, v47
    v_mov_b32 v48, s74
    v_lshlrev_b32 v20, 2, v1
    v_readlane_b32 s4, v44, 63
    v_readlane_b32 s5, v45, 63
    v_readlane_b32 s37, v46, 63
    v_readlane_b32 s38, v47, 63
    s_nop 1
    v_writelane_b32 v48, s4, 0
    v_writelane_b32 v48, s5, 1
    v_writelane_b32 v48, s37, 4
    v_writelane_b32 v48, s38, 5
    s_lshl_b32 s36, s36, 6
    s_add_u32 s36, s36, 16777216
    s_mov_b32 exec_hi, 0
    buffer_store_dword v48, v20, s[24:27], s36 offen sc1
    s_mov_b64 exec, -1
    s_waitcnt vmcnt(11)
    s_barrier
    s_lshl_b32 s44, s54, 7
    s_add_u32 m0, s42, 98304
    s_nop 0
    buffer_load_dwordx4 v4, s[8:11], s44 offen lds
    s_add_u32 m0, s42, 99328
    s_nop 0
    buffer_load_dwordx4 v5, s[8:11], s44 offen lds
    s_add_u32 m0, s42, 100352
    s_nop 0
    buffer_load_dwordx4 v6, s[8:11], s44 offen lds
    s_add_u32 m0, s42, 101376
    s_nop 0
    buffer_load_dwordx4 v7, s[8:11], s44 offen lds
    s_mul_i32 s44, s54, 172032
    s_add_u32 m0, s40, 114688
    s_nop 0
    buffer_load_dwordx4 v8, s[12:15], s44 offen lds
    s_mul_i32 s44, s54, 229376
    s_add_u32 s44, s44, s72
    s_add_u32 m0, s40, 118784
    s_nop 0
    buffer_load_dwordx4 v11, s[16:19], s44 offen lds
    s_add_u32 m0, s40, 122880
    s_nop 0
    buffer_load_dwordx4 v12, s[20:23], s44 offen lds
    s_waitcnt vmcnt(11)
    s_barrier
    s_mul_i32 s44, s54, 172032
    s_add_u32 s44, s44, 86016
    s_add_u32 m0, s40, 126976
    s_nop 0
    buffer_load_dwordx4 v8, s[12:15], s44 offen lds
    s_mul_i32 s44, s54, 229376
    s_add_u32 s44, s44, s72
    s_add_u32 s44, s44, 114688
    s_add_u32 m0, s40, 131072
    s_nop 0
    buffer_load_dwordx4 v11, s[16:19], s44 offen lds
    s_add_u32 m0, s40, 135168
    s_nop 0
    buffer_load_dwordx4 v12, s[20:23], s44 offen lds
    s_waitcnt vmcnt(11)
    s_barrier
    s_mul_i32 s44, s48, 229376
    s_add_u32 s44, s44, s73
    s_add_u32 m0, s40, 139264
    s_nop 0
    buffer_load_dwordx4 v11, s[16:19], s44 offen lds
    s_add_u32 m0, s40, 143360
    s_nop 0
    buffer_load_dwordx4 v12, s[20:23], s44 offen lds
    s_waitcnt vmcnt(5)
    s_barrier
    s_mul_i32 s44, s48, 229376
    s_add_u32 s44, s44, s73
    s_add_u32 s44, s44, 114688
    s_add_u32 m0, s40, 147456
    s_nop 0
    buffer_load_dwordx4 v11, s[16:19], s44 offen lds
    s_add_u32 m0, s40, 151552
    s_nop 0
    buffer_load_dwordx4 v12, s[20:23], s44 offen lds
    s_mul_i32 s44, s49, 229376
    s_add_u32 s44, s44, s73
    s_add_u32 m0, s40, 155648
    s_nop 0
    buffer_load_dwordx4 v11, s[16:19], s44 offen lds
    s_add_u32 m0, s40, 159744
    s_nop 0
    buffer_load_dwordx4 v12, s[20:23], s44 offen lds
    s_mov_b32 s43, 0
    s_and_b32 s4, s2, 7
    s_lshl_b32 s4, s4, 1
    s_lshr_b32 s5, s2, 7
    s_add_u32 s37, s4, s5
    s_bfe_u32 s38, s2, 0x40003
    s_lshl_b32 s6, s37, 18
    s_add_u32 s6, s6, 2097152
    s_lshl_b32 s5, s35, 16
    s_add_u32 s39, s6, s5
    s_mul_i32 s46, s37, 12288
    s_add_u32 s46, s46, 17039360
    v_and_b32 v3, 7, v1
    v_bfe_u32 v20, v1, 3, 1
    v_lshl_add_u32 v3, v20, 5, v3
    s_lshl_b32 s4, s35, 3
    s_add_u32 s4, s4, 32
    v_add_u32 v3, s4, v3
    v_lshlrev_b32 v3, 7, v3
    v_add_u32 v3, s46, v3
    s_add_u32 s4, s46, 4096
    v_writelane_b32 v3, s4, 16
    s_lshl_b32 s4, s38, 1
    s_lshr_b32 s5, s35, 1
    s_add_u32 s4, s4, s5
    s_lshl_b32 s4, s4, 7
    s_add_u32 s4, s4, s46
    v_writelane_b32 v3, s4, 17
    s_lshl_b32 s4, s38, 2
    s_add_u32 s4, s4, s35
    s_lshl_b32 s4, s4, 11
    s_add_u32 s4, s4, 16774920
    v_lshlrev_b32 v20, 7, v1
    v_add_u32 v20, s4, v20
    s_mov_b32 s4, 0xfffc0000
    s_mov_b32 s5, 3
    v_cndmask_b32 v3, v3, v20, s[4:5]
    v_bfe_u32 v25, v1, 1, 4
    v_lshlrev_b32 v25, 7, v25
    v_and_b32 v26, 1, v1
    v_lshl_add_u32 v25, v26, 2, v25
    s_waitcnt vmcnt(6)
    s_barrier
    s_mul_i32 s44, s49, 229376
    s_add_u32 s44, s44, s73
    s_add_u32 s44, s44, 114688
    s_add_u32 m0, s40, 114688
    s_nop 0
    buffer_load_dwordx4 v11, s[16:19], s44 offen lds
    s_add_u32 m0, s40, 118784
    s_nop 0
    buffer_load_dwordx4 v12, s[20:23], s44 offen lds
    s_waitcnt vmcnt(6)
    s_barrier
    s_mul_i32 s44, s50, 229376
    s_add_u32 s44, s44, s73
    s_add_u32 m0, s40, 122880
    s_nop 0
    buffer_load_dwordx4 v11, s[16:19], s44 offen lds
    s_add_u32 m0, s40, 126976
    s_nop 0
    buffer_load_dwordx4 v12, s[20:23], s44 offen lds
    s_mul_i32 s44, s50, 229376
    s_add_u32 s44, s44, s73
    s_add_u32 s44, s44, 114688
    s_add_u32 m0, s40, 131072
    s_nop 0
    buffer_load_dwordx4 v11, s[16:19], s44 offen lds
    s_add_u32 m0, s40, 135168
    s_nop 0
    buffer_load_dwordx4 v12, s[20:23], s44 offen lds
    s_waitcnt vmcnt(8)
    s_barrier
    s_waitcnt vmcnt(6)
    s_barrier
    s_mul_i32 s44, s51, 229376
    s_add_u32 s44, s44, s73
    s_add_u32 m0, s40, 139264
    s_nop 0
    buffer_load_dwordx4 v11, s[16:19], s44 offen lds
    s_add_u32 m0, s40, 143360
    s_nop 0
    buffer_load_dwordx4 v12, s[20:23], s44 offen lds
    s_waitcnt vmcnt(6)
    s_barrier
    s_mul_i32 s44, s51, 229376
    s_add_u32 s44, s44, s73
    s_add_u32 s44, s44, 114688
    s_add_u32 m0, s40, 147456
    s_nop 0
    buffer_load_dwordx4 v11, s[16:19], s44 offen lds
    s_add_u32 m0, s40, 151552
    s_nop 0
    buffer_load_dwordx4 v12, s[20:23], s44 offen lds
    s_waitcnt vmcnt(6)
    s_barrier
    s_mul_i32 s44, s52, 229376
    s_add_u32 s44, s44, s73
    s_add_u32 m0, s40, 155648
    s_nop 0
    buffer_load_dwordx4 v11, s[16:19], s44 offen lds
    s_add_u32 m0, s40, 159744
    s_nop 0
    buffer_load_dwordx4 v12, s[20:23], s44 offen lds
    v_mov_b32 v28, 0
    ds_write_b32 v28, v28
    v_lshlrev_b32 v29, 2, v1
    s_lshl_b32 s4, s35, 8
    v_add_u32 v29, s4, v29
    ds_write_b32 v29, v28 offset:256
    s_waitcnt lgkmcnt(0)
    s_waitcnt vmcnt(6)
    s_barrier
    s_mul_i32 s44, s52, 229376
    s_add_u32 s44, s44, s73
    s_add_u32 s44, s44, 114688
    s_add_u32 m0, s40, 114688
    s_nop 0
    buffer_load_dwordx4 v11, s[16:19], s44 offen lds
    s_add_u32 m0, s40, 118784
    s_nop 0
    buffer_load_dwordx4 v12, s[20:23], s44 offen lds
    s_waitcnt vmcnt(6)
    s_barrier
    s_mul_i32 s44, s53, 229376
    s_add_u32 s44, s44, s73
    s_add_u32 m0, s40, 122880
    s_nop 0
    buffer_load_dwordx4 v11, s[16:19], s44 offen lds
    s_add_u32 m0, s40, 126976
    s_nop 0
    buffer_load_dwordx4 v12, s[20:23], s44 offen lds
    s_waitcnt vmcnt(6)
    s_barrier
    s_mul_i32 s44, s53, 229376
    s_add_u32 s44, s44, s73
    s_add_u32 s44, s44, 114688
    s_add_u32 m0, s40, 131072
    s_nop 0
    buffer_load_dwordx4 v11, s[16:19], s44 offen lds
    s_add_u32 m0, s40, 135168
    s_nop 0
    buffer_load_dwordx4 v12, s[20:23], s44 offen lds
    s_waitcnt vmcnt(6)
    s_barrier
    s_mul_i32 s44, s54, 229376
    s_add_u32 s44, s44, s73
    s_add_u32 m0, s40, 139264
    s_nop 0
    buffer_load_dwordx4 v11, s[16:19], s44 offen lds
    s_add_u32 m0, s40, 143360
    s_nop 0
    buffer_load_dwordx4 v12, s[20:23], s44 offen lds
    s_waitcnt vmcnt(6)
    s_barrier
    s_mul_i32 s44, s54, 229376
    s_add_u32 s44, s44, s73
    s_add_u32 s44, s44, 114688
    s_add_u32 m0, s40, 147456
    s_nop 0
    buffer_load_dwordx4 v11, s[16:19], s44 offen lds
    s_add_u32 m0, s40, 151552
    s_nop 0
    buffer_load_dwordx4 v12, s[20:23], s44 offen lds
    s_waitcnt vmcnt(6)
    s_barrier
    buffer_load_dword v21, v3, s[24:27], 0 offen sc1
    s_waitcnt vmcnt(5)
    s_barrier
    s_waitcnt vmcnt(1)
    s_getreg_b32 s4, hwreg(HW_REG_IB_STS)
    s_and_b32 s4, s4, 0xc0000f
    s_or_b32 s4, s4, s43
    s_cbranch_scc1 LDI_TRY25_SKIP
    v_cmp_ne_u32 vcc, s74, v21
    s_nop 0
    s_cmp_eq_u64 vcc, 0
    s_cbranch_scc1 LDI_TRY25_GO
    buffer_load_dword v21, v3, s[24:27], 0 offen sc1
    s_branch LDI_TRY25_SKIP
LDI_TRY25_GO:
    s_lshl_b32 s4, s37, 4
    s_add_u32 s4, s4, s38
    s_lshl_b32 s4, s4, 2
    s_add_u32 s4, s4, s35
    s_lshl_b32 s44, s4, 11
    buffer_load_dwordx4 v[32:35], v2, s[24:27], s44 offen offset:0 sc1
    buffer_load_dwordx4 v[36:39], v2, s[24:27], s44 offen offset:1024 sc1
    buffer_load_dwordx4 v[40:43], v2, s[24:27], s6 offen offset:0 sc1
    buffer_load_dwordx4 v[44:47], v2, s[24:27], s6 offen offset:1024 sc1
    s_add_u32 m0, s42, 26624
    s_lshl_b32 s44, s38, 12
    s_add_u32 s44, s44, s39
    buffer_load_dwordx4 v2, s[24:27], s44 offen offset:0 sc1 lds
    buffer_load_dwordx4 v2, s[24:27], s44 offen offset:1024 sc1 lds
    buffer_load_dwordx4 v2, s[24:27], s44 offen offset:2048 sc1 lds
    buffer_load_dwordx4 v2, s[24:27], s44 offen offset:3072 sc1 lds
    s_lshl_b32 s4, s35, 8
    s_add_u32 m0, s4, 43008
    s_lshl_b32 s44, s38, 2
    s_add_u32 s44, s44, s35
    s_lshl_b32 s44, s44, 11
    s_add_u32 s44, s44, 16777216
    buffer_load_dword v25, s[24:27], s44 offen sc1 lds
    s_mov_b32 s43, 1
LDI_TRY25_SKIP:
    s_barrier
    s_getreg_b32 s4, hwreg(HW_REG_IB_STS)
    s_and_b32 s4, s4, 0xc0000f
    s_or_b32 s4, s4, s43
    s_cbranch_scc1 LDI_TRY26_SKIP
    v_cmp_ne_u32 vcc, s74, v21
    s_nop 0
    s_cmp_eq_u64 vcc, 0
    s_cbranch_scc1 LDI_TRY26_GO
    buffer_load_dword v21, v3, s[24:27], 0 offen sc1
    s_branch LDI_TRY26_SKIP
LDI_TRY26_GO:
    s_lshl_b32 s4, s37, 4
    s_add_u32 s4, s4, s38
    s_lshl_b32 s4, s4, 2
    s_add_u32 s4, s4, s35
    s_lshl_b32 s44, s4, 11
    buffer_load_dwordx4 v[32:35], v2, s[24:27], s44 offen offset:0 sc1
    buffer_load_dwordx4 v[36:39], v2, s[24:27], s44 offen offset:1024 sc1
    buffer_load_dwordx4 v[40:43], v2, s[24:27], s6 offen offset:0 sc1
    buffer_load_dwordx4 v[44:47], v2, s[24:27], s6 offen offset:1024 sc1
    s_add_u32 m0, s42, 26624
    s_lshl_b32 s44, s38, 12
    s_add_u32 s44, s44, s39
    buffer_load_dwordx4 v2, s[24:27], s44 offen offset:0 sc1 lds
    buffer_load_dwordx4 v2, s[24:27], s44 offen offset:1024 sc1 lds
    buffer_load_dwordx4 v2, s[24:27], s44 offen offset:2048 sc1 lds
    buffer_load_dwordx4 v2, s[24:27], s44 offen offset:3072 sc1 lds
    s_lshl_b32 s4, s35, 8
    s_add_u32 m0, s4, 43008
    s_lshl_b32 s44, s38, 2
    s_add_u32 s44, s44, s35
    s_lshl_b32 s44, s44, 11
    s_add_u32 s44, s44, 16777216
    buffer_load_dword v25, s[24:27], s44 offen sc1 lds
    s_mov_b32 s43, 1
LDI_TRY26_SKIP:
    s_barrier
    s_branch ROLE_G
K_LII:
    s_add_u32 s73, s6, 24
    s_mov_b32 s72, 0
    s_lshl_b32 s34, s6, 4
    s_cmp_eq_u32 s6, 3
    s_cselect_b32 s34, 38, s34
    s_mul_i32 s38, s34, 56
    s_lshl_b32 s37, s35, 3
    v_and_b32 v25, 1, v21
    v_lshlrev_b32 v25, 2, v25
    v_add_u32 v26, s37, v20
    s_lshl_b32 s39, s35, 6
    v_add_u32 v27, s39, v1
    v_add_u32 v23, 0, v27
    v_mul_u32_u24 v24, 2731, v23
    v_lshrrev_b32 v24, 16, v24
    v_mul_u32_u24 v28, 24, v24
    v_sub_u32 v28, v23, v28
    v_lshlrev_b32 v29, 1, v24
    v_and_b32 v29, 4, v29
    v_xor_b32 v28, v28, v29
    v_min_u32 v28, 21, v28
    v_mul_u32_u24 v24, 2688, v24
    v_lshl_add_u32 v8, v28, 4, v24
    v_add_u32 v8, s38, v8
    v_add_u32 v23, 256, v27
    v_mul_u32_u24 v24, 2731, v23
    v_lshrrev_b32 v24, 16, v24
    v_mul_u32_u24 v28, 24, v24
    v_sub_u32 v28, v23, v28
    v_lshlrev_b32 v29, 1, v24
    v_and_b32 v29, 4, v29
    v_xor_b32 v28, v28, v29
    v_min_u32 v28, 21, v28
    v_mul_u32_u24 v24, 2688, v24
    v_lshl_add_u32 v9, v28, 4, v24
    v_add_u32 v9, s38, v9
    v_add_u32 v23, 512, v27
    v_mul_u32_u24 v24, 2731, v23
    v_lshrrev_b32 v24, 16, v24
    v_mul_u32_u24 v28, 24, v24
    v_sub_u32 v28, v23, v28
    v_lshlrev_b32 v29, 1, v24
    v_and_b32 v29, 4, v29
    v_xor_b32 v28, v28, v29
    v_min_u32 v28, 21, v28
    v_mul_u32_u24 v24, 2688, v24
    v_lshl_add_u32 v10, v28, 4, v24
    v_add_u32 v10, s38, v10
    v_mul_u32_u24 v24, 3584, v26
    v_add_u32 v23, 0, v25
    v_xor_b32 v23, v22, v23
    v_lshl_add_u32 v11, v23, 4, v24
    v_add_u32 v23, 2, v25
    v_xor_b32 v23, v22, v23
    v_lshl_add_u32 v12, v23, 4, v24
    s_mov_b32 s48, 0
    s_add_u32 s49, s75, 1
    s_cmp_ge_u32 s49, 7
    s_cselect_b32 s4, 6, 0
    s_sub_u32 s49, s49, s4
    s_add_u32 s50, s75, 2
    s_cmp_ge_u32 s50, 7
    s_cselect_b32 s4, 6, 0
    s_sub_u32 s50, s50, s4
    s_add_u32 s51, s75, 3
    s_cmp_ge_u32 s51, 7
    s_cselect_b32 s4, 6, 0
    s_sub_u32 s51, s51, s4
    s_add_u32 s52, s75, 4
    s_cmp_ge_u32 s52, 7
    s_cselect_b32 s4, 6, 0
    s_sub_u32 s52, s52, s4
    s_add_u32 s53, s75, 5
    s_cmp_ge_u32 s53, 7
    s_cselect_b32 s4, 6, 0
    s_sub_u32 s53, s53, s4
    s_add_u32 s54, s75, 6
    s_cmp_ge_u32 s54, 7
    s_cselect_b32 s4, 6, 0
    s_sub_u32 s54, s54, s4
    s_lshl_b32 s40, s35, 10
    s_lshl_b32 s72, s72, 7
    s_lshl_b32 s73, s73, 7
    s_mul_i32 s44, s49, 172032
    s_add_u32 m0, s40, 139264
    s_nop 0
    buffer_load_dwordx4 v8, s[12:15], s44 offen lds
    s_add_u32 m0, s40, 143360
    s_nop 0
    buffer_load_dwordx4 v9, s[12:15], s44 offen lds
    s_add_u32 m0, s40, 147456
    s_nop 0
    buffer_load_dwordx4 v10, s[12:15], s44 offen lds
    s_mul_i32 s44, s49, 172032
    s_add_u32 s44, s44, 86016
    s_add_u32 m0, s40, 151552
    s_nop 0
    buffer_load_dwordx4 v8, s[12:15], s44 offen lds
    s_add_u32 m0, s40, 155648
    s_nop 0
    buffer_load_dwordx4 v9, s[12:15], s44 offen lds
    s_add_u32 m0, s40, 159744
    s_nop 0
    buffer_load_dwordx4 v10, s[12:15], s44 offen lds
    s_waitcnt vmcnt(10)
    s_barrier
    s_waitcnt vmcnt(10)
    s_barrier
    s_lshl_b32 s44, s50, 7
    s_add_u32 m0, s42, 32768
    s_nop 0
    buffer_load_dwordx4 v4, s[8:11], s44 offen lds
    s_add_u32 m0, s42, 33792
    s_nop 0
    buffer_load_dwordx4 v5, s[8:11], s44 offen lds
    s_add_u32 m0, s42, 34816
    s_nop 0
    buffer_load_dwordx4 v6, s[8:11], s44 offen lds
    s_add_u32 m0, s42, 35840
    s_nop 0
    buffer_load_dwordx4 v7, s[8:11], s44 offen lds
    s_mul_i32 s44, s50, 172032
    s_add_u32 m0, s40, 114688
    s_nop 0
    buffer_load_dwordx4 v8, s[12:15], s44 offen lds
    s_add_u32 m0, s40, 118784
    s_nop 0
    buffer_load_dwordx4 v9, s[12:15], s44 offen lds
    s_add_u32 m0, s40, 122880
    s_nop 0
    buffer_load_dwordx4 v10, s[12:15], s44 offen lds
    s_load_dwordx2 s[28:29], s[0:1], 56
    s_load_dwordx2 s[24:25], s[0:1], 80
    s_load_dwordx2 s[56:57], s[0:1], 48
    s_load_dwordx2 s[60:61], s[0:1], 16
    s_load_dwordx2 s[64:65], s[0:1], 64
    s_load_dwordx2 s[68:69], s[0:1], 72
    s_mov_b32 s30, 896
    s_mov_b32 s31, 0x00020000
    s_mov_b32 s26, 17498112
    s_mov_b32 s27, 0x00020000
    s_mov_b32 s58, 1605632
    s_mov_b32 s59, 0x00020000
    s_mov_b32 s62, 401408
    s_mov_b32 s63, 0x00020000
    s_mov_b32 s66, 1835008
    s_mov_b32 s67, 0x00020000
    s_mov_b32 s70, 256
    s_mov_b32 s71, 0x00020000
    s_waitcnt vmcnt(10)
    s_barrier
    s_mul_i32 s44, s50, 172032
    s_add_u32 s44, s44, 86016
    s_add_u32 m0, s40, 126976
    s_nop 0
    buffer_load_dwordx4 v8, s[12:15], s44 offen lds
    s_add_u32 m0, s40, 131072
    s_nop 0
    buffer_load_dwordx4 v9, s[12:15], s44 offen lds
    s_add_u32 m0, s40, 135168
    s_nop 0
    buffer_load_dwordx4 v10, s[12:15], s44 offen lds
    s_waitcnt lgkmcnt(0)
    s_waitcnt vmcnt(10)
    s_barrier
    s_lshl_b32 s44, s51, 7
    s_add_u32 m0, s42, 49152
    s_nop 0
    buffer_load_dwordx4 v4, s[8:11], s44 offen lds
    s_add_u32 m0, s42, 50176
    s_nop 0
    buffer_load_dwordx4 v5, s[8:11], s44 offen lds
    s_add_u32 m0, s42, 51200
    s_nop 0
    buffer_load_dwordx4 v6, s[8:11], s44 offen lds
    s_add_u32 m0, s42, 52224
    s_nop 0
    buffer_load_dwordx4 v7, s[8:11], s44 offen lds
    s_mul_i32 s44, s51, 172032
    s_add_u32 m0, s40, 139264
    s_nop 0
    buffer_load_dwordx4 v8, s[12:15], s44 offen lds
    s_add_u32 m0, s40, 143360
    s_nop 0
    buffer_load_dwordx4 v9, s[12:15], s44 offen lds
    s_add_u32 m0, s40, 147456
    s_nop 0
    buffer_load_dwordx4 v10, s[12:15], s44 offen lds
    v_mov_b32 v31, 0
    buffer_load_dword v30, v31, s[68:71], 0 offen sc1
    s_lshl_b32 s36, s32, 7
    s_lshl_b32 s37, s33, 3
    s_add_u32 s36, s36, s37
    s_lshl_b32 s37, s35, 1
    s_add_u32 s36, s36, s37
    s_mul_i32 s37, s36, 896
    s_add_u32 s38, s37, 896
    v_mov_b32 v21, 2147479552
    v_cmp_gt_u32 vcc, 56, v1
    s_nop 1
    v_cndmask_b32 v20, v21, v2, vcc
    buffer_load_dwordx4 v[32:35], v20, s[28:31], 0 offen
    buffer_load_dwordx4 v[36:39], v20, s[8:11], s37 offen
    buffer_load_dwordx4 v[40:43], v20, s[8:11], s38 offen
    s_waitcnt vmcnt(14)
    s_barrier
    s_mul_i32 s44, s51, 172032
    s_add_u32 s44, s44, 86016
    s_add_u32 m0, s40, 151552
    s_nop 0
    buffer_load_dwordx4 v8, s[12:15], s44 offen lds
    s_add_u32 m0, s40, 155648
    s_nop 0
    buffer_load_dwordx4 v9, s[12:15], s44 offen lds
    s_add_u32 m0, s40, 159744
    s_nop 0
    buffer_load_dwordx4 v10, s[12:15], s44 offen lds
    s_waitcnt vmcnt(14)
    s_barrier
    s_lshl_b32 s44, s52, 7
    s_add_u32 m0, s42, 65536
    s_nop 0
    buffer_load_dwordx4 v4, s[8:11], s44 offen lds
    s_add_u32 m0, s42, 66560
    s_nop 0
    buffer_load_dwordx4 v5, s[8:11], s44 offen lds
    s_add_u32 m0, s42, 67584
    s_nop 0
    buffer_load_dwordx4 v6, s[8:11], s44 offen lds
    s_add_u32 m0, s42, 68608
    s_nop 0
    buffer_load_dwordx4 v7, s[8:11], s44 offen lds
    s_mul_i32 s44, s52, 172032
    s_add_u32 m0, s40, 114688
    s_nop 0
    buffer_load_dwordx4 v8, s[12:15], s44 offen lds
    s_add_u32 m0, s40, 118784
    s_nop 0
    buffer_load_dwordx4 v9, s[12:15], s44 offen lds
    s_add_u32 m0, s40, 122880
    s_nop 0
    buffer_load_dwordx4 v10, s[12:15], s44 offen lds
    s_waitcnt vmcnt(10)
    s_mov_b32 s47, 1048576
LDII_NONCE:
    v_readfirstlane_b32 s74, v30
    s_nop 0
    s_cmp_lg_u32 s74, 0
    s_cbranch_scc1 LDII_NONCE_OK
    s_sleep 2
    buffer_load_dword v30, v31, s[68:71], 0 offen sc1
    s_waitcnt vmcnt(0)
    s_sub_u32 s47, s47, 1
    s_cmp_lg_u32 s47, 0
    s_cbranch_scc1 LDII_NONCE
LDII_NONCE_OK:
    v_mov_b32 v30, s74
    s_mov_b32 s39, 0xffff0000
    v_lshlrev_b32 v48, 16, v32
    v_and_b32 v49, s39, v32
    v_lshlrev_b32 v50, 16, v33
    v_and_b32 v51, s39, v33
    v_lshlrev_b32 v52, 16, v34
    v_and_b32 v53, s39, v34
    v_lshlrev_b32 v54, 16, v35
    v_and_b32 v55, s39, v35
    v_lshlrev_b32 v56, 16, v36
    v_and_b32 v57, s39, v36
    v_lshlrev_b32 v58, 16, v37
    v_and_b32 v59, s39, v37
    v_lshlrev_b32 v60, 16, v38
    v_and_b32 v61, s39, v38
    v_lshlrev_b32 v62, 16, v39
    v_and_b32 v63, s39, v39
    v_lshlrev_b32 v64, 16, v40
    v_and_b32 v65, s39, v40
    v_lshlrev_b32 v66, 16, v41
    v_and_b32 v67, s39, v41
    v_lshlrev_b32 v68, 16, v42
    v_and_b32 v69, s39, v42
    v_lshlrev_b32 v70, 16, v43
    s_waitcnt vmcnt(14)
    s_barrier
    s_mul_i32 s44, s52, 172032
    s_add_u32 s44, s44, 86016
    s_add_u32 m0, s40, 126976
    s_nop 0
    buffer_load_dwordx4 v8, s[12:15], s44 offen lds
    s_add_u32 m0, s40, 131072
    s_nop 0
    buffer_load_dwordx4 v9, s[12:15], s44 offen lds
    s_add_u32 m0, s40, 135168
    s_nop 0
    buffer_load_dwordx4 v10, s[12:15], s44 offen lds
    v_and_b32 v71, s39, v43
    v_mul_f32 v44, v48, v56
    v_mul_f32 v45, v48, v64
    v_fmac_f32 v44, v49, v57
    v_fmac_f32 v45, v49, v65
    v_fmac_f32 v44, v50, v58
    v_fmac_f32 v45, v50, v66
    v_fmac_f32 v44, v51, v59
    v_fmac_f32 v45, v51, v67
    v_fmac_f32 v44, v52, v60
    v_fmac_f32 v45, v52, v68
    v_fmac_f32 v44, v53, v61
    v_fmac_f32 v45, v53, v69
    v_fmac_f32 v44, v54, v62
    v_fmac_f32 v45, v54, v70
    v_fmac_f32 v44, v55, v63
    v_fmac_f32 v45, v55, v71
    s_nop 1
    v_add_f32_dpp v44, v44, v44 row_shr:1 row_mask:0xf bank_mask:0xf bound_ctrl:0
    v_add_f32_dpp v45, v45, v45 row_shr:1 row_mask:0xf bank_mask:0xf bound_ctrl:0
    s_nop 1
    v_add_f32_dpp v44, v44, v44 row_shr:2 row_mask:0xf bank_mask:0xf bound_ctrl:0
    v_add_f32_dpp v45, v45, v45 row_shr:2 row_mask:0xf bank_mask:0xf bound_ctrl:0
    s_nop 1
    s_waitcnt vmcnt(10)
    s_barrier
    s_lshl_b32 s44, s53, 7
    s_add_u32 m0, s42, 81920
    s_nop 0
    buffer_load_dwordx4 v4, s[8:11], s44 offen lds
    s_add_u32 m0, s42, 82944
    s_nop 0
    buffer_load_dwordx4 v5, s[8:11], s44 offen lds
    s_add_u32 m0, s42, 83968
    s_nop 0
    buffer_load_dwordx4 v6, s[8:11], s44 offen lds
    s_add_u32 m0, s42, 84992
    s_nop 0
    buffer_load_dwordx4 v7, s[8:11], s44 offen lds
    s_mul_i32 s44, s53, 172032
    s_add_u32 m0, s40, 139264
    s_nop 0
    buffer_load_dwordx4 v8, s[12:15], s44 offen lds
    s_add_u32 m0, s40, 143360
    s_nop 0
    buffer_load_dwordx4 v9, s[12:15], s44 offen lds
    s_add_u32 m0, s40, 147456
    s_nop 0
    buffer_load_dwordx4 v10, s[12:15], s44 offen lds
    v_add_f32_dpp v44, v44, v44 row_shr:4 row_mask:0xf bank_mask:0xf bound_ctrl:0
    v_add_f32_dpp v45, v45, v45 row_shr:4 row_mask:0xf bank_mask:0xf bound_ctrl:0
    s_nop 1
    v_add_f32_dpp v44, v44, v44 row_shr:8 row_mask:0xf bank_mask:0xf bound_ctrl:0
    v_add_f32_dpp v45, v45, v45 row_shr:8 row_mask:0xf bank_mask:0xf bound_ctrl:0
    s_nop 1
    v_add_f32_dpp v44, v44, v44 row_bcast:15 row_mask:0xa bank_mask:0xf bound_ctrl:0
    v_add_f32_dpp v45, v45, v45 row_bcast:15 row_mask:0xa bank_mask:0xf bound_ctrl:0
    s_nop 1
    v_add_f32_dpp v44, v44, v44 row_bcast:31 row_mask:0xc bank_mask:0xf bound_ctrl:0
    v_add_f32_dpp v45, v45, v45 row_bcast:31 row_mask:0xc bank_mask:0xf bound_ctrl:0
    v_mov_b32 v46, 0xc2a00000
    s_mov_b32 s39, 0x42200000
    v_med3_f32 v44, v44, s39, v46
    v_med3_f32 v45, v45, s39, v46
    s_mov_b32 s39, 0x3fb8aa3b
    v_mul_f32 v44, s39, v44
    v_mul_f32 v45, s39, v45
    v_exp_f32 v44, v44
    v_exp_f32 v45, v45
    s_nop 0
    v_add_f32 v46, 1.0, v44
    v_add_f32 v47, 1.0, v45
    v_rcp_f32 v46, v46
    s_waitcnt vmcnt(10)
    s_barrier
    s_mul_i32 s44, s53, 172032
    s_add_u32 s44, s44, 86016
    s_add_u32 m0, s40, 151552
    s_nop 0
    buffer_load_dwordx4 v8, s[12:15], s44 offen lds
    s_add_u32 m0, s40, 155648
    s_nop 0
    buffer_load_dwordx4 v9, s[12:15], s44 offen lds
    s_add_u32 m0, s40, 159744
    s_nop 0
    buffer_load_dwordx4 v10, s[12:15], s44 offen lds
    v_rcp_f32 v47, v47
    v_mov_b32 v48, s74
    v_lshlrev_b32 v20, 2, v1
    v_readlane_b32 s4, v44, 63
    v_readlane_b32 s5, v45, 63
    v_readlane_b32 s37, v46, 63
    v_readlane_b32 s38, v47, 63
    s_nop 1
    v_writelane_b32 v48, s4, 0
    v_writelane_b32 v48, s5, 1
    v_writelane_b32 v48, s37, 4
    v_writelane_b32 v48, s38, 5
    s_lshl_b32 s36, s36, 6
    s_add_u32 s36, s36, 16777216
    s_mov_b32 exec_hi, 0
    buffer_store_dword v48, v20, s[24:27], s36 offen sc1
    s_mov_b64 exec, -1
    s_waitcnt vmcnt(11)
    s_barrier
    s_lshl_b32 s44, s54, 7
    s_add_u32 m0, s42, 98304
    s_nop 0
    buffer_load_dwordx4 v4, s[8:11], s44 offen lds
    s_add_u32 m0, s42, 99328
    s_nop 0
    buffer_load_dwordx4 v5, s[8:11], s44 offen lds
    s_add_u32 m0, s42, 100352
    s_nop 0
    buffer_load_dwordx4 v6, s[8:11], s44 offen lds
    s_add_u32 m0, s42, 101376
    s_nop 0
    buffer_load_dwordx4 v7, s[8:11], s44 offen lds
    s_mul_i32 s44, s54, 172032
    s_add_u32 m0, s40, 114688
    s_nop 0
    buffer_load_dwordx4 v8, s[12:15], s44 offen lds
    s_add_u32 m0, s40, 118784
    s_nop 0
    buffer_load_dwordx4 v9, s[12:15], s44 offen lds
    s_add_u32 m0, s40, 122880
    s_nop 0
    buffer_load_dwordx4 v10, s[12:15], s44 offen lds
    s_waitcnt vmcnt(11)
    s_barrier
    s_mul_i32 s44, s54, 172032
    s_add_u32 s44, s44, 86016
    s_add_u32 m0, s40, 126976
    s_nop 0
    buffer_load_dwordx4 v8, s[12:15], s44 offen lds
    s_add_u32 m0, s40, 131072
    s_nop 0
    buffer_load_dwordx4 v9, s[12:15], s44 offen lds
    s_add_u32 m0, s40, 135168
    s_nop 0
    buffer_load_dwordx4 v10, s[12:15], s44 offen lds
    s_waitcnt vmcnt(11)
    s_barrier
    s_mul_i32 s44, s48, 229376
    s_add_u32 s44, s44, s73
    s_add_u32 m0, s40, 139264
    s_nop 0
    buffer_load_dwordx4 v11, s[16:19], s44 offen lds
    s_add_u32 m0, s40, 143360
    s_nop 0
    buffer_load_dwordx4 v12, s[20:23], s44 offen lds
    s_waitcnt vmcnt(5)
    s_barrier
    s_mul_i32 s44, s48, 229376
    s_add_u32 s44, s44, s73
    s_add_u32 s44, s44, 114688
    s_add_u32 m0, s40, 147456
    s_nop 0
    buffer_load_dwordx4 v11, s[16:19], s44 offen lds
    s_add_u32 m0, s40, 151552
    s_nop 0
    buffer_load_dwordx4 v12, s[20:23], s44 offen lds
    s_mul_i32 s44, s49, 229376
    s_add_u32 s44, s44, s73
    s_add_u32 m0, s40, 155648
    s_nop 0
    buffer_load_dwordx4 v11, s[16:19], s44 offen lds
    s_add_u32 m0, s40, 159744
    s_nop 0
    buffer_load_dwordx4 v12, s[20:23], s44 offen lds
    s_mov_b32 s43, 0
    s_and_b32 s4, s2, 7
    s_lshl_b32 s4, s4, 1
    s_lshr_b32 s5, s2, 7
    s_add_u32 s37, s4, s5
    s_bfe_u32 s38, s2, 0x40003
    s_lshl_b32 s6, s37, 18
    s_add_u32 s6, s6, 2097152
    s_lshl_b32 s5, s35, 16
    s_add_u32 s39, s6, s5
    s_mul_i32 s46, s37, 12288
    s_add_u32 s46, s46, 17039360
    v_and_b32 v3, 7, v1
    v_bfe_u32 v20, v1, 3, 1
    v_lshl_add_u32 v3, v20, 5, v3
    s_lshl_b32 s4, s35, 3
    s_add_u32 s4, s4, 32
    v_add_u32 v3, s4, v3
    v_lshlrev_b32 v3, 7, v3
    v_add_u32 v3, s46, v3
    s_add_u32 s4, s46, 4096
    v_writelane_b32 v3, s4, 16
    s_lshl_b32 s4, s38, 1
    s_lshr_b32 s5, s35, 1
    s_add_u32 s4, s4, s5
    s_lshl_b32 s4, s4, 7
    s_add_u32 s4, s4, s46
    v_writelane_b32 v3, s4, 17
    s_lshl_b32 s4, s38, 2
    s_add_u32 s4, s4, s35
    s_lshl_b32 s4, s4, 11
    s_add_u32 s4, s4, 16774920
    v_lshlrev_b32 v20, 7, v1
    v_add_u32 v20, s4, v20
    s_mov_b32 s4, 0xfffc0000
    s_mov_b32 s5, 3
    v_cndmask_b32 v3, v3, v20, s[4:5]
    v_bfe_u32 v25, v1, 1, 4
    v_lshlrev_b32 v25, 7, v25
    v_and_b32 v26, 1, v1
    v_lshl_add_u32 v25, v26, 2, v25
    s_waitcnt vmcnt(6)
    s_barrier
    s_mul_i32 s44, s49, 229376
    s_add_u32 s44, s44, s73
    s_add_u32 s44, s44, 114688
    s_add_u32 m0, s40, 114688
    s_nop 0
    buffer_load_dwordx4 v11, s[16:19], s44 offen lds
    s_add_u32 m0, s40, 118784
    s_nop 0
    buffer_load_dwordx4 v12, s[20:23], s44 offen lds
    s_waitcnt vmcnt(6)
    s_barrier
    s_mul_i32 s44, s50, 229376
    s_add_u32 s44, s44, s73
    s_add_u32 m0, s40, 122880
    s_nop 0
    buffer_load_dwordx4 v11, s[16:19], s44 offen lds
    s_add_u32 m0, s40, 126976
    s_nop 0
    buffer_load_dwordx4 v12, s[20:23], s44 offen lds
    s_mul_i32 s44, s50, 229376
    s_add_u32 s44, s44, s73
    s_add_u32 s44, s44, 114688
    s_add_u32 m0, s40, 131072
    s_nop 0
    buffer_load_dwordx4 v11, s[16:19], s44 offen lds
    s_add_u32 m0, s40, 135168
    s_nop 0
    buffer_load_dwordx4 v12, s[20:23], s44 offen lds
    s_waitcnt vmcnt(8)
    s_barrier
    s_waitcnt vmcnt(6)
    s_barrier
    s_mul_i32 s44, s51, 229376
    s_add_u32 s44, s44, s73
    s_add_u32 m0, s40, 139264
    s_nop 0
    buffer_load_dwordx4 v11, s[16:19], s44 offen lds
    s_add_u32 m0, s40, 143360
    s_nop 0
    buffer_load_dwordx4 v12, s[20:23], s44 offen lds
    s_waitcnt vmcnt(6)
    s_barrier
    s_mul_i32 s44, s51, 229376
    s_add_u32 s44, s44, s73
    s_add_u32 s44, s44, 114688
    s_add_u32 m0, s40, 147456
    s_nop 0
    buffer_load_dwordx4 v11, s[16:19], s44 offen lds
    s_add_u32 m0, s40, 151552
    s_nop 0
    buffer_load_dwordx4 v12, s[20:23], s44 offen lds
    s_waitcnt vmcnt(6)
    s_barrier
    s_mul_i32 s44, s52, 229376
    s_add_u32 s44, s44, s73
    s_add_u32 m0, s40, 155648
    s_nop 0
    buffer_load_dwordx4 v11, s[16:19], s44 offen lds
    s_add_u32 m0, s40, 159744
    s_nop 0
    buffer_load_dwordx4 v12, s[20:23], s44 offen lds
    v_mov_b32 v28, 0
    ds_write_b32 v28, v28
    v_lshlrev_b32 v29, 2, v1
    s_lshl_b32 s4, s35, 8
    v_add_u32 v29, s4, v29
    ds_write_b32 v29, v28 offset:256
    s_waitcnt lgkmcnt(0)
    s_waitcnt vmcnt(6)
    s_barrier
    s_mul_i32 s44, s52, 229376
    s_add_u32 s44, s44, s73
    s_add_u32 s44, s44, 114688
    s_add_u32 m0, s40, 114688
    s_nop 0
    buffer_load_dwordx4 v11, s[16:19], s44 offen lds
    s_add_u32 m0, s40, 118784
    s_nop 0
    buffer_load_dwordx4 v12, s[20:23], s44 offen lds
    s_waitcnt vmcnt(6)
    s_barrier
    s_mul_i32 s44, s53, 229376
    s_add_u32 s44, s44, s73
    s_add_u32 m0, s40, 122880
    s_nop 0
    buffer_load_dwordx4 v11, s[16:19], s44 offen lds
    s_add_u32 m0, s40, 126976
    s_nop 0
    buffer_load_dwordx4 v12, s[20:23], s44 offen lds
    s_waitcnt vmcnt(6)
    s_barrier
    s_mul_i32 s44, s53, 229376
    s_add_u32 s44, s44, s73
    s_add_u32 s44, s44, 114688
    s_add_u32 m0, s40, 131072
    s_nop 0
    buffer_load_dwordx4 v11, s[16:19], s44 offen lds
    s_add_u32 m0, s40, 135168
    s_nop 0
    buffer_load_dwordx4 v12, s[20:23], s44 offen lds
    s_waitcnt vmcnt(6)
    s_barrier
    s_mul_i32 s44, s54, 229376
    s_add_u32 s44, s44, s73
    s_add_u32 m0, s40, 139264
    s_nop 0
    buffer_load_dwordx4 v11, s[16:19], s44 offen lds
    s_add_u32 m0, s40, 143360
    s_nop 0
    buffer_load_dwordx4 v12, s[20:23], s44 offen lds
    s_waitcnt vmcnt(6)
    s_barrier
    s_mul_i32 s44, s54, 229376
    s_add_u32 s44, s44, s73
    s_add_u32 s44, s44, 114688
    s_add_u32 m0, s40, 147456
    s_nop 0
    buffer_load_dwordx4 v11, s[16:19], s44 offen lds
    s_add_u32 m0, s40, 151552
    s_nop 0
    buffer_load_dwordx4 v12, s[20:23], s44 offen lds
    s_waitcnt vmcnt(6)
    s_barrier
    buffer_load_dword v21, v3, s[24:27], 0 offen sc1
    s_waitcnt vmcnt(5)
    s_barrier
    s_waitcnt vmcnt(1)
    s_getreg_b32 s4, hwreg(HW_REG_IB_STS)
    s_and_b32 s4, s4, 0xc0000f
    s_or_b32 s4, s4, s43
    s_cbranch_scc1 LDII_TRY25_SKIP
    v_cmp_ne_u32 vcc, s74, v21
    s_nop 0
    s_cmp_eq_u64 vcc, 0
    s_cbranch_scc1 LDII_TRY25_GO
    buffer_load_dword v21, v3, s[24:27], 0 offen sc1
    s_branch LDII_TRY25_SKIP
LDII_TRY25_GO:
    s_lshl_b32 s4, s37, 4
    s_add_u32 s4, s4, s38
    s_lshl_b32 s4, s4, 2
    s_add_u32 s4, s4, s35
    s_lshl_b32 s44, s4, 11
    buffer_load_dwordx4 v[32:35], v2, s[24:27], s44 offen offset:0 sc1
    buffer_load_dwordx4 v[36:39], v2, s[24:27], s44 offen offset:1024 sc1
    buffer_load_dwordx4 v[40:43], v2, s[24:27], s6 offen offset:0 sc1
    buffer_load_dwordx4 v[44:47], v2, s[24:27], s6 offen offset:1024 sc1
    s_add_u32 m0, s42, 26624
    s_lshl_b32 s44, s38, 12
    s_add_u32 s44, s44, s39
    buffer_load_dwordx4 v2, s[24:27], s44 offen offset:0 sc1 lds
    buffer_load_dwordx4 v2, s[24:27], s44 offen offset:1024 sc1 lds
    buffer_load_dwordx4 v2, s[24:27], s44 offen offset:2048 sc1 lds
    buffer_load_dwordx4 v2, s[24:27], s44 offen offset:3072 sc1 lds
    s_lshl_b32 s4, s35, 8
    s_add_u32 m0, s4, 43008
    s_lshl_b32 s44, s38, 2
    s_add_u32 s44, s44, s35
    s_lshl_b32 s44, s44, 11
    s_add_u32 s44, s44, 16777216
    buffer_load_dword v25, s[24:27], s44 offen sc1 lds
    s_mov_b32 s43, 1
LDII_TRY25_SKIP:
    s_barrier
    s_getreg_b32 s4, hwreg(HW_REG_IB_STS)
    s_and_b32 s4, s4, 0xc0000f
    s_or_b32 s4, s4, s43
    s_cbranch_scc1 LDII_TRY26_SKIP
    v_cmp_ne_u32 vcc, s74, v21
    s_nop 0
    s_cmp_eq_u64 vcc, 0
    s_cbranch_scc1 LDII_TRY26_GO
    buffer_load_dword v21, v3, s[24:27], 0 offen sc1
    s_branch LDII_TRY26_SKIP
LDII_TRY26_GO:
    s_lshl_b32 s4, s37, 4
    s_add_u32 s4, s4, s38
    s_lshl_b32 s4, s4, 2
    s_add_u32 s4, s4, s35
    s_lshl_b32 s44, s4, 11
    buffer_load_dwordx4 v[32:35], v2, s[24:27], s44 offen offset:0 sc1
    buffer_load_dwordx4 v[36:39], v2, s[24:27], s44 offen offset:1024 sc1
    buffer_load_dwordx4 v[40:43], v2, s[24:27], s6 offen offset:0 sc1
    buffer_load_dwordx4 v[44:47], v2, s[24:27], s6 offen offset:1024 sc1
    s_add_u32 m0, s42, 26624
    s_lshl_b32 s44, s38, 12
    s_add_u32 s44, s44, s39
    buffer_load_dwordx4 v2, s[24:27], s44 offen offset:0 sc1 lds
    buffer_load_dwordx4 v2, s[24:27], s44 offen offset:1024 sc1 lds
    buffer_load_dwordx4 v2, s[24:27], s44 offen offset:2048 sc1 lds
    buffer_load_dwordx4 v2, s[24:27], s44 offen offset:3072 sc1 lds
    s_lshl_b32 s4, s35, 8
    s_add_u32 m0, s4, 43008
    s_lshl_b32 s44, s38, 2
    s_add_u32 s44, s44, s35
    s_lshl_b32 s44, s44, 11
    s_add_u32 s44, s44, 16777216
    buffer_load_dword v25, s[24:27], s44 offen sc1 lds
    s_mov_b32 s43, 1
LDII_TRY26_SKIP:
    s_barrier
    s_branch ROLE_G
ROLE_G:
    s_cmp_lg_u32 s43, 0
    s_cbranch_scc1 G_STAGED
    s_mov_b32 s47, 1048576
G_POLL1:
    s_waitcnt vmcnt(0)
    v_cmp_ne_u32 vcc, s74, v21
    s_nop 0
    s_cmp_eq_u64 vcc, 0
    s_cbranch_scc1 G_POLL1_OK
    s_sleep 1
    buffer_load_dword v21, v3, s[24:27], 0 offen sc1
    s_sub_u32 s47, s47, 1
    s_cmp_lg_u32 s47, 0
    s_cbranch_scc1 G_POLL1
    s_waitcnt vmcnt(0)
G_POLL1_OK:
    s_lshl_b32 s4, s37, 4
    s_add_u32 s4, s4, s38
    s_lshl_b32 s4, s4, 2
    s_add_u32 s4, s4, s35
    s_lshl_b32 s44, s4, 11
    buffer_load_dwordx4 v[32:35], v2, s[24:27], s44 offen offset:0 sc1
    buffer_load_dwordx4 v[36:39], v2, s[24:27], s44 offen offset:1024 sc1
    buffer_load_dwordx4 v[40:43], v2, s[24:27], s6 offen offset:0 sc1
    buffer_load_dwordx4 v[44:47], v2, s[24:27], s6 offen offset:1024 sc1
    s_add_u32 m0, s42, 26624
    s_lshl_b32 s44, s38, 12
    s_add_u32 s44, s44, s39
    buffer_load_dwordx4 v2, s[24:27], s44 offen offset:0 sc1 lds
    buffer_load_dwordx4 v2, s[24:27], s44 offen offset:1024 sc1 lds
    buffer_load_dwordx4 v2, s[24:27], s44 offen offset:2048 sc1 lds
    buffer_load_dwordx4 v2, s[24:27], s44 offen offset:3072 sc1 lds
    s_lshl_b32 s4, s35, 8
    s_add_u32 m0, s4, 43008
    s_lshl_b32 s44, s38, 2
    s_add_u32 s44, s44, s35
    s_lshl_b32 s44, s44, 11
    s_add_u32 s44, s44, 16777216
    buffer_load_dword v25, s[24:27], s44 offen sc1 lds
G_STAGED:
    s_waitcnt vmcnt(5)
    v_mfma_f32_32x32x16_bf16 v[48:63], v[40:43], v[32:35], 0
    v_mfma_f32_32x32x16_bf16 v[48:63], v[44:47], v[36:39], v[48:63]
    s_lshl_b32 s5, s35, 11
    v_add_u32 v22, s5, v2
    ds_write_b128 v22, v[32:35] offset:16384
    s_mov_b32 s50, 0
    s_mov_b32 s51, -1
    s_nop 6
    v_max3_f32 v4, v48, v49, v50
    v_max3_f32 v4, v4, v51, v52
    v_max3_f32 v4, v4, v53, v54
    v_max3_f32 v4, v4, v55, v56
    v_max3_f32 v4, v4, v57, v58
    v_max3_f32 v4, v4, v59, v60
    v_max3_f32 v4, v4, v61, v62
    v_max_f32 v4, v4, v63
    v_mov_b32 v12, v4
    s_nop 1
    v_permlane32_swap_b32 v4, v12
    v_max_f32 v4, v4, v12
    v_sub_f32 v4, 0, v4
    v_cvt_pk_bf16_f32 v12, v4, v4
    v_lshlrev_b32 v12, 16, v12
    v_sub_f32 v12, v4, v12
    v_cvt_pk_bf16_f32 v13, v4, v12
    v_and_b32 v14, 0xffff0000, v13
    v_sub_f32 v14, v12, v14
    v_cvt_pk_bf16_f32 v14, v14, 0
    v_cndmask_b32 v38, v38, v13, s[50:51]
    v_cndmask_b32 v39, v39, v14, s[50:51]
    ds_write_b128 v22, v[36:39] offset:17408
    s_waitcnt lgkmcnt(0)
    s_waitcnt vmcnt(0)
    s_barrier
    s_and_b32 s4, s2, 1
    s_lshl_b32 s4, s4, 2
    s_lshr_b32 s5, s2, 6
    s_add_u32 s37, s4, s5
    s_cmp_ge_u32 s37, 7
    s_cbranch_scc1 G_DONE
    s_bfe_u32 s4, s2, 0x20001
    s_lshl_b32 s4, s4, 3
    s_bfe_u32 s5, s2, 0x30003
    s_add_u32 s36, s4, s5
    v_lshrrev_b32 v20, 3, v1
    v_bfe_u32 v21, v1, 4, 1
    v_lshlrev_b32 v21, 2, v21
    v_and_b32 v22, 7, v1
    v_xor_b32 v22, v22, v21
    v_mul_u32_u24 v20, 896, v20
    v_lshl_add_u32 v4, v22, 4, v20
    s_lshl_b32 s4, s37, 7
    v_add_u32 v4, s4, v4
    s_mul_i32 s34, s35, 24576
    s_add_u32 s34, s34, 65536
    s_mul_i32 s38, s35, 401408
    s_and_b32 s4, s36, 7
    s_mul_i32 s4, s4, 7
    s_lshr_b32 s4, s4, 1
    s_and_b32 s5, s37, 3
    s_mul_i32 s5, s5, 7
    s_add_u32 s4, s4, s5
    s_cmp_ge_u32 s4, 28
    s_cselect_b32 s5, 28, 0
    s_sub_u32 s4, s4, s5
    s_mul_i32 s48, s4, 14336
    s_lshl_b32 s49, s4, 10
    v_lshrrev_b32 v20, 5, v1
    v_bfe_u32 v21, v1, 2, 2
    v_lshl_add_u32 v20, v20, 2, v21
    v_bfe_u32 v22, v1, 4, 1
    v_and_b32 v23, 3, v1
    v_lshlrev_b32 v22, 5, v22
    v_lshl_add_u32 v22, v23, 3, v22
    v_bfe_u32 v21, v21, 1, 1
    v_lshlrev_b32 v21, 6, v21
    v_xor_b32 v22, v22, v21
    v_lshl_add_u32 v5, v20, 7, v22
    v_add_u32 v6, s34, v5
    s_and_b32 s4, s35, 1
    s_lshl_b32 s4, s4, 6
    v_xor_b32 v6, s4, v6
    v_xor_b32 v5, 64, v6
    s_mul_i32 s39, s35, 100352
    s_lshl_b32 s4, s35, 8
    v_mov_b32 v12, s4
G_PACE0:
    ds_read_b32 v13, v12 offset:256
    s_waitcnt lgkmcnt(0)
    v_readfirstlane_b32 s4, v13
    s_nop 0
    s_cmp_ge_u32 s4, 3
    s_cbranch_scc1 G_PACE0_OK
    s_sleep 4
    s_branch G_PACE0
G_PACE0_OK:
    s_add_u32 m0, s34, 0
    s_add_u32 s44, s39, 0
    buffer_load_dwordx4 v4, s[60:63], s44 offen lds
    s_add_u32 m0, s34, 1024
    s_add_u32 s44, s39, 7168
    buffer_load_dwordx4 v4, s[60:63], s44 offen lds
    s_add_u32 m0, s34, 2048
    s_add_u32 s44, s39, 14336
    buffer_load_dwordx4 v4, s[60:63], s44 offen lds
    s_add_u32 m0, s34, 3072
    s_add_u32 s44, s39, 21504
    buffer_load_dwordx4 v4, s[60:63], s44 offen lds
    s_add_u32 m0, s34, 4096
    s_add_u32 s44, s39, 28672
    buffer_load_dwordx4 v4, s[60:63], s44 offen lds
    s_add_u32 m0, s34, 5120
    s_add_u32 s44, s39, 35840
    buffer_load_dwordx4 v4, s[60:63], s44 offen lds
    s_add_u32 m0, s34, 6144
    s_add_u32 s44, s39, 43008
    buffer_load_dwordx4 v4, s[60:63], s44 offen lds
    s_add_u32 m0, s34, 7168
    s_add_u32 s44, s39, 50176
    buffer_load_dwordx4 v4, s[60:63], s44 offen lds
    s_add_u32 m0, s34, 8192
    s_add_u32 s44, s39, 57344
    buffer_load_dwordx4 v4, s[60:63], s44 offen lds
    s_add_u32 m0, s34, 9216
    s_add_u32 s44, s39, 64512
    buffer_load_dwordx4 v4, s[60:63], s44 offen lds
    s_add_u32 m0, s34, 10240
    s_add_u32 s44, s39, 71680
    buffer_load_dwordx4 v4, s[60:63], s44 offen lds
    s_add_u32 m0, s34, 11264
    s_add_u32 s44, s39, 78848
    buffer_load_dwordx4 v4, s[60:63], s44 offen lds
    s_add_u32 m0, s34, 12288
    s_add_u32 s44, s39, 86016
    buffer_load_dwordx4 v4, s[60:63], s44 offen lds
    s_add_u32 m0, s34, 13312
    s_add_u32 s44, s39, 93184
    buffer_load_dwordx4 v4, s[60:63], s44 offen lds
    s_add_u32 m0, s34, 14336
    s_add_u32 s44, s39, 100352
    buffer_load_dwordx4 v4, s[60:63], s44 offen lds
    s_add_u32 s4, s37, 0
    s_and_b32 s4, s4, 3
    s_lshl_b32 s50, s4, 11
    s_mul_i32 s4, s4, 3584
    v_add_u32 v112, s4, v5
    v_add_u32 v113, s4, v6
    s_add_u32 s4, s37, 1
    s_and_b32 s4, s4, 3
    s_lshl_b32 s51, s4, 11
    s_mul_i32 s4, s4, 3584
    v_add_u32 v114, s4, v5
    v_add_u32 v115, s4, v6
    s_add_u32 s4, s37, 2
    s_and_b32 s4, s4, 3
    s_lshl_b32 s52, s4, 11
    s_mul_i32 s4, s4, 3584
    v_add_u32 v116, s4, v5
    v_add_u32 v117, s4, v6
    s_add_u32 s4, s37, 3
    s_and_b32 s4, s4, 3
    s_lshl_b32 s53, s4, 11
    s_mul_i32 s4, s4, 3584
    v_add_u32 v118, s4, v5
    v_add_u32 v119, s4, v6
    s_waitcnt vmcnt(0)
    ds_read_b64_tr_b16 v[192:193], v112 offset:0
    ds_read_b64_tr_b16 v[194:195], v112 offset:1024
    ds_read_b64_tr_b16 v[196:197], v113 offset:0
    ds_read_b64_tr_b16 v[198:199], v113 offset:1024
    ds_read_b64_tr_b16 v[200:201], v112 offset:2048
    ds_read_b64_tr_b16 v[202:203], v112 offset:3072
    ds_read_b64_tr_b16 v[204:205], v113 offset:2048
    ds_read_b64_tr_b16 v[206:207], v113 offset:3072
    ds_read_b64_tr_b16 v[208:209], v114 offset:0
    ds_read_b64_tr_b16 v[210:211], v114 offset:1024
    ds_read_b64_tr_b16 v[212:213], v115 offset:0
    ds_read_b64_tr_b16 v[214:215], v115 offset:1024
    ds_read_b64_tr_b16 v[216:217], v114 offset:2048
    ds_read_b64_tr_b16 v[218:219], v114 offset:3072
    ds_read_b64_tr_b16 v[220:221], v115 offset:2048
    ds_read_b64_tr_b16 v[222:223], v115 offset:3072
    ds_read_b64_tr_b16 v[224:225], v116 offset:0
    ds_read_b64_tr_b16 v[226:227], v116 offset:1024
    ds_read_b64_tr_b16 v[228:229], v117 offset:0
    ds_read_b64_tr_b16 v[230:231], v117 offset:1024
    ds_read_b64_tr_b16 v[232:233], v116 offset:2048
    ds_read_b64_tr_b16 v[234:235], v116 offset:3072
    ds_read_b64_tr_b16 v[236:237], v117 offset:2048
    ds_read_b64_tr_b16 v[238:239], v117 offset:3072
    ds_read_b64_tr_b16 v[240:241], v118 offset:0
    ds_read_b64_tr_b16 v[242:243], v118 offset:1024
    ds_read_b64_tr_b16 v[244:245], v119 offset:0
    ds_read_b64_tr_b16 v[246:247], v119 offset:1024
    ds_read_b64_tr_b16 v[248:249], v118 offset:2048
    ds_read_b64_tr_b16 v[250:251], v118 offset:3072
    ds_read_b64_tr_b16 v[252:253], v119 offset:2048
    ds_read_b64_tr_b16 v[254:255], v119 offset:3072
    s_waitcnt lgkmcnt(0)
    s_lshl_b32 s4, s35, 8
    v_mov_b32 v12, s4
G_PACE1:
    ds_read_b32 v13, v12 offset:256
    s_waitcnt lgkmcnt(0)
    v_readfirstlane_b32 s4, v13
    s_nop 0
    s_cmp_ge_u32 s4, 4
    s_cbranch_scc1 G_PACE1_OK
    s_sleep 4
    s_branch G_PACE1
G_PACE1_OK:
    s_add_u32 m0, s34, 0
    s_add_u32 s44, s38, s48
    buffer_load_dwordx4 v4, s[56:59], s44 offen lds
    s_add_u32 m0, s34, 1024
    s_add_u32 s44, s44, 7168
    buffer_load_dwordx4 v4, s[56:59], s44 offen lds
    s_add_u32 s48, s48, 14336
    s_cmp_eq_u32 s48, 401408
    s_cselect_b32 s48, 0, s48
    s_add_u32 m0, s34, 2048
    s_add_u32 s44, s38, s48
    buffer_load_dwordx4 v4, s[56:59], s44 offen lds
    s_add_u32 m0, s34, 3072
    s_add_u32 s44, s44, 7168
    buffer_load_dwordx4 v4, s[56:59], s44 offen lds
    s_add_u32 s48, s48, 14336
    s_cmp_eq_u32 s48, 401408
    s_cselect_b32 s48, 0, s48
    s_add_u32 m0, s34, 4096
    s_add_u32 s44, s38, s48
    buffer_load_dwordx4 v4, s[56:59], s44 offen lds
    s_add_u32 m0, s34, 5120
    s_add_u32 s44, s44, 7168
    buffer_load_dwordx4 v4, s[56:59], s44 offen lds
    s_add_u32 s48, s48, 14336
    s_cmp_eq_u32 s48, 401408
    s_cselect_b32 s48, 0, s48
    s_lshl_b32 s4, s35, 8
    v_mov_b32 v12, s4
G_PA1:
    ds_read_b32 v13, v12 offset:256
    s_waitcnt lgkmcnt(0)
    v_readfirstlane_b32 s4, v13
    s_nop 0
    s_cmp_ge_u32 s4, 5
    s_cbranch_scc1 G_PA1_OK
    s_sleep 4
    s_branch G_PA1
G_PA1_OK:
    s_add_u32 m0, s34, 6144
    s_add_u32 s44, s38, s48
    buffer_load_dwordx4 v4, s[56:59], s44 offen lds
    s_add_u32 m0, s34, 7168
    s_add_u32 s44, s44, 7168
    buffer_load_dwordx4 v4, s[56:59], s44 offen lds
    s_add_u32 s48, s48, 14336
    s_cmp_eq_u32 s48, 401408
    s_cselect_b32 s48, 0, s48
    s_add_u32 m0, s34, 8192
    s_add_u32 s44, s38, s48
    buffer_load_dwordx4 v4, s[56:59], s44 offen lds
    s_add_u32 m0, s34, 9216
    s_add_u32 s44, s44, 7168
    buffer_load_dwordx4 v4, s[56:59], s44 offen lds
    s_add_u32 s48, s48, 14336
    s_cmp_eq_u32 s48, 401408
    s_cselect_b32 s48, 0, s48
    s_add_u32 m0, s34, 10240
    s_add_u32 s44, s38, s48
    buffer_load_dwordx4 v4, s[56:59], s44 offen lds
    s_add_u32 m0, s34, 11264
    s_add_u32 s44, s44, 7168
    buffer_load_dwordx4 v4, s[56:59], s44 offen lds
    s_add_u32 s48, s48, 14336
    s_cmp_eq_u32 s48, 401408
    s_cselect_b32 s48, 0, s48
    s_lshl_b32 s4, s35, 8
    v_mov_b32 v12, s4
G_PA2:
    ds_read_b32 v13, v12 offset:256
    s_waitcnt lgkmcnt(0)
    v_readfirstlane_b32 s4, v13
    s_nop 0
    s_cmp_ge_u32 s4, 6
    s_cbranch_scc1 G_PA2_OK
    s_sleep 4
    s_branch G_PA2
G_PA2_OK:
    s_add_u32 m0, s34, 12288
    s_add_u32 s44, s38, s48
    buffer_load_dwordx4 v4, s[56:59], s44 offen lds
    s_add_u32 m0, s34, 13312
    s_add_u32 s44, s44, 7168
    buffer_load_dwordx4 v4, s[56:59], s44 offen lds
    s_add_u32 s48, s48, 14336
    s_cmp_eq_u32 s48, 401408
    s_cselect_b32 s48, 0, s48
    s_add_u32 m0, s34, 14336
    s_add_u32 s44, s38, s48
    buffer_load_dwordx4 v4, s[56:59], s44 offen lds
    s_add_u32 m0, s34, 15360
    s_add_u32 s44, s44, 7168
    buffer_load_dwordx4 v4, s[56:59], s44 offen lds
    s_add_u32 s48, s48, 14336
    s_cmp_eq_u32 s48, 401408
    s_cselect_b32 s48, 0, s48
    s_add_u32 m0, s34, 16384
    s_add_u32 s44, s38, s48
    buffer_load_dwordx4 v4, s[56:59], s44 offen lds
    s_add_u32 m0, s34, 17408
    s_add_u32 s44, s44, 7168
    buffer_load_dwordx4 v4, s[56:59], s44 offen lds
    s_add_u32 s48, s48, 14336
    s_cmp_eq_u32 s48, 401408
    s_cselect_b32 s48, 0, s48
    s_lshl_b32 s4, s35, 8
    v_mov_b32 v12, s4
G_PA3:
    ds_read_b32 v13, v12 offset:256
    s_waitcnt lgkmcnt(0)
    v_readfirstlane_b32 s4, v13
    s_nop 0
    s_cmp_ge_u32 s4, 7
    s_cbranch_scc1 G_PA3_OK
    s_sleep 4
    s_branch G_PA3
G_PA3_OK:
    s_add_u32 m0, s34, 18432
    s_add_u32 s44, s38, s48
    buffer_load_dwordx4 v4, s[56:59], s44 offen lds
    s_add_u32 m0, s34, 19456
    s_add_u32 s44, s44, 7168
    buffer_load_dwordx4 v4, s[56:59], s44 offen lds
    s_add_u32 s48, s48, 14336
    s_cmp_eq_u32 s48, 401408
    s_cselect_b32 s48, 0, s48
    s_add_u32 m0, s34, 20480
    s_add_u32 s44, s38, s48
    buffer_load_dwordx4 v4, s[56:59], s44 offen lds
    s_add_u32 m0, s34, 21504
    s_add_u32 s44, s44, 7168
    buffer_load_dwordx4 v4, s[56:59], s44 offen lds
    s_add_u32 s48, s48, 14336
    s_cmp_eq_u32 s48, 401408
    s_cselect_b32 s48, 0, s48
    s_mul_i32 s40, s36, 229376
    s_mul_i32 s4, s35, 28672
    s_add_u32 s40, s40, s4
    s_add_u32 s40, s40, 6291456
    s_lshl_b32 s41, s36, 16
    s_lshl_b32 s4, s35, 13
    s_add_u32 s41, s41, s4
    s_add_u32 s41, s41, 14680064
    s_lshl_b32 s43, s36, 12
    s_add_u32 s43, s43, 16777216
    s_cmp_lt_u32 s35, 2
    s_cselect_b32 s54, 114688, 0
    s_cselect_b32 s55, 32768, 0
    s_cselect_b32 s46, 2048, 0
    s_add_u32 s40, s40, s54
    s_add_u32 s41, s41, s55
    s_add_u32 s7, s43, 2048
    s_sub_u32 s7, s7, s46
    s_add_u32 s43, s43, s46
    s_cmp_lt_u32 s35, 2
    s_cselect_b32 s54, 4294852608, s54
    s_cselect_b32 s55, 4294934528, s55
    s_cmp_ge_u32 s35, 2
    s_cselect_b32 s54, 114688, s54
    s_cselect_b32 s55, 32768, s55
    v_bfe_u32 v7, v1, 1, 4
    v_and_b32 v12, 1, v1
    v_lshl_add_u32 v7, v7, 2, v12
    s_lshr_b32 s4, s36, 1
    s_lshl_b32 s4, s4, 6
    s_and_b32 s5, s36, 1
    s_lshl_b32 s5, s5, 1
    s_add_u32 s4, s4, s5
    v_add_u32 v7, s4, v7
    v_lshlrev_b32 v7, 7, v7
    v_add_u32 v7, 17235968, v7
    s_lshl_b32 s4, s36, 12
    s_add_u32 s4, s4, 16773128
    v_lshlrev_b32 v12, 7, v1
    v_add_u32 v12, s4, v12
    s_mov_b32 s4, 0
    s_mov_b32 s5, -1
    v_cndmask_b32 v7, v7, v12, s[4:5]
    s_mov_b32 s42, 0
    v_and_b32 v11, 31, v1
    v_lshlrev_b32 v11, 7, v11
    s_lshl_b32 s4, s36, 12
    s_add_u32 s4, s4, 17367040
    v_add_u32 v11, s4, v11
    s_mov_b32 s47, 1048576
G_POLL2:
    buffer_load_dword v12, v7, s[24:27], s42 offen offset:0 sc1
    s_waitcnt vmcnt(0)
    v_cmp_ne_u32 vcc, s74, v12
    s_nop 0
    s_cmp_eq_u64 vcc, 0
    s_cbranch_scc1 G_POLL2_OK
    s_sleep 2
    s_sub_u32 s47, s47, 1
    s_cmp_lg_u32 s47, 0
    s_cbranch_scc1 G_POLL2
G_POLL2_OK:
    v_and_b32 v3, 31, v1
    v_lshrrev_b32 v10, 1, v3
    v_lshlrev_b32 v10, 7, v10
    v_and_b32 v12, 1, v3
    v_lshl_add_u32 v10, v12, 2, v10
    s_add_u32 s44, s40, s49
    buffer_load_dwordx4 v[32:35], v2, s[24:27], s44 offen sc1
    s_add_u32 s44, s44, s54
    buffer_load_dwordx4 v[36:39], v2, s[24:27], s44 offen sc1
    s_add_u32 s49, s49, 1024
    s_cmp_eq_u32 s49, 28672
    s_cselect_b32 s49, 0, s49
    s_add_u32 s44, s40, s49
    buffer_load_dwordx4 v[40:43], v2, s[24:27], s44 offen sc1
    s_add_u32 s44, s44, s54
    buffer_load_dwordx4 v[44:47], v2, s[24:27], s44 offen sc1
    s_add_u32 s49, s49, 1024
    s_cmp_eq_u32 s49, 28672
    s_cselect_b32 s49, 0, s49
    s_add_u32 s44, s40, s49
    buffer_load_dwordx4 v[48:51], v2, s[24:27], s44 offen sc1
    s_add_u32 s44, s44, s54
    buffer_load_dwordx4 v[52:55], v2, s[24:27], s44 offen sc1
    s_add_u32 s49, s49, 1024
    s_cmp_eq_u32 s49, 28672
    s_cselect_b32 s49, 0, s49
    s_lshl_b32 s4, s35, 8
    v_mov_b32 v12, s4
G_PB1:
    ds_read_b32 v13, v12 offset:256
    s_waitcnt lgkmcnt(0)
    v_readfirstlane_b32 s4, v13
    s_nop 0
    s_cmp_ge_u32 s4, 9
    s_cbranch_scc1 G_PB1_OK
    s_sleep 4
    s_branch G_PB1
G_PB1_OK:
    s_add_u32 s44, s40, s49
    buffer_load_dwordx4 v[56:59], v2, s[24:27], s44 offen sc1
    s_add_u32 s44, s44, s54
    buffer_load_dwordx4 v[60:63], v2, s[24:27], s44 offen sc1
    s_add_u32 s49, s49, 1024
    s_cmp_eq_u32 s49, 28672
    s_cselect_b32 s49, 0, s49
    s_add_u32 s44, s40, s49
    buffer_load_dwordx4 v[64:67], v2, s[24:27], s44 offen sc1
    s_add_u32 s44, s44, s54
    buffer_load_dwordx4 v[68:71], v2, s[24:27], s44 offen sc1
    s_add_u32 s49, s49, 1024
    s_cmp_eq_u32 s49, 28672
    s_cselect_b32 s49, 0, s49
    s_add_u32 s44, s40, s49
    buffer_load_dwordx4 v[72:75], v2, s[24:27], s44 offen sc1
    s_add_u32 s44, s44, s54
    buffer_load_dwordx4 v[76:79], v2, s[24:27], s44 offen sc1
    s_add_u32 s49, s49, 1024
    s_cmp_eq_u32 s49, 28672
    s_cselect_b32 s49, 0, s49
    s_lshl_b32 s4, s35, 8
    v_mov_b32 v12, s4
G_PB2:
    ds_read_b32 v13, v12 offset:256
    s_waitcnt lgkmcnt(0)
    v_readfirstlane_b32 s4, v13
    s_nop 0
    s_cmp_ge_u32 s4, 10
    s_cbranch_scc1 G_PB2_OK
    s_sleep 4
    s_branch G_PB2
G_PB2_OK:
    s_add_u32 s44, s40, s49
    buffer_load_dwordx4 v[80:83], v2, s[24:27], s44 offen sc1
    s_add_u32 s44, s44, s54
    buffer_load_dwordx4 v[84:87], v2, s[24:27], s44 offen sc1
    s_add_u32 s49, s49, 1024
    s_cmp_eq_u32 s49, 28672
    s_cselect_b32 s49, 0, s49
    s_add_u32 s44, s40, s49
    buffer_load_dwordx4 v[88:91], v2, s[24:27], s44 offen sc1
    s_add_u32 s44, s44, s54
    buffer_load_dwordx4 v[92:95], v2, s[24:27], s44 offen sc1
    s_add_u32 s49, s49, 1024
    s_cmp_eq_u32 s49, 28672
    s_cselect_b32 s49, 0, s49
    s_add_u32 s44, s40, s49
    buffer_load_dwordx4 v[112:115], v2, s[24:27], s44 offen sc1
    s_add_u32 s44, s44, s54
    buffer_load_dwordx4 v[116:119], v2, s[24:27], s44 offen sc1
    s_add_u32 s49, s49, 1024
    s_cmp_eq_u32 s49, 28672
    s_cselect_b32 s49, 0, s49
    buffer_load_dword v8, v10, s[24:27], s7 offen offset:16 sc1
    s_add_u32 s55, s41, s55
    v_add_u32 v10, s34, v2
    s_xor_b32 s4, s35, 1
    s_mul_i32 s4, s4, 24576
    s_add_u32 s4, s4, 73728
    v_add_u32 v16, s4, v2
    s_xor_b32 s4, s35, 2
    s_mul_i32 s4, s4, 24576
    s_add_u32 s4, s4, 69632
    v_add_u32 v17, s4, v2
    s_xor_b32 s4, s35, 3
    s_mul_i32 s4, s4, 24576
    s_add_u32 s4, s4, 65536
    v_add_u32 v18, s4, v2
    v_mul_u32_u24 v15, 896, v3
    v_lshrrev_b32 v19, 5, v1
    v_lshl_add_u32 v15, v19, 4, v15
    s_lshl_b32 s4, s36, 1
    s_lshr_b32 s5, s35, 1
    s_add_u32 s4, s4, s5
    s_mul_i32 s6, s4, 28672
    s_lshl_b32 s4, s37, 1
    s_and_b32 s5, s35, 1
    s_add_u32 s4, s4, s5
    s_lshl_b32 s4, s4, 6
    s_add_u32 s6, s6, s4
    ds_read_b64_tr_b16 v[96:97], v5 offset:0
    ds_read_b64_tr_b16 v[98:99], v5 offset:1024
    ds_read_b64_tr_b16 v[100:101], v6 offset:0
    ds_read_b64_tr_b16 v[102:103], v6 offset:1024
    s_lshl_b32 s4, s35, 8
    v_mov_b32 v12, s4
G_PACE:
    ds_read_b32 v13, v12 offset:256
    s_waitcnt lgkmcnt(0)
    v_readfirstlane_b32 s4, v13
    s_nop 0
    s_cmp_ge_u32 s4, 14
    s_cbranch_scc1 G_PACE_OK
    s_sleep 4
    s_branch G_PACE
G_PACE_OK:
    s_add_u32 m0, s34, 22528
    s_add_u32 s44, s38, s48
    buffer_load_dwordx4 v4, s[56:59], s44 offen lds
    s_add_u32 m0, s34, 23552
    s_add_u32 s44, s44, 7168
    buffer_load_dwordx4 v4, s[56:59], s44 offen lds
    s_add_u32 s48, s48, 14336
    s_cmp_eq_u32 s48, 401408
    s_cselect_b32 s48, 0, s48
    s_add_u32 s44, s40, s49
    buffer_load_dwordx4 v[120:123], v2, s[24:27], s44 offen sc1
    s_add_u32 s44, s44, s54
    buffer_load_dwordx4 v[124:127], v2, s[24:27], s44 offen sc1
    s_add_u32 s49, s49, 1024
    s_cmp_eq_u32 s49, 28672
    s_cselect_b32 s49, 0, s49
    s_waitcnt vmcnt(21)
    s_waitcnt lgkmcnt(0)
    ds_read_b64_tr_b16 v[104:105], v5 offset:2048
    ds_read_b64_tr_b16 v[106:107], v5 offset:3072
    ds_read_b64_tr_b16 v[108:109], v6 offset:2048
    ds_read_b64_tr_b16 v[110:111], v6 offset:3072
    v_mfma_f32_32x32x16_bf16 v[128:143], v[96:99], v[32:35], 0
    v_mfma_f32_32x32x16_bf16 v[144:159], v[96:99], v[36:39], 0
    v_mfma_f32_32x32x16_bf16 v[160:175], v[100:103], v[32:35], 0
    v_mfma_f32_32x32x16_bf16 v[176:191], v[100:103], v[36:39], 0
    s_add_u32 s44, s40, s49
    buffer_load_dwordx4 v[32:35], v2, s[24:27], s44 offen sc1
    s_add_u32 s44, s44, s54
    buffer_load_dwordx4 v[36:39], v2, s[24:27], s44 offen sc1
    s_add_u32 s49, s49, 1024
    s_cmp_eq_u32 s49, 28672
    s_cselect_b32 s49, 0, s49
    s_waitcnt vmcnt(21)
    s_waitcnt lgkmcnt(0)
    ds_read_b64_tr_b16 v[96:97], v5 offset:4096
    ds_read_b64_tr_b16 v[98:99], v5 offset:5120
    ds_read_b64_tr_b16 v[100:101], v6 offset:4096
    ds_read_b64_tr_b16 v[102:103], v6 offset:5120
    v_mfma_f32_32x32x16_bf16 v[128:143], v[104:107], v[40:43], v[128:143]
    v_mfma_f32_32x32x16_bf16 v[144:159], v[104:107], v[44:47], v[144:159]
    v_mfma_f32_32x32x16_bf16 v[160:175], v[108:111], v[40:43], v[160:175]
    v_mfma_f32_32x32x16_bf16 v[176:191], v[108:111], v[44:47], v[176:191]
    s_add_u32 m0, s34, 0
    s_add_u32 s44, s38, s48
    buffer_load_dwordx4 v4, s[56:59], s44 offen lds
    s_add_u32 m0, s34, 1024
    s_add_u32 s44, s44, 7168
    buffer_load_dwordx4 v4, s[56:59], s44 offen lds
    s_add_u32 s48, s48, 14336
    s_cmp_eq_u32 s48, 401408
    s_cselect_b32 s48, 0, s48
    s_add_u32 s44, s40, s49
    buffer_load_dwordx4 v[40:43], v2, s[24:27], s44 offen sc1
    s_add_u32 s44, s44, s54
    buffer_load_dwordx4 v[44:47], v2, s[24:27], s44 offen sc1
    s_add_u32 s49, s49, 1024
    s_cmp_eq_u32 s49, 28672
    s_cselect_b32 s49, 0, s49
    s_waitcnt vmcnt(23)
    s_waitcnt lgkmcnt(0)
    ds_read_b64_tr_b16 v[104:105], v5 offset:6144
    ds_read_b64_tr_b16 v[106:107], v5 offset:7168
    ds_read_b64_tr_b16 v[108:109], v6 offset:6144
    ds_read_b64_tr_b16 v[110:111], v6 offset:7168
    v_mfma_f32_32x32x16_bf16 v[128:143], v[96:99], v[48:51], v[128:143]
    v_mfma_f32_32x32x16_bf16 v[144:159], v[96:99], v[52:55], v[144:159]
    v_mfma_f32_32x32x16_bf16 v[160:175], v[100:103], v[48:51], v[160:175]
    v_mfma_f32_32x32x16_bf16 v[176:191], v[100:103], v[52:55], v[176:191]
    s_add_u32 m0, s34, 2048
    s_add_u32 s44, s38, s48
    buffer_load_dwordx4 v4, s[56:59], s44 offen lds
    s_add_u32 m0, s34, 3072
    s_add_u32 s44, s44, 7168
    buffer_load_dwordx4 v4, s[56:59], s44 offen lds
    s_add_u32 s48, s48, 14336
    s_cmp_eq_u32 s48, 401408
    s_cselect_b32 s48, 0, s48
    s_add_u32 s44, s40, s49
    buffer_load_dwordx4 v[48:51], v2, s[24:27], s44 offen sc1
    s_add_u32 s44, s44, s54
    buffer_load_dwordx4 v[52:55], v2, s[24:27], s44 offen sc1
    s_add_u32 s49, s49, 1024
    s_cmp_eq_u32 s49, 28672
    s_cselect_b32 s49, 0, s49
    s_waitcnt vmcnt(25)
    s_waitcnt lgkmcnt(0)
    ds_read_b64_tr_b16 v[96:97], v5 offset:8192
    ds_read_b64_tr_b16 v[98:99], v5 offset:9216
    ds_read_b64_tr_b16 v[100:101], v6 offset:8192
    ds_read_b64_tr_b16 v[102:103], v6 offset:9216
    v_mfma_f32_32x32x16_bf16 v[128:143], v[104:107], v[56:59], v[128:143]
    v_mfma_f32_32x32x16_bf16 v[144:159], v[104:107], v[60:63], v[144:159]
    v_mfma_f32_32x32x16_bf16 v[160:175], v[108:111], v[56:59], v[160:175]
    v_mfma_f32_32x32x16_bf16 v[176:191], v[108:111], v[60:63], v[176:191]
    s_add_u32 m0, s34, 4096
    s_add_u32 s44, s38, s48
    buffer_load_dwordx4 v4, s[56:59], s44 offen lds
    s_add_u32 m0, s34, 5120
    s_add_u32 s44, s44, 7168
    buffer_load_dwordx4 v4, s[56:59], s44 offen lds
    s_add_u32 s48, s48, 14336
    s_cmp_eq_u32 s48, 401408
    s_cselect_b32 s48, 0, s48
    s_waitcnt vmcnt(25)
    s_waitcnt lgkmcnt(0)
    ds_read_b64_tr_b16 v[104:105], v5 offset:10240
    ds_read_b64_tr_b16 v[106:107], v5 offset:11264
    ds_read_b64_tr_b16 v[108:109], v6 offset:10240
    ds_read_b64_tr_b16 v[110:111], v6 offset:11264
    v_mfma_f32_32x32x16_bf16 v[128:143], v[96:99], v[64:67], v[128:143]
    v_mfma_f32_32x32x16_bf16 v[144:159], v[96:99], v[68:71], v[144:159]
    v_mfma_f32_32x32x16_bf16 v[160:175], v[100:103], v[64:67], v[160:175]
    v_mfma_f32_32x32x16_bf16 v[176:191], v[100:103], v[68:71], v[176:191]
    s_add_u32 s44, s40, s49
    buffer_load_dwordx4 v[56:59], v2, s[24:27], s44 offen sc1
    s_add_u32 s44, s44, s54
    buffer_load_dwordx4 v[60:63], v2, s[24:27], s44 offen sc1
    s_add_u32 s49, s49, 1024
    s_cmp_eq_u32 s49, 28672
    s_cselect_b32 s49, 0, s49
    s_waitcnt vmcnt(25)
    s_waitcnt lgkmcnt(0)
    ds_read_b64_tr_b16 v[96:97], v5 offset:12288
    ds_read_b64_tr_b16 v[98:99], v5 offset:13312
    ds_read_b64_tr_b16 v[100:101], v6 offset:12288
    ds_read_b64_tr_b16 v[102:103], v6 offset:13312
    v_mfma_f32_32x32x16_bf16 v[128:143], v[104:107], v[72:75], v[128:143]
    v_mfma_f32_32x32x16_bf16 v[144:159], v[104:107], v[76:79], v[144:159]
    v_mfma_f32_32x32x16_bf16 v[160:175], v[108:111], v[72:75], v[160:175]
    v_mfma_f32_32x32x16_bf16 v[176:191], v[108:111], v[76:79], v[176:191]
    s_add_u32 m0, s34, 6144
    s_add_u32 s44, s38, s48
    buffer_load_dwordx4 v4, s[56:59], s44 offen lds
    s_add_u32 m0, s34, 7168
    s_add_u32 s44, s44, 7168
    buffer_load_dwordx4 v4, s[56:59], s44 offen lds
    s_add_u32 s48, s48, 14336
    s_cmp_eq_u32 s48, 401408
    s_cselect_b32 s48, 0, s48
    s_add_u32 s44, s40, s49
    buffer_load_dwordx4 v[64:67], v2, s[24:27], s44 offen sc1
    s_add_u32 s44, s44, s54
    buffer_load_dwordx4 v[68:71], v2, s[24:27], s44 offen sc1
    s_add_u32 s49, s49, 1024
    s_cmp_eq_u32 s49, 28672
    s_cselect_b32 s49, 0, s49
    s_waitcnt vmcnt(27)
    s_waitcnt lgkmcnt(0)
    ds_read_b64_tr_b16 v[104:105], v5 offset:14336
    ds_read_b64_tr_b16 v[106:107], v5 offset:15360
    ds_read_b64_tr_b16 v[108:109], v6 offset:14336
    ds_read_b64_tr_b16 v[110:111], v6 offset:15360
    v_mfma_f32_32x32x16_bf16 v[128:143], v[96:99], v[80:83], v[128:143]
    v_mfma_f32_32x32x16_bf16 v[144:159], v[96:99], v[84:87], v[144:159]
    v_mfma_f32_32x32x16_bf16 v[160:175], v[100:103], v[80:83], v[160:175]
    v_mfma_f32_32x32x16_bf16 v[176:191], v[100:103], v[84:87], v[176:191]
    s_add_u32 m0, s34, 8192
    s_add_u32 s44, s38, s48
    buffer_load_dwordx4 v4, s[56:59], s44 offen lds
    s_add_u32 m0, s34, 9216
    s_add_u32 s44, s44, 7168
    buffer_load_dwordx4 v4, s[56:59], s44 offen lds
    s_add_u32 s48, s48, 14336
    s_cmp_eq_u32 s48, 401408
    s_cselect_b32 s48, 0, s48
    s_add_u32 s44, s40, s49
    buffer_load_dwordx4 v[72:75], v2, s[24:27], s44 offen sc1
    s_add_u32 s44, s44, s54
    buffer_load_dwordx4 v[76:79], v2, s[24:27], s44 offen sc1
    s_add_u32 s49, s49, 1024
    s_cmp_eq_u32 s49, 28672
    s_cselect_b32 s49, 0, s49
    s_waitcnt vmcnt(29)
    s_waitcnt lgkmcnt(0)
    ds_read_b64_tr_b16 v[96:97], v5 offset:16384
    ds_read_b64_tr_b16 v[98:99], v5 offset:17408
    ds_read_b64_tr_b16 v[100:101], v6 offset:16384
    ds_read_b64_tr_b16 v[102:103], v6 offset:17408
    v_mfma_f32_32x32x16_bf16 v[128:143], v[104:107], v[88:91], v[128:143]
    v_mfma_f32_32x32x16_bf16 v[144:159], v[104:107], v[92:95], v[144:159]
    v_mfma_f32_32x32x16_bf16 v[160:175], v[108:111], v[88:91], v[160:175]
    v_mfma_f32_32x32x16_bf16 v[176:191], v[108:111], v[92:95], v[176:191]
    s_add_u32 s44, s40, s49
    buffer_load_dwordx4 v[80:83], v2, s[24:27], s44 offen sc1
    s_add_u32 s44, s44, s54
    buffer_load_dwordx4 v[84:87], v2, s[24:27], s44 offen sc1
    s_add_u32 s49, s49, 1024
    s_cmp_eq_u32 s49, 28672
    s_cselect_b32 s49, 0, s49
    s_waitcnt vmcnt(29)
    s_waitcnt lgkmcnt(0)
    ds_read_b64_tr_b16 v[104:105], v5 offset:18432
    ds_read_b64_tr_b16 v[106:107], v5 offset:19456
    ds_read_b64_tr_b16 v[108:109], v6 offset:18432
    ds_read_b64_tr_b16 v[110:111], v6 offset:19456
    v_mfma_f32_32x32x16_bf16 v[128:143], v[96:99], v[112:115], v[128:143]
    v_mfma_f32_32x32x16_bf16 v[144:159], v[96:99], v[116:119], v[144:159]
    v_mfma_f32_32x32x16_bf16 v[160:175], v[100:103], v[112:115], v[160:175]
    v_mfma_f32_32x32x16_bf16 v[176:191], v[100:103], v[116:119], v[176:191]
    s_add_u32 m0, s34, 10240
    s_add_u32 s44, s38, s48
    buffer_load_dwordx4 v4, s[56:59], s44 offen lds
    s_add_u32 m0, s34, 11264
    s_add_u32 s44, s44, 7168
    buffer_load_dwordx4 v4, s[56:59], s44 offen lds
    s_add_u32 s48, s48, 14336
    s_cmp_eq_u32 s48, 401408
    s_cselect_b32 s48, 0, s48
    s_waitcnt vmcnt(26)
    s_waitcnt lgkmcnt(0)
    ds_read_b64_tr_b16 v[96:97], v5 offset:20480
    ds_read_b64_tr_b16 v[98:99], v5 offset:21504
    ds_read_b64_tr_b16 v[100:101], v6 offset:20480
    ds_read_b64_tr_b16 v[102:103], v6 offset:21504
    v_mfma_f32_32x32x16_bf16 v[128:143], v[104:107], v[120:123], v[128:143]
    v_mfma_f32_32x32x16_bf16 v[144:159], v[104:107], v[124:127], v[144:159]
    v_mfma_f32_32x32x16_bf16 v[160:175], v[108:111], v[120:123], v[160:175]
    v_mfma_f32_32x32x16_bf16 v[176:191], v[108:111], v[124:127], v[176:191]
    s_add_u32 m0, s34, 12288
    s_add_u32 s44, s38, s48
    buffer_load_dwordx4 v4, s[56:59], s44 offen lds
    s_add_u32 m0, s34, 13312
    s_add_u32 s44, s44, 7168
    buffer_load_dwordx4 v4, s[56:59], s44 offen lds
    s_add_u32 s48, s48, 14336
    s_cmp_eq_u32 s48, 401408
    s_cselect_b32 s48, 0, s48
    s_add_u32 s44, s40, s49
    buffer_load_dwordx4 v[88:91], v2, s[24:27], s44 offen sc1
    s_add_u32 s44, s44, s54
    buffer_load_dwordx4 v[92:95], v2, s[24:27], s44 offen sc1
    s_add_u32 s49, s49, 1024
    s_cmp_eq_u32 s49, 28672
    s_cselect_b32 s49, 0, s49
    s_waitcnt vmcnt(28)
    s_waitcnt lgkmcnt(0)
    ds_read_b64_tr_b16 v[104:105], v5 offset:22528
    ds_read_b64_tr_b16 v[106:107], v5 offset:23552
    ds_read_b64_tr_b16 v[108:109], v6 offset:22528
    ds_read_b64_tr_b16 v[110:111], v6 offset:23552
    v_mfma_f32_32x32x16_bf16 v[128:143], v[96:99], v[32:35], v[128:143]
    v_mfma_f32_32x32x16_bf16 v[144:159], v[96:99], v[36:39], v[144:159]
    v_mfma_f32_32x32x16_bf16 v[160:175], v[100:103], v[32:35], v[160:175]
    v_mfma_f32_32x32x16_bf16 v[176:191], v[100:103], v[36:39], v[176:191]
    s_add_u32 m0, s34, 14336
    s_add_u32 s44, s38, s48
    buffer_load_dwordx4 v4, s[56:59], s44 offen lds
    s_add_u32 m0, s34, 15360
    s_add_u32 s44, s44, 7168
    buffer_load_dwordx4 v4, s[56:59], s44 offen lds
    s_add_u32 s48, s48, 14336
    s_cmp_eq_u32 s48, 401408
    s_cselect_b32 s48, 0, s48
    s_add_u32 s44, s40, s49
    buffer_load_dwordx4 v[112:115], v2, s[24:27], s44 offen sc1
    s_add_u32 s44, s44, s54
    buffer_load_dwordx4 v[116:119], v2, s[24:27], s44 offen sc1
    s_add_u32 s49, s49, 1024
    s_cmp_eq_u32 s49, 28672
    s_cselect_b32 s49, 0, s49
    s_waitcnt vmcnt(28)
    s_waitcnt lgkmcnt(0)
    ds_read_b64_tr_b16 v[96:97], v5 offset:0
    ds_read_b64_tr_b16 v[98:99], v5 offset:1024
    ds_read_b64_tr_b16 v[100:101], v6 offset:0
    ds_read_b64_tr_b16 v[102:103], v6 offset:1024
    v_mfma_f32_32x32x16_bf16 v[128:143], v[104:107], v[40:43], v[128:143]
    v_mfma_f32_32x32x16_bf16 v[144:159], v[104:107], v[44:47], v[144:159]
    v_mfma_f32_32x32x16_bf16 v[160:175], v[108:111], v[40:43], v[160:175]
    v_mfma_f32_32x32x16_bf16 v[176:191], v[108:111], v[44:47], v[176:191]
    s_add_u32 s44, s40, s49
    buffer_load_dwordx4 v[120:123], v2, s[24:27], s44 offen sc1
    s_add_u32 s44, s44, s54
    buffer_load_dwordx4 v[124:127], v2, s[24:27], s44 offen sc1
    s_add_u32 s49, s49, 1024
    s_cmp_eq_u32 s49, 28672
    s_cselect_b32 s49, 0, s49
    s_waitcnt vmcnt(26)
    s_waitcnt lgkmcnt(0)
    ds_read_b64_tr_b16 v[104:105], v5 offset:2048
    ds_read_b64_tr_b16 v[106:107], v5 offset:3072
    ds_read_b64_tr_b16 v[108:109], v6 offset:2048
    ds_read_b64_tr_b16 v[110:111], v6 offset:3072
    v_mfma_f32_32x32x16_bf16 v[128:143], v[96:99], v[48:51], v[128:143]
    v_mfma_f32_32x32x16_bf16 v[144:159], v[96:99], v[52:55], v[144:159]
    v_mfma_f32_32x32x16_bf16 v[160:175], v[100:103], v[48:51], v[160:175]
    v_mfma_f32_32x32x16_bf16 v[176:191], v[100:103], v[52:55], v[176:191]
    s_add_u32 m0, s34, 16384
    s_add_u32 s44, s38, s48
    buffer_load_dwordx4 v4, s[56:59], s44 offen lds
    s_add_u32 m0, s34, 17408
    s_add_u32 s44, s44, 7168
    buffer_load_dwordx4 v4, s[56:59], s44 offen lds
    s_add_u32 s48, s48, 14336
    s_cmp_eq_u32 s48, 401408
    s_cselect_b32 s48, 0, s48
    s_add_u32 s44, s40, s49
    buffer_load_dwordx4 v[32:35], v2, s[24:27], s44 offen sc1
    s_add_u32 s44, s44, s54
    buffer_load_dwordx4 v[36:39], v2, s[24:27], s44 offen sc1
    s_add_u32 s49, s49, 1024
    s_cmp_eq_u32 s49, 28672
    s_cselect_b32 s49, 0, s49
    s_waitcnt vmcnt(26)
    s_waitcnt lgkmcnt(0)
    ds_read_b64_tr_b16 v[96:97], v5 offset:4096
    ds_read_b64_tr_b16 v[98:99], v5 offset:5120
    ds_read_b64_tr_b16 v[100:101], v6 offset:4096
    ds_read_b64_tr_b16 v[102:103], v6 offset:5120
    v_mfma_f32_32x32x16_bf16 v[128:143], v[104:107], v[56:59], v[128:143]
    v_mfma_f32_32x32x16_bf16 v[144:159], v[104:107], v[60:63], v[144:159]
    v_mfma_f32_32x32x16_bf16 v[160:175], v[108:111], v[56:59], v[160:175]
    v_mfma_f32_32x32x16_bf16 v[176:191], v[108:111], v[60:63], v[176:191]
    s_add_u32 m0, s34, 18432
    s_add_u32 s44, s38, s48
    buffer_load_dwordx4 v4, s[56:59], s44 offen lds
    s_add_u32 m0, s34, 19456
    s_add_u32 s44, s44, 7168
    buffer_load_dwordx4 v4, s[56:59], s44 offen lds
    s_add_u32 s48, s48, 14336
    s_cmp_eq_u32 s48, 401408
    s_cselect_b32 s48, 0, s48
    s_waitcnt vmcnt(24)
    s_waitcnt lgkmcnt(0)
    ds_read_b64_tr_b16 v[104:105], v5 offset:6144
    ds_read_b64_tr_b16 v[106:107], v5 offset:7168
    ds_read_b64_tr_b16 v[108:109], v6 offset:6144
    ds_read_b64_tr_b16 v[110:111], v6 offset:7168
    v_mfma_f32_32x32x16_bf16 v[128:143], v[96:99], v[64:67], v[128:143]
    v_mfma_f32_32x32x16_bf16 v[144:159], v[96:99], v[68:71], v[144:159]
    v_mfma_f32_32x32x16_bf16 v[160:175], v[100:103], v[64:67], v[160:175]
    v_mfma_f32_32x32x16_bf16 v[176:191], v[100:103], v[68:71], v[176:191]
    s_add_u32 s44, s40, s49
    buffer_load_dwordx4 v[40:43], v2, s[24:27], s44 offen sc1
    s_add_u32 s44, s44, s54
    buffer_load_dwordx4 v[44:47], v2, s[24:27], s44 offen sc1
    s_add_u32 s49, s49, 1024
    s_cmp_eq_u32 s49, 28672
    s_cselect_b32 s49, 0, s49
    s_waitcnt vmcnt(22)
    s_waitcnt lgkmcnt(0)
    ds_read_b64_tr_b16 v[96:97], v5 offset:8192
    ds_read_b64_tr_b16 v[98:99], v5 offset:9216
    ds_read_b64_tr_b16 v[100:101], v6 offset:8192
    ds_read_b64_tr_b16 v[102:103], v6 offset:9216
    v_mfma_f32_32x32x16_bf16 v[128:143], v[104:107], v[72:75], v[128:143]
    v_mfma_f32_32x32x16_bf16 v[144:159], v[104:107], v[76:79], v[144:159]
    v_mfma_f32_32x32x16_bf16 v[160:175], v[108:111], v[72:75], v[160:175]
    v_mfma_f32_32x32x16_bf16 v[176:191], v[108:111], v[76:79], v[176:191]
    s_add_u32 m0, s34, 20480
    s_add_u32 s44, s38, s48
    buffer_load_dwordx4 v4, s[56:59], s44 offen lds
    s_add_u32 m0, s34, 21504
    s_add_u32 s44, s44, 7168
    buffer_load_dwordx4 v4, s[56:59], s44 offen lds
    s_add_u32 s48, s48, 14336
    s_cmp_eq_u32 s48, 401408
    s_cselect_b32 s48, 0, s48
    s_add_u32 s44, s40, s49
    buffer_load_dwordx4 v[48:51], v2, s[24:27], s44 offen sc1
    s_add_u32 s44, s44, s54
    buffer_load_dwordx4 v[52:55], v2, s[24:27], s44 offen sc1
    s_add_u32 s49, s49, 1024
    s_cmp_eq_u32 s49, 28672
    s_cselect_b32 s49, 0, s49
    s_waitcnt vmcnt(22)
    s_waitcnt lgkmcnt(0)
    ds_read_b64_tr_b16 v[104:105], v5 offset:10240
    ds_read_b64_tr_b16 v[106:107], v5 offset:11264
    ds_read_b64_tr_b16 v[108:109], v6 offset:10240
    ds_read_b64_tr_b16 v[110:111], v6 offset:11264
    v_mfma_f32_32x32x16_bf16 v[128:143], v[96:99], v[80:83], v[128:143]
    v_mfma_f32_32x32x16_bf16 v[144:159], v[96:99], v[84:87], v[144:159]
    v_mfma_f32_32x32x16_bf16 v[160:175], v[100:103], v[80:83], v[160:175]
    v_mfma_f32_32x32x16_bf16 v[176:191], v[100:103], v[84:87], v[176:191]
    s_add_u32 m0, s34, 22528
    s_add_u32 s44, s38, s48
    buffer_load_dwordx4 v4, s[56:59], s44 offen lds
    s_add_u32 m0, s34, 23552
    s_add_u32 s44, s44, 7168
    buffer_load_dwordx4 v4, s[56:59], s44 offen lds
    s_add_u32 s48, s48, 14336
    s_cmp_eq_u32 s48, 401408
    s_cselect_b32 s48, 0, s48
    s_add_u32 s44, s40, s49
    buffer_load_dwordx4 v[56:59], v2, s[24:27], s44 offen sc1
    s_add_u32 s44, s44, s54
    buffer_load_dwordx4 v[60:63], v2, s[24:27], s44 offen sc1
    s_add_u32 s49, s49, 1024
    s_cmp_eq_u32 s49, 28672
    s_cselect_b32 s49, 0, s49
    s_waitcnt vmcnt(22)
    s_waitcnt lgkmcnt(0)
    ds_read_b64_tr_b16 v[96:97], v5 offset:12288
    ds_read_b64_tr_b16 v[98:99], v5 offset:13312
    ds_read_b64_tr_b16 v[100:101], v6 offset:12288
    ds_read_b64_tr_b16 v[102:103], v6 offset:13312
    v_mfma_f32_32x32x16_bf16 v[128:143], v[104:107], v[88:91], v[128:143]
    v_mfma_f32_32x32x16_bf16 v[144:159], v[104:107], v[92:95], v[144:159]
    v_mfma_f32_32x32x16_bf16 v[160:175], v[108:111], v[88:91], v[160:175]
    v_mfma_f32_32x32x16_bf16 v[176:191], v[108:111], v[92:95], v[176:191]
    s_add_u32 s44, s40, s49
    buffer_load_dwordx4 v[64:67], v2, s[24:27], s44 offen sc1
    s_add_u32 s44, s44, s54
    buffer_load_dwordx4 v[68:71], v2, s[24:27], s44 offen sc1
    s_add_u32 s49, s49, 1024
    s_cmp_eq_u32 s49, 28672
    s_cselect_b32 s49, 0, s49
    s_waitcnt vmcnt(20)
    s_waitcnt lgkmcnt(0)
    ds_read_b64_tr_b16 v[104:105], v5 offset:14336
    ds_read_b64_tr_b16 v[106:107], v5 offset:15360
    ds_read_b64_tr_b16 v[108:109], v6 offset:14336
    ds_read_b64_tr_b16 v[110:111], v6 offset:15360
    v_mfma_f32_32x32x16_bf16 v[128:143], v[96:99], v[112:115], v[128:143]
    v_mfma_f32_32x32x16_bf16 v[144:159], v[96:99], v[116:119], v[144:159]
    v_mfma_f32_32x32x16_bf16 v[160:175], v[100:103], v[112:115], v[160:175]
    v_mfma_f32_32x32x16_bf16 v[176:191], v[100:103], v[116:119], v[176:191]
    s_add_u32 m0, s34, 0
    s_add_u32 s44, s38, s48
    buffer_load_dwordx4 v4, s[56:59], s44 offen lds
    s_add_u32 m0, s34, 1024
    s_add_u32 s44, s44, 7168
    buffer_load_dwordx4 v4, s[56:59], s44 offen lds
    s_add_u32 s48, s48, 14336
    s_cmp_eq_u32 s48, 401408
    s_cselect_b32 s48, 0, s48
    s_waitcnt vmcnt(18)
    s_waitcnt lgkmcnt(0)
    ds_read_b64_tr_b16 v[96:97], v5 offset:16384
    ds_read_b64_tr_b16 v[98:99], v5 offset:17408
    ds_read_b64_tr_b16 v[100:101], v6 offset:16384
    ds_read_b64_tr_b16 v[102:103], v6 offset:17408
    v_mfma_f32_32x32x16_bf16 v[128:143], v[104:107], v[120:123], v[128:143]
    v_mfma_f32_32x32x16_bf16 v[144:159], v[104:107], v[124:127], v[144:159]
    v_mfma_f32_32x32x16_bf16 v[160:175], v[108:111], v[120:123], v[160:175]
    v_mfma_f32_32x32x16_bf16 v[176:191], v[108:111], v[124:127], v[176:191]
    s_add_u32 m0, s34, 2048
    s_add_u32 s44, s38, s48
    buffer_load_dwordx4 v4, s[56:59], s44 offen lds
    s_add_u32 m0, s34, 3072
    s_add_u32 s44, s44, 7168
    buffer_load_dwordx4 v4, s[56:59], s44 offen lds
    s_add_u32 s48, s48, 14336
    s_cmp_eq_u32 s48, 401408
    s_cselect_b32 s48, 0, s48
    s_add_u32 s44, s40, s49
    buffer_load_dwordx4 v[72:75], v2, s[24:27], s44 offen sc1
    s_add_u32 s44, s44, s54
    buffer_load_dwordx4 v[76:79], v2, s[24:27], s44 offen sc1
    s_add_u32 s49, s49, 1024
    s_cmp_eq_u32 s49, 28672
    s_cselect_b32 s49, 0, s49
    s_waitcnt vmcnt(18)
    s_waitcnt lgkmcnt(0)
    ds_read_b64_tr_b16 v[104:105], v5 offset:18432
    ds_read_b64_tr_b16 v[106:107], v5 offset:19456
    ds_read_b64_tr_b16 v[108:109], v6 offset:18432
    ds_read_b64_tr_b16 v[110:111], v6 offset:19456
    v_mfma_f32_32x32x16_bf16 v[128:143], v[96:99], v[32:35], v[128:143]
    v_mfma_f32_32x32x16_bf16 v[144:159], v[96:99], v[36:39], v[144:159]
    v_mfma_f32_32x32x16_bf16 v[160:175], v[100:103], v[32:35], v[160:175]
    v_mfma_f32_32x32x16_bf16 v[176:191], v[100:103], v[36:39], v[176:191]
    s_add_u32 m0, s34, 4096
    s_add_u32 s44, s38, s48
    buffer_load_dwordx4 v4, s[56:59], s44 offen lds
    s_add_u32 m0, s34, 5120
    s_add_u32 s44, s44, 7168
    buffer_load_dwordx4 v4, s[56:59], s44 offen lds
    s_add_u32 s48, s48, 14336
    s_cmp_eq_u32 s48, 401408
    s_cselect_b32 s48, 0, s48
    s_add_u32 s44, s40, s49
    buffer_load_dwordx4 v[80:83], v2, s[24:27], s44 offen sc1
    s_add_u32 s44, s44, s54
    buffer_load_dwordx4 v[84:87], v2, s[24:27], s44 offen sc1
    s_add_u32 s49, s49, 1024
    s_cmp_eq_u32 s49, 28672
    s_cselect_b32 s49, 0, s49
    s_waitcnt vmcnt(18)
    s_waitcnt lgkmcnt(0)
    ds_read_b64_tr_b16 v[96:97], v5 offset:20480
    ds_read_b64_tr_b16 v[98:99], v5 offset:21504
    ds_read_b64_tr_b16 v[100:101], v6 offset:20480
    ds_read_b64_tr_b16 v[102:103], v6 offset:21504
    v_mfma_f32_32x32x16_bf16 v[128:143], v[104:107], v[40:43], v[128:143]
    v_mfma_f32_32x32x16_bf16 v[144:159], v[104:107], v[44:47], v[144:159]
    v_mfma_f32_32x32x16_bf16 v[160:175], v[108:111], v[40:43], v[160:175]
    v_mfma_f32_32x32x16_bf16 v[176:191], v[108:111], v[44:47], v[176:191]
    s_add_u32 s44, s40, s49
    buffer_load_dwordx4 v[88:91], v2, s[24:27], s44 offen sc1
    s_add_u32 s44, s44, s54
    buffer_load_dwordx4 v[92:95], v2, s[24:27], s44 offen sc1
    s_add_u32 s49, s49, 1024
    s_cmp_eq_u32 s49, 28672
    s_cselect_b32 s49, 0, s49
    s_waitcnt vmcnt(16)
    s_waitcnt lgkmcnt(0)
    ds_read_b64_tr_b16 v[104:105], v5 offset:22528
    ds_read_b64_tr_b16 v[106:107], v5 offset:23552
    ds_read_b64_tr_b16 v[108:109], v6 offset:22528
    ds_read_b64_tr_b16 v[110:111], v6 offset:23552
    v_mfma_f32_32x32x16_bf16 v[128:143], v[96:99], v[48:51], v[128:143]
    v_mfma_f32_32x32x16_bf16 v[144:159], v[96:99], v[52:55], v[144:159]
    v_mfma_f32_32x32x16_bf16 v[160:175], v[100:103], v[48:51], v[160:175]
    v_mfma_f32_32x32x16_bf16 v[176:191], v[100:103], v[52:55], v[176:191]
    s_add_u32 m0, s34, 6144
    s_add_u32 s44, s38, s48
    buffer_load_dwordx4 v4, s[56:59], s44 offen lds
    s_add_u32 m0, s34, 7168
    s_add_u32 s44, s44, 7168
    buffer_load_dwordx4 v4, s[56:59], s44 offen lds
    s_add_u32 s48, s48, 14336
    s_cmp_eq_u32 s48, 401408
    s_cselect_b32 s48, 0, s48
    s_waitcnt vmcnt(12)
    s_waitcnt lgkmcnt(0)
    ds_read_b64_tr_b16 v[96:97], v5 offset:0
    ds_read_b64_tr_b16 v[98:99], v5 offset:1024
    ds_read_b64_tr_b16 v[100:101], v6 offset:0
    ds_read_b64_tr_b16 v[102:103], v6 offset:1024
    buffer_load_dword v14, v11, s[24:27], 0 offen sc1
    v_mfma_f32_32x32x16_bf16 v[128:143], v[104:107], v[56:59], v[128:143]
    v_mfma_f32_32x32x16_bf16 v[144:159], v[104:107], v[60:63], v[144:159]
    v_mfma_f32_32x32x16_bf16 v[160:175], v[108:111], v[56:59], v[160:175]
    v_mfma_f32_32x32x16_bf16 v[176:191], v[108:111], v[60:63], v[176:191]
    s_waitcnt vmcnt(11)
    s_waitcnt lgkmcnt(0)
    ds_read_b64_tr_b16 v[104:105], v5 offset:2048
    ds_read_b64_tr_b16 v[106:107], v5 offset:3072
    ds_read_b64_tr_b16 v[108:109], v6 offset:2048
    ds_read_b64_tr_b16 v[110:111], v6 offset:3072
    v_mfma_f32_32x32x16_bf16 v[128:143], v[96:99], v[64:67], v[128:143]
    v_mfma_f32_32x32x16_bf16 v[144:159], v[96:99], v[68:71], v[144:159]
    v_mfma_f32_32x32x16_bf16 v[160:175], v[100:103], v[64:67], v[160:175]
    v_mfma_f32_32x32x16_bf16 v[176:191], v[100:103], v[68:71], v[176:191]
    s_waitcnt vmcnt(7)
    s_waitcnt lgkmcnt(0)
    ds_read_b64_tr_b16 v[96:97], v5 offset:4096
    ds_read_b64_tr_b16 v[98:99], v5 offset:5120
    ds_read_b64_tr_b16 v[100:101], v6 offset:4096
    ds_read_b64_tr_b16 v[102:103], v6 offset:5120
    v_mfma_f32_32x32x16_bf16 v[128:143], v[104:107], v[72:75], v[128:143]
    v_mfma_f32_32x32x16_bf16 v[144:159], v[104:107], v[76:79], v[144:159]
    v_mfma_f32_32x32x16_bf16 v[160:175], v[108:111], v[72:75], v[160:175]
    v_mfma_f32_32x32x16_bf16 v[176:191], v[108:111], v[76:79], v[176:191]
    s_waitcnt vmcnt(1)
    s_waitcnt lgkmcnt(0)
    ds_read_b64_tr_b16 v[104:105], v5 offset:6144
    ds_read_b64_tr_b16 v[106:107], v5 offset:7168
    ds_read_b64_tr_b16 v[108:109], v6 offset:6144
    ds_read_b64_tr_b16 v[110:111], v6 offset:7168
    s_waitcnt vmcnt(0)
    v_cmp_ne_u32 vcc, s74, v14
    s_nop 0
    s_cmp_lg_u64 vcc, 0
    s_cselect_b32 s43, 1, 0
    s_cbranch_scc1 G_OLATE
    s_add_u32 s44, s41, s50
    buffer_load_dwordx4 v[112:115], v2, s[24:27], s44 offen offset:0 sc1
    buffer_load_dwordx4 v[120:123], v2, s[24:27], s44 offen offset:1024 sc1
    s_add_u32 s44, s41, s51
    buffer_load_dwordx4 v[32:35], v2, s[24:27], s44 offen offset:0 sc1
    buffer_load_dwordx4 v[40:43], v2, s[24:27], s44 offen offset:1024 sc1
    s_add_u32 s44, s41, s52
    buffer_load_dwordx4 v[48:51], v2, s[24:27], s44 offen offset:0 sc1
    buffer_load_dwordx4 v[56:59], v2, s[24:27], s44 offen offset:1024 sc1
    s_add_u32 s44, s41, s53
    buffer_load_dwordx4 v[64:67], v2, s[24:27], s44 offen offset:0 sc1
    buffer_load_dwordx4 v[72:75], v2, s[24:27], s44 offen offset:1024 sc1
    s_add_u32 s44, s55, s50
    buffer_load_dwordx4 v[116:119], v2, s[24:27], s44 offen offset:0 sc1
    buffer_load_dwordx4 v[124:127], v2, s[24:27], s44 offen offset:1024 sc1
    s_add_u32 s44, s55, s51
    buffer_load_dwordx4 v[36:39], v2, s[24:27], s44 offen offset:0 sc1
    buffer_load_dwordx4 v[44:47], v2, s[24:27], s44 offen offset:1024 sc1
    s_add_u32 s44, s55, s52
    buffer_load_dwordx4 v[52:55], v2, s[24:27], s44 offen offset:0 sc1
    buffer_load_dwordx4 v[60:63], v2, s[24:27], s44 offen offset:1024 sc1
    s_add_u32 s44, s55, s53
    buffer_load_dwordx4 v[68:71], v2, s[24:27], s44 offen offset:0 sc1
    buffer_load_dwordx4 v[76:79], v2, s[24:27], s44 offen offset:1024 sc1
G_OLATE:
    v_mfma_f32_32x32x16_bf16 v[128:143], v[96:99], v[80:83], v[128:143]
    v_mfma_f32_32x32x16_bf16 v[144:159], v[96:99], v[84:87], v[144:159]
    v_mfma_f32_32x32x16_bf16 v[160:175], v[100:103], v[80:83], v[160:175]
    v_mfma_f32_32x32x16_bf16 v[176:191], v[100:103], v[84:87], v[176:191]
    s_waitcnt lgkmcnt(0)
    v_mfma_f32_32x32x16_bf16 v[128:143], v[104:107], v[88:91], v[128:143]
    v_mfma_f32_32x32x16_bf16 v[144:159], v[104:107], v[92:95], v[144:159]
    v_mfma_f32_32x32x16_bf16 v[160:175], v[108:111], v[88:91], v[160:175]
    v_mfma_f32_32x32x16_bf16 v[176:191], v[108:111], v[92:95], v[176:191]
    s_mov_b32 s42, 0
    s_mov_b32 s47, 1048576
    s_cmp_eq_u32 s43, 0
    s_cbranch_scc1 G_OGO
    s_mov_b32 s47, 1048576
G_POLL3:
    buffer_load_dword v12, v11, s[24:27], s42 offen offset:0 sc1
    s_waitcnt vmcnt(0)
    v_cmp_ne_u32 vcc, s74, v12
    s_nop 0
    s_cmp_eq_u64 vcc, 0
    s_cbranch_scc1 G_POLL3_OK
    s_sleep 2
    s_sub_u32 s47, s47, 1
    s_cmp_lg_u32 s47, 0
    s_cbranch_scc1 G_POLL3
G_POLL3_OK:
    s_add_u32 s44, s41, s50
    buffer_load_dwordx4 v[112:115], v2, s[24:27], s44 offen offset:0 sc1
    buffer_load_dwordx4 v[120:123], v2, s[24:27], s44 offen offset:1024 sc1
    s_add_u32 s44, s41, s51
    buffer_load_dwordx4 v[32:35], v2, s[24:27], s44 offen offset:0 sc1
    buffer_load_dwordx4 v[40:43], v2, s[24:27], s44 offen offset:1024 sc1
    s_add_u32 s44, s41, s52
    buffer_load_dwordx4 v[48:51], v2, s[24:27], s44 offen offset:0 sc1
    buffer_load_dwordx4 v[56:59], v2, s[24:27], s44 offen offset:1024 sc1
    s_add_u32 s44, s41, s53
    buffer_load_dwordx4 v[64:67], v2, s[24:27], s44 offen offset:0 sc1
    buffer_load_dwordx4 v[72:75], v2, s[24:27], s44 offen offset:1024 sc1
    s_add_u32 s44, s55, s50
    buffer_load_dwordx4 v[116:119], v2, s[24:27], s44 offen offset:0 sc1
    buffer_load_dwordx4 v[124:127], v2, s[24:27], s44 offen offset:1024 sc1
    s_add_u32 s44, s55, s51
    buffer_load_dwordx4 v[36:39], v2, s[24:27], s44 offen offset:0 sc1
    buffer_load_dwordx4 v[44:47], v2, s[24:27], s44 offen offset:1024 sc1
    s_add_u32 s44, s55, s52
    buffer_load_dwordx4 v[52:55], v2, s[24:27], s44 offen offset:0 sc1
    buffer_load_dwordx4 v[60:63], v2, s[24:27], s44 offen offset:1024 sc1
    s_add_u32 s44, s55, s53
    buffer_load_dwordx4 v[68:71], v2, s[24:27], s44 offen offset:0 sc1
    buffer_load_dwordx4 v[76:79], v2, s[24:27], s44 offen offset:1024 sc1
G_OGO:
    s_waitcnt vmcnt(15)
    v_mfma_f32_32x32x16_bf16 v[128:143], v[192:195], v[112:115], v[128:143]
    v_mfma_f32_32x32x16_bf16 v[160:175], v[196:199], v[112:115], v[160:175]
    s_waitcnt vmcnt(14)
    v_mfma_f32_32x32x16_bf16 v[128:143], v[200:203], v[120:123], v[128:143]
    v_mfma_f32_32x32x16_bf16 v[160:175], v[204:207], v[120:123], v[160:175]
    s_waitcnt vmcnt(13)
    v_mfma_f32_32x32x16_bf16 v[128:143], v[208:211], v[32:35], v[128:143]
    v_mfma_f32_32x32x16_bf16 v[160:175], v[212:215], v[32:35], v[160:175]
    s_waitcnt vmcnt(12)
    v_mfma_f32_32x32x16_bf16 v[128:143], v[216:219], v[40:43], v[128:143]
    v_mfma_f32_32x32x16_bf16 v[160:175], v[220:223], v[40:43], v[160:175]
    s_waitcnt vmcnt(11)
    v_mfma_f32_32x32x16_bf16 v[128:143], v[224:227], v[48:51], v[128:143]
    v_mfma_f32_32x32x16_bf16 v[160:175], v[228:231], v[48:51], v[160:175]
    s_waitcnt vmcnt(10)
    v_mfma_f32_32x32x16_bf16 v[128:143], v[232:235], v[56:59], v[128:143]
    v_mfma_f32_32x32x16_bf16 v[160:175], v[236:239], v[56:59], v[160:175]
    s_waitcnt vmcnt(9)
    v_mfma_f32_32x32x16_bf16 v[128:143], v[240:243], v[64:67], v[128:143]
    v_mfma_f32_32x32x16_bf16 v[160:175], v[244:247], v[64:67], v[160:175]
    s_waitcnt vmcnt(8)
    v_mfma_f32_32x32x16_bf16 v[128:143], v[248:251], v[72:75], v[128:143]
    v_mfma_f32_32x32x16_bf16 v[160:175], v[252:255], v[72:75], v[160:175]
    s_waitcnt vmcnt(7)
    v_mfma_f32_32x32x16_bf16 v[144:159], v[192:195], v[116:119], v[144:159]
    s_waitcnt vmcnt(6)
    v_mfma_f32_32x32x16_bf16 v[144:159], v[200:203], v[124:127], v[144:159]
    s_waitcnt vmcnt(5)
    v_mfma_f32_32x32x16_bf16 v[144:159], v[208:211], v[36:39], v[144:159]
    s_waitcnt vmcnt(4)
    v_mfma_f32_32x32x16_bf16 v[144:159], v[216:219], v[44:47], v[144:159]
    s_waitcnt vmcnt(3)
    v_mfma_f32_32x32x16_bf16 v[144:159], v[224:227], v[52:55], v[144:159]
    s_nop 1
    ds_write_b128 v10, v[128:131] offset:0
    ds_write_b128 v10, v[132:135] offset:1024
    ds_write_b128 v10, v[136:139] offset:2048
    ds_write_b128 v10, v[140:143] offset:3072
    s_waitcnt vmcnt(2)
    v_mfma_f32_32x32x16_bf16 v[144:159], v[232:235], v[60:63], v[144:159]
    ds_write_b128 v10, v[160:163] offset:4096
    ds_write_b128 v10, v[164:167] offset:5120
    ds_write_b128 v10, v[168:171] offset:6144
    ds_write_b128 v10, v[172:175] offset:7168
    s_waitcnt vmcnt(1)
    v_mfma_f32_32x32x16_bf16 v[144:159], v[240:243], v[68:71], v[144:159]
    s_waitcnt vmcnt(0)
    v_mfma_f32_32x32x16_bf16 v[144:159], v[248:251], v[76:79], v[144:159]
    s_waitcnt lgkmcnt(0)
    s_barrier
    ds_read_b128 v[80:83], v18 offset:0
    ds_read_b128 v[84:87], v18 offset:1024
    ds_read_b128 v[88:91], v18 offset:2048
    ds_read_b128 v[92:95], v18 offset:3072
    ds_read_b128 v[96:99], v17 offset:0
    ds_read_b128 v[100:103], v17 offset:1024
    ds_read_b128 v[104:107], v17 offset:2048
    ds_read_b128 v[108:111], v17 offset:3072
    v_mfma_f32_32x32x16_bf16 v[176:191], v[196:199], v[116:119], v[176:191]
    v_mfma_f32_32x32x16_bf16 v[176:191], v[204:207], v[124:127], v[176:191]
    s_nop 0
    ds_write_b128 v10, v[144:147] offset:8192
    ds_write_b128 v10, v[148:151] offset:9216
    ds_write_b128 v10, v[152:155] offset:10240
    ds_write_b128 v10, v[156:159] offset:11264
    v_mfma_f32_32x32x16_bf16 v[176:191], v[212:215], v[36:39], v[176:191]
    v_mfma_f32_32x32x16_bf16 v[176:191], v[220:223], v[44:47], v[176:191]
    v_mfma_f32_32x32x16_bf16 v[176:191], v[228:231], v[52:55], v[176:191]
    v_mfma_f32_32x32x16_bf16 v[176:191], v[236:239], v[60:63], v[176:191]
    v_mfma_f32_32x32x16_bf16 v[176:191], v[244:247], v[68:71], v[176:191]
    v_mfma_f32_32x32x16_bf16 v[176:191], v[252:255], v[76:79], v[176:191]
    s_waitcnt lgkmcnt(0)
    s_barrier
    ds_read_b128 v[32:35], v16 offset:0
    ds_read_b128 v[36:39], v16 offset:1024
    ds_read_b128 v[40:43], v16 offset:2048
    ds_read_b128 v[44:47], v16 offset:3072
    v_pk_add_f32 v[80:81], v[80:81], v[96:97]
    v_pk_add_f32 v[82:83], v[82:83], v[98:99]
    v_pk_add_f32 v[84:85], v[84:85], v[100:101]
    v_pk_add_f32 v[86:87], v[86:87], v[102:103]
    v_pk_add_f32 v[88:89], v[88:89], v[104:105]
    v_pk_add_f32 v[90:91], v[90:91], v[106:107]
    v_pk_add_f32 v[92:93], v[92:93], v[108:109]
    v_pk_add_f32 v[94:95], v[94:95], v[110:111]
    v_mov_b32 v9, v8
    v_pk_add_f32 v[176:177], v[176:177], v[80:81]
    v_pk_add_f32 v[178:179], v[178:179], v[82:83]
    v_pk_add_f32 v[180:181], v[180:181], v[84:85]
    v_pk_add_f32 v[182:183], v[182:183], v[86:87]
    v_pk_add_f32 v[184:185], v[184:185], v[88:89]
    v_pk_add_f32 v[186:187], v[186:187], v[90:91]
    v_pk_add_f32 v[188:189], v[188:189], v[92:93]
    v_pk_add_f32 v[190:191], v[190:191], v[94:95]
    s_waitcnt lgkmcnt(2)
    v_pk_add_f32 v[176:177], v[176:177], v[32:33]
    v_pk_add_f32 v[178:179], v[178:179], v[34:35]
    v_pk_add_f32 v[180:181], v[180:181], v[36:37]
    v_pk_add_f32 v[182:183], v[182:183], v[38:39]
    v_pk_mul_f32 v[176:177], v[176:177], v[8:9]
    v_pk_mul_f32 v[178:179], v[178:179], v[8:9]
    v_pk_mul_f32 v[180:181], v[180:181], v[8:9]
    v_pk_mul_f32 v[182:183], v[182:183], v[8:9]
    v_cvt_pk_bf16_f32 v48, v176, v177
    v_cvt_pk_bf16_f32 v49, v178, v179
    v_cvt_pk_bf16_f32 v50, v180, v181
    v_cvt_pk_bf16_f32 v51, v182, v183
    s_nop 0
    v_permlane32_swap_b32 v48, v50
    v_permlane32_swap_b32 v49, v51
    buffer_store_dwordx4 v[48:51], v15, s[64:67], s6 offen offset:0
    s_waitcnt lgkmcnt(0)
    v_pk_add_f32 v[184:185], v[184:185], v[40:41]
    v_pk_add_f32 v[186:187], v[186:187], v[42:43]
    v_pk_add_f32 v[188:189], v[188:189], v[44:45]
    v_pk_add_f32 v[190:191], v[190:191], v[46:47]
    v_pk_mul_f32 v[184:185], v[184:185], v[8:9]
    v_pk_mul_f32 v[186:187], v[186:187], v[8:9]
    v_pk_mul_f32 v[188:189], v[188:189], v[8:9]
    v_pk_mul_f32 v[190:191], v[190:191], v[8:9]
    v_cvt_pk_bf16_f32 v52, v184, v185
    v_cvt_pk_bf16_f32 v53, v186, v187
    v_cvt_pk_bf16_f32 v54, v188, v189
    v_cvt_pk_bf16_f32 v55, v190, v191
    s_nop 0
    v_permlane32_swap_b32 v52, v54
    v_permlane32_swap_b32 v53, v55
    buffer_store_dwordx4 v[52:55], v15, s[64:67], s6 offen offset:32
G_DONE:
    s_endpgm
K_CA:
    s_waitcnt vmcnt(4)
    s_barrier
    ds_read_b128 v[32:35], v4 offset:0
    ds_read_b64_tr_b16 v[40:41], v12 offset:0
    ds_read_b64_tr_b16 v[42:43], v12 offset:512
    ds_read_b128 v[36:39], v4 offset:4096
    ds_read_b64_tr_b16 v[44:45], v15 offset:4096
    ds_read_b64_tr_b16 v[46:47], v15 offset:4608
    ds_read_b64_tr_b16 v[48:49], v16 offset:4096
    ds_read_b64_tr_b16 v[50:51], v16 offset:4608
    s_waitcnt lgkmcnt(0)
    v_mfma_f32_32x32x16_bf16 v[96:111], v[40:43], v[32:35], 0
    ds_read_b128 v[52:55], v5 offset:0
    ds_read_b64_tr_b16 v[60:61], v12 offset:2048
    ds_read_b64_tr_b16 v[62:63], v12 offset:2560
    v_mfma_f32_32x32x16_bf16 v[112:127], v[40:43], v[36:39], 0
    ds_read_b128 v[56:59], v5 offset:4096
    ds_read_b64_tr_b16 v[64:65], v15 offset:6144
    ds_read_b64_tr_b16 v[66:67], v15 offset:6656
    v_mfma_f32_32x32x16_bf16 v[128:143], v[44:47], v[32:35], 0
    ds_read_b64_tr_b16 v[68:69], v16 offset:6144
    ds_read_b64_tr_b16 v[70:71], v16 offset:6656
    v_mfma_f32_32x32x16_bf16 v[144:159], v[44:47], v[36:39], 0
    v_mfma_f32_32x32x16_bf16 v[160:175], v[48:51], v[32:35], 0
    v_mfma_f32_32x32x16_bf16 v[176:191], v[48:51], v[36:39], 0
    s_waitcnt lgkmcnt(0)
    v_mfma_f32_32x32x16_bf16 v[96:111], v[60:63], v[52:55], v[96:111]
    s_waitcnt vmcnt(1)
    s_barrier
    ds_read_b128 v[32:35], v6 offset:0
    ds_read_b64_tr_b16 v[40:41], v12 offset:12288
    ds_read_b64_tr_b16 v[42:43], v12 offset:12800
    v_add_u32 v8, 0x10000, v4
    v_add_u32 v9, 0x10000, v5
    v_add_u32 v10, 0x10000, v6
    v_mfma_f32_32x32x16_bf16 v[112:127], v[60:63], v[56:59], v[112:127]
    ds_read_b128 v[36:39], v6 offset:4096
    ds_read_b64_tr_b16 v[44:45], v15 offset:16384
    ds_read_b64_tr_b16 v[46:47], v15 offset:16896
    v_add_u32 v11, 0x10000, v7
    s_mov_b32 s30, 896
    s_mov_b32 s31, 0x00020000
    v_mfma_f32_32x32x16_bf16 v[128:143], v[64:67], v[52:55], v[128:143]
    ds_read_b64_tr_b16 v[48:49], v16 offset:16384
    ds_read_b64_tr_b16 v[50:51], v16 offset:16896
    s_mov_b32 s26, 17498112
    s_mov_b32 s27, 0x00020000
    s_mov_b32 s58, 1605632
    v_mfma_f32_32x32x16_bf16 v[144:159], v[64:67], v[56:59], v[144:159]
    s_mov_b32 s59, 0x00020000
    s_mov_b32 s62, 401408
    s_mov_b32 s63, 0x00020000
    v_mfma_f32_32x32x16_bf16 v[160:175], v[68:71], v[52:55], v[160:175]
    s_mov_b32 s66, 1835008
    s_mov_b32 s67, 0x00020000
    s_mov_b32 s70, 256
    v_mfma_f32_32x32x16_bf16 v[176:191], v[68:71], v[56:59], v[176:191]
    s_mov_b32 s71, 0x00020000
    s_and_b32 s4, s2, 7
    s_lshl_b32 s4, s4, 1
    s_waitcnt lgkmcnt(0)
    v_mfma_f32_32x32x16_bf16 v[96:111], v[40:43], v[32:35], v[96:111]
    ds_read_b128 v[52:55], v7 offset:0
    ds_read_b64_tr_b16 v[60:61], v12 offset:14336
    ds_read_b64_tr_b16 v[62:63], v12 offset:14848
    s_lshr_b32 s5, s2, 7
    s_add_u32 s37, s4, s5
    s_bfe_u32 s38, s2, 0x40003
    v_mfma_f32_32x32x16_bf16 v[112:127], v[40:43], v[36:39], v[112:127]
    ds_read_b128 v[56:59], v7 offset:4096
    ds_read_b64_tr_b16 v[64:65], v15 offset:18432
    ds_read_b64_tr_b16 v[66:67], v15 offset:18944
    s_lshl_b32 s6, s37, 18
    s_add_u32 s6, s6, 2097152
    s_lshl_b32 s5, s3, 16
    v_mfma_f32_32x32x16_bf16 v[128:143], v[44:47], v[32:35], v[128:143]
    ds_read_b64_tr_b16 v[68:69], v16 offset:18432
    ds_read_b64_tr_b16 v[70:71], v16 offset:18944
    s_add_u32 s39, s6, s5
    s_mov_b32 s99, s39
    v_mov_b32 v28, 0
    v_mfma_f32_32x32x16_bf16 v[144:159], v[44:47], v[36:39], v[144:159]
    v_mov_b32 v27, 1
    v_lshlrev_b32 v24, 2, v1
    s_lshl_b32 s4, s3, 12
    v_mfma_f32_32x32x16_bf16 v[160:175], v[48:51], v[32:35], v[160:175]
    v_add_u32 v3, s4, v2
    s_lshl_b32 s4, s3, 8
    v_add_u32 v25, s4, v24
    v_mfma_f32_32x32x16_bf16 v[176:191], v[48:51], v[36:39], v[176:191]
    s_add_u32 s4, s38, 0
    s_and_b32 s4, s4, 15
    s_lshl_b32 s4, s4, 12
    s_waitcnt lgkmcnt(0)
    v_mfma_f32_32x32x16_bf16 v[96:111], v[60:63], v[52:55], v[96:111]
    s_barrier
    ds_read_b128 v[32:35], v4 offset:16384
    ds_read_b64_tr_b16 v[40:41], v12 offset:24576
    ds_read_b64_tr_b16 v[42:43], v12 offset:25088
    s_add_u32 s8, s4, s39
    s_add_u32 s4, s38, 1
    v_mfma_f32_32x32x16_bf16 v[112:127], v[60:63], v[56:59], v[112:127]
    ds_read_b128 v[36:39], v4 offset:20480
    ds_read_b64_tr_b16 v[44:45], v15 offset:28672
    ds_read_b64_tr_b16 v[46:47], v15 offset:29184
    s_and_b32 s4, s4, 15
    s_lshl_b32 s4, s4, 12
    v_mfma_f32_32x32x16_bf16 v[128:143], v[64:67], v[52:55], v[128:143]
    ds_read_b64_tr_b16 v[48:49], v16 offset:28672
    ds_read_b64_tr_b16 v[50:51], v16 offset:29184
    s_add_u32 s9, s4, s39
    s_add_u32 s4, s38, 2
    v_mfma_f32_32x32x16_bf16 v[144:159], v[64:67], v[56:59], v[144:159]
    s_and_b32 s4, s4, 15
    s_lshl_b32 s4, s4, 12
    v_mfma_f32_32x32x16_bf16 v[160:175], v[68:71], v[52:55], v[160:175]
    s_add_u32 s10, s4, s39
    s_add_u32 s4, s38, 3
    v_mfma_f32_32x32x16_bf16 v[176:191], v[68:71], v[56:59], v[176:191]
    s_and_b32 s4, s4, 15
    s_lshl_b32 s4, s4, 12
    s_waitcnt lgkmcnt(0)
    v_mfma_f32_32x32x16_bf16 v[96:111], v[40:43], v[32:35], v[96:111]
    ds_read_b128 v[52:55], v5 offset:16384
    ds_read_b64_tr_b16 v[60:61], v12 offset:26624
    ds_read_b64_tr_b16 v[62:63], v12 offset:27136
    s_add_u32 s11, s4, s39
    s_add_u32 s4, s38, 4
    v_mfma_f32_32x32x16_bf16 v[112:127], v[40:43], v[36:39], v[112:127]
    ds_read_b128 v[56:59], v5 offset:20480
    ds_read_b64_tr_b16 v[64:65], v15 offset:30720
    ds_read_b64_tr_b16 v[66:67], v15 offset:31232
    s_and_b32 s4, s4, 15
    s_lshl_b32 s4, s4, 12
    v_mfma_f32_32x32x16_bf16 v[128:143], v[44:47], v[32:35], v[128:143]
    ds_read_b64_tr_b16 v[68:69], v16 offset:30720
    ds_read_b64_tr_b16 v[70:71], v16 offset:31232
    s_add_u32 s12, s4, s39
    s_add_u32 s4, s38, 5
    v_mfma_f32_32x32x16_bf16 v[144:159], v[44:47], v[36:39], v[144:159]
    s_and_b32 s4, s4, 15
    s_lshl_b32 s4, s4, 12
    v_mfma_f32_32x32x16_bf16 v[160:175], v[48:51], v[32:35], v[160:175]
    s_add_u32 s13, s4, s39
    s_add_u32 s4, s38, 6
    v_mfma_f32_32x32x16_bf16 v[176:191], v[48:51], v[36:39], v[176:191]
    s_and_b32 s4, s4, 15
    s_lshl_b32 s4, s4, 12
    s_waitcnt lgkmcnt(0)
    v_mfma_f32_32x32x16_bf16 v[96:111], v[60:63], v[52:55], v[96:111]
    s_barrier
    ds_read_b128 v[32:35], v6 offset:16384
    ds_read_b64_tr_b16 v[40:41], v12 offset:36864
    ds_read_b64_tr_b16 v[42:43], v12 offset:37376
    s_add_u32 s14, s4, s39
    s_add_u32 s4, s38, 7
    v_mfma_f32_32x32x16_bf16 v[112:127], v[60:63], v[56:59], v[112:127]
    ds_read_b128 v[36:39], v6 offset:20480
    ds_read_b64_tr_b16 v[44:45], v15 offset:40960
    ds_read_b64_tr_b16 v[46:47], v15 offset:41472
    s_and_b32 s4, s4, 15
    s_lshl_b32 s4, s4, 12
    v_mfma_f32_32x32x16_bf16 v[128:143], v[64:67], v[52:55], v[128:143]
    ds_read_b64_tr_b16 v[48:49], v16 offset:40960
    ds_read_b64_tr_b16 v[50:51], v16 offset:41472
    s_add_u32 s15, s4, s39
    s_add_u32 s4, s38, 8
    v_mfma_f32_32x32x16_bf16 v[144:159], v[64:67], v[56:59], v[144:159]
    s_and_b32 s4, s4, 15
    s_lshl_b32 s4, s4, 12
    v_mfma_f32_32x32x16_bf16 v[160:175], v[68:71], v[52:55], v[160:175]
    s_add_u32 s28, s4, s39
    s_add_u32 s4, s38, 9
    v_mfma_f32_32x32x16_bf16 v[176:191], v[68:71], v[56:59], v[176:191]
    s_and_b32 s4, s4, 15
    s_lshl_b32 s4, s4, 12
    s_waitcnt lgkmcnt(0)
    v_mfma_f32_32x32x16_bf16 v[96:111], v[40:43], v[32:35], v[96:111]
    ds_read_b128 v[52:55], v7 offset:16384
    ds_read_b64_tr_b16 v[60:61], v12 offset:38912
    ds_read_b64_tr_b16 v[62:63], v12 offset:39424
    s_add_u32 s29, s4, s39
    s_add_u32 s4, s38, 10
    v_mfma_f32_32x32x16_bf16 v[112:127], v[40:43], v[36:39], v[112:127]
    ds_read_b128 v[56:59], v7 offset:20480
    ds_read_b64_tr_b16 v[64:65], v15 offset:43008
    ds_read_b64_tr_b16 v[66:67], v15 offset:43520
    s_and_b32 s4, s4, 15
    s_lshl_b32 s4, s4, 12
    v_mfma_f32_32x32x16_bf16 v[128:143], v[44:47], v[32:35], v[128:143]
    ds_read_b64_tr_b16 v[68:69], v16 offset:43008
    ds_read_b64_tr_b16 v[70:71], v16 offset:43520
    s_add_u32 s30, s4, s39
    s_add_u32 s4, s38, 11
    v_mfma_f32_32x32x16_bf16 v[144:159], v[44:47], v[36:39], v[144:159]
    s_and_b32 s4, s4, 15
    s_lshl_b32 s4, s4, 12
    v_mfma_f32_32x32x16_bf16 v[160:175], v[48:51], v[32:35], v[160:175]
    s_add_u32 s31, s4, s39
    s_add_u32 s4, s38, 12
    v_mfma_f32_32x32x16_bf16 v[176:191], v[48:51], v[36:39], v[176:191]
    s_and_b32 s4, s4, 15
    s_lshl_b32 s4, s4, 12
    s_waitcnt lgkmcnt(0)
    v_mfma_f32_32x32x16_bf16 v[96:111], v[60:63], v[52:55], v[96:111]
    s_barrier
    ds_read_b128 v[32:35], v4 offset:32768
    ds_read_b64_tr_b16 v[40:41], v12 offset:0
    ds_read_b64_tr_b16 v[42:43], v12 offset:512
    s_add_u32 s64, s4, s39
    s_add_u32 s4, s38, 13
    v_mfma_f32_32x32x16_bf16 v[112:127], v[60:63], v[56:59], v[112:127]
    ds_read_b128 v[36:39], v4 offset:36864
    ds_read_b64_tr_b16 v[44:45], v15 offset:4096
    ds_read_b64_tr_b16 v[46:47], v15 offset:4608
    s_and_b32 s4, s4, 15
    s_lshl_b32 s4, s4, 12
    v_mfma_f32_32x32x16_bf16 v[128:143], v[64:67], v[52:55], v[128:143]
    ds_read_b64_tr_b16 v[48:49], v16 offset:4096
    ds_read_b64_tr_b16 v[50:51], v16 offset:4608
    s_add_u32 s65, s4, s39
    s_add_u32 s4, s38, 14
    v_mfma_f32_32x32x16_bf16 v[144:159], v[64:67], v[56:59], v[144:159]
    s_and_b32 s4, s4, 15
    s_lshl_b32 s4, s4, 12
    v_mfma_f32_32x32x16_bf16 v[160:175], v[68:71], v[52:55], v[160:175]
    s_add_u32 s66, s4, s39
    s_add_u32 s4, s38, 15
    v_mfma_f32_32x32x16_bf16 v[176:191], v[68:71], v[56:59], v[176:191]
    s_and_b32 s4, s4, 15
    s_lshl_b32 s4, s4, 12
    s_waitcnt lgkmcnt(0)
    v_mfma_f32_32x32x16_bf16 v[96:111], v[40:43], v[32:35], v[96:111]
    ds_read_b128 v[52:55], v5 offset:32768
    ds_read_b64_tr_b16 v[60:61], v12 offset:2048
    ds_read_b64_tr_b16 v[62:63], v12 offset:2560
    s_add_u32 s67, s4, s39
    s_add_u32 s4, s3, 1
    v_mfma_f32_32x32x16_bf16 v[112:127], v[40:43], v[36:39], v[112:127]
    ds_read_b128 v[56:59], v5 offset:36864
    ds_read_b64_tr_b16 v[64:65], v15 offset:6144
    ds_read_b64_tr_b16 v[66:67], v15 offset:6656
    s_and_b32 s4, s4, 3
    s_lshl_b32 s4, s4, 11
    v_mfma_f32_32x32x16_bf16 v[128:143], v[44:47], v[32:35], v[128:143]
    ds_read_b64_tr_b16 v[68:69], v16 offset:6144
    ds_read_b64_tr_b16 v[70:71], v16 offset:6656
    v_add_u32 v20, s4, v2
    s_add_u32 s4, s3, 2
    v_mfma_f32_32x32x16_bf16 v[144:159], v[44:47], v[36:39], v[144:159]
    s_and_b32 s4, s4, 3
    s_lshl_b32 s4, s4, 11
    v_mfma_f32_32x32x16_bf16 v[160:175], v[48:51], v[32:35], v[160:175]
    v_add_u32 v21, s4, v2
    s_add_u32 s4, s3, 3
    v_mfma_f32_32x32x16_bf16 v[176:191], v[48:51], v[36:39], v[176:191]
    s_and_b32 s4, s4, 3
    s_lshl_b32 s4, s4, 11
    s_waitcnt lgkmcnt(0)
    v_mfma_f32_32x32x16_bf16 v[96:111], v[60:63], v[52:55], v[96:111]
    s_barrier
    ds_read_b128 v[32:35], v6 offset:32768
    ds_read_b64_tr_b16 v[40:41], v12 offset:12288
    ds_read_b64_tr_b16 v[42:43], v12 offset:12800
    v_add_u32 v22, s4, v2
    s_add_u32 s4, s3, 4
    v_mfma_f32_32x32x16_bf16 v[112:127], v[60:63], v[56:59], v[112:127]
    ds_read_b128 v[36:39], v6 offset:36864
    ds_read_b64_tr_b16 v[44:45], v15 offset:16384
    ds_read_b64_tr_b16 v[46:47], v15 offset:16896
    s_and_b32 s4, s4, 3
    s_lshl_b32 s4, s4, 11
    v_mfma_f32_32x32x16_bf16 v[128:143], v[64:67], v[52:55], v[128:143]
    v_mov_b32 v31, 0
    buffer_load_dword v30, v31, s[68:71], 0 offen sc1
    ds_read_b64_tr_b16 v[48:49], v16 offset:16384
    ds_read_b64_tr_b16 v[50:51], v16 offset:16896
    v_add_u32 v23, s4, v2
    s_lshl_b32 s5, s38, 2
    v_mfma_f32_32x32x16_bf16 v[144:159], v[64:67], v[56:59], v[144:159]
    s_add_u32 s5, s5, s3
    s_lshl_b32 s5, s5, 4
    v_mfma_f32_32x32x16_bf16 v[160:175], v[68:71], v[52:55], v[160:175]
    s_add_u32 s5, s5, s37
    s_lshl_b32 s96, s5, 11
    v_mfma_f32_32x32x16_bf16 v[176:191], v[68:71], v[56:59], v[176:191]
    s_add_u32 s96, s96, 14680064
    s_mov_b32 s100, s96
    s_waitcnt lgkmcnt(0)
    v_mfma_f32_32x32x16_bf16 v[96:111], v[40:43], v[32:35], v[96:111]
    ds_read_b128 v[52:55], v7 offset:32768
    ds_read_b64_tr_b16 v[60:61], v12 offset:14336
    ds_read_b64_tr_b16 v[62:63], v12 offset:14848
    s_lshl_b32 s97, s5, 7
    s_add_u32 s97, s97, 17367040
    v_mfma_f32_32x32x16_bf16 v[112:127], v[40:43], v[36:39], v[112:127]
    ds_read_b128 v[56:59], v7 offset:36864
    ds_read_b64_tr_b16 v[64:65], v15 offset:18432
    ds_read_b64_tr_b16 v[66:67], v15 offset:18944
    s_lshl_b32 s4, s32, 6
    s_lshl_b32 s5, s33, 2
    v_mfma_f32_32x32x16_bf16 v[128:143], v[44:47], v[32:35], v[128:143]
    s_lshl_b32 s44, s2, 2
    s_add_u32 s44, s44, s3
    s_mul_i32 s45, s44, 1600
    v_min_u32 v29, 24, v1
    v_lshlrev_b32 v29, 6, v29
    buffer_load_dword v95, v29, s[56:59], s45 offen
    s_mul_i32 s45, s44, 448
    v_min_u32 v29, 384, v29
    buffer_load_dword v95, v29, s[60:63], s45 offen
    ds_read_b64_tr_b16 v[68:69], v16 offset:18432
    ds_read_b64_tr_b16 v[70:71], v16 offset:18944
    s_add_u32 s4, s4, s5
    s_add_u32 s4, s4, s3
    v_mfma_f32_32x32x16_bf16 v[144:159], v[44:47], v[36:39], v[144:159]
    s_lshl_b32 s4, s4, 7
    s_add_u32 s98, s4, 17235968
    v_mfma_f32_32x32x16_bf16 v[160:175], v[48:51], v[32:35], v[160:175]
    s_lshl_b32 s37, s32, 2
    s_lshl_b32 s38, s35, 1
    v_mfma_f32_32x32x16_bf16 v[176:191], v[48:51], v[36:39], v[176:191]
    s_add_u32 s37, s37, s38
    s_mul_i32 s39, s36, 1
    s_waitcnt lgkmcnt(0)
    v_mfma_f32_32x32x16_bf16 v[96:111], v[60:63], v[52:55], v[96:111]
    s_barrier
    ds_read_b128 v[32:35], v4 offset:49152
    ds_read_b64_tr_b16 v[40:41], v12 offset:24576
    ds_read_b64_tr_b16 v[42:43], v12 offset:25088
    s_add_u32 s39, s39, s34
    v_lshrrev_b32 v17, 4, v1
    v_mfma_f32_32x32x16_bf16 v[112:127], v[60:63], v[56:59], v[112:127]
    ds_read_b128 v[36:39], v4 offset:53248
    ds_read_b64_tr_b16 v[44:45], v15 offset:28672
    ds_read_b64_tr_b16 v[46:47], v15 offset:29184
    v_add_u32 v17, s39, v17
    v_and_b32 v18, 15, v17
    v_mfma_f32_32x32x16_bf16 v[128:143], v[64:67], v[52:55], v[128:143]
    ds_read_b64_tr_b16 v[48:49], v16 offset:28672
    ds_read_b64_tr_b16 v[50:51], v16 offset:29184
    v_lshrrev_b32 v17, 4, v17
    v_mul_u32_u24 v18, 3, v18
    v_mfma_f32_32x32x16_bf16 v[144:159], v[64:67], v[56:59], v[144:159]
    v_add_u32 v17, v17, v18
    v_lshlrev_b32 v17, 12, v17
    v_mfma_f32_32x32x16_bf16 v[160:175], v[68:71], v[52:55], v[160:175]
    v_and_b32 v18, 15, v1
    v_lshl_add_u32 v17, v18, 3, v17
    v_mfma_f32_32x32x16_bf16 v[176:191], v[68:71], v[56:59], v[176:191]
    s_lshl_b32 s48, s37, 6
    s_add_u32 s48, s48, 17039360
    s_waitcnt lgkmcnt(0)
    v_mfma_f32_32x32x16_bf16 v[96:111], v[40:43], v[32:35], v[96:111]
    ds_read_b128 v[52:55], v5 offset:49152
    ds_read_b64_tr_b16 v[60:61], v12 offset:26624
    ds_read_b64_tr_b16 v[62:63], v12 offset:27136
    s_and_b32 s39, s39, 15
    s_lshl_b32 s39, s39, 6
    v_mfma_f32_32x32x16_bf16 v[112:127], v[40:43], v[36:39], v[112:127]
    ds_read_b128 v[56:59], v5 offset:53248
    ds_read_b64_tr_b16 v[64:65], v15 offset:30720
    ds_read_b64_tr_b16 v[66:67], v15 offset:31232
    s_add_u32 s39, s39, s37
    s_mov_b32 s50, 0
    v_mfma_f32_32x32x16_bf16 v[128:143], v[44:47], v[32:35], v[128:143]
    ds_read_b64_tr_b16 v[68:69], v16 offset:30720
    ds_read_b64_tr_b16 v[70:71], v16 offset:31232
    s_mov_b32 s51, -1
    s_cmp_lt_u32 s34, 16
    s_cselect_b32 s92, 0x3e8b97f6, 1.0
    s_mov_b32 s93, s92
    s_cselect_b32 s40, 0, 0x3f803f80
    s_cselect_b32 s41, 0, 0x3f80
    s_cselect_b32 s42, 11, 12
    s_cselect_b32 s43, 0, 2097152
    v_mfma_f32_32x32x16_bf16 v[144:159], v[44:47], v[36:39], v[144:159]
    v_mov_b32 v18, s40
    v_mov_b32 v19, s41
    v_mfma_f32_32x32x16_bf16 v[160:175], v[48:51], v[32:35], v[160:175]
    s_mul_i32 s40, s37, 112
    s_lshl_b32 s41, s36, 1
    v_mfma_f32_32x32x16_bf16 v[176:191], v[48:51], v[36:39], v[176:191]
    s_add_u32 s40, s40, s41
    s_lshl_b32 s41, s73, 2
    s_waitcnt lgkmcnt(0)
    v_mfma_f32_32x32x16_bf16 v[96:111], v[60:63], v[52:55], v[96:111]
    s_barrier
    ds_read_b128 v[32:35], v6 offset:49152
    ds_read_b64_tr_b16 v[40:41], v12 offset:36864
    ds_read_b64_tr_b16 v[42:43], v12 offset:37376
    s_add_u32 s54, s40, s41
    s_lshl_b32 s54, s54, 10
    v_mfma_f32_32x32x16_bf16 v[112:127], v[60:63], v[56:59], v[112:127]
    ds_read_b128 v[36:39], v6 offset:53248
    ds_read_b64_tr_b16 v[44:45], v15 offset:40960
    ds_read_b64_tr_b16 v[46:47], v15 offset:41472
    s_add_u32 s54, s54, 6291456
    s_add_u32 s55, s54, 114688
    v_mfma_f32_32x32x16_bf16 v[128:143], v[64:67], v[52:55], v[128:143]
    ds_read_b64_tr_b16 v[48:49], v16 offset:40960
    ds_read_b64_tr_b16 v[50:51], v16 offset:41472
    s_lshl_b32 s41, s72, 2
    s_add_u32 s40, s40, s41
    v_mfma_f32_32x32x16_bf16 v[144:159], v[64:67], v[56:59], v[144:159]
    s_lshl_b32 s40, s40, 10
    s_add_u32 s40, s40, 6291456
    v_mfma_f32_32x32x16_bf16 v[160:175], v[68:71], v[52:55], v[160:175]
    s_add_u32 s41, s40, 114688
    v_mfma_f32_32x32x16_bf16 v[176:191], v[68:71], v[56:59], v[176:191]
    s_waitcnt lgkmcnt(0)
    v_mfma_f32_32x32x16_bf16 v[96:111], v[40:43], v[32:35], v[96:111]
    ds_read_b128 v[52:55], v7 offset:49152
    ds_read_b64_tr_b16 v[60:61], v12 offset:38912
    ds_read_b64_tr_b16 v[62:63], v12 offset:39424
    v_mfma_f32_32x32x16_bf16 v[112:127], v[40:43], v[36:39], v[112:127]
    ds_read_b128 v[56:59], v7 offset:53248
    ds_read_b64_tr_b16 v[64:65], v15 offset:43008
    ds_read_b64_tr_b16 v[66:67], v15 offset:43520
    v_mfma_f32_32x32x16_bf16 v[128:143], v[44:47], v[32:35], v[128:143]
    ds_read_b64_tr_b16 v[68:69], v16 offset:43008
    ds_read_b64_tr_b16 v[70:71], v16 offset:43520
    v_mfma_f32_32x32x16_bf16 v[144:159], v[44:47], v[36:39], v[144:159]
    v_mfma_f32_32x32x16_bf16 v[160:175], v[48:51], v[32:35], v[160:175]
    v_mfma_f32_32x32x16_bf16 v[176:191], v[48:51], v[36:39], v[176:191]
    s_waitcnt lgkmcnt(0)
    v_mfma_f32_32x32x16_bf16 v[96:111], v[60:63], v[52:55], v[96:111]
    s_barrier
    ds_read_b128 v[32:35], v8 offset:0
    ds_read_b64_tr_b16 v[40:41], v12 offset:0
    ds_read_b64_tr_b16 v[42:43], v12 offset:512
    v_mfma_f32_32x32x16_bf16 v[112:127], v[60:63], v[56:59], v[112:127]
    ds_read_b128 v[36:39], v8 offset:4096
    ds_read_b64_tr_b16 v[44:45], v15 offset:4096
    ds_read_b64_tr_b16 v[46:47], v15 offset:4608
    v_mfma_f32_32x32x16_bf16 v[128:143], v[64:67], v[52:55], v[128:143]
    ds_read_b64_tr_b16 v[48:49], v16 offset:4096
    ds_read_b64_tr_b16 v[50:51], v16 offset:4608
    v_mfma_f32_32x32x16_bf16 v[144:159], v[64:67], v[56:59], v[144:159]
    v_mfma_f32_32x32x16_bf16 v[160:175], v[68:71], v[52:55], v[160:175]
    v_mfma_f32_32x32x16_bf16 v[176:191], v[68:71], v[56:59], v[176:191]
    s_waitcnt lgkmcnt(0)
    v_mfma_f32_32x32x16_bf16 v[96:111], v[40:43], v[32:35], v[96:111]
    ds_read_b128 v[52:55], v9 offset:0
    ds_read_b64_tr_b16 v[60:61], v12 offset:2048
    ds_read_b64_tr_b16 v[62:63], v12 offset:2560
    v_mfma_f32_32x32x16_bf16 v[112:127], v[40:43], v[36:39], v[112:127]
    ds_read_b128 v[56:59], v9 offset:4096
    ds_read_b64_tr_b16 v[64:65], v15 offset:6144
    ds_read_b64_tr_b16 v[66:67], v15 offset:6656
    v_mfma_f32_32x32x16_bf16 v[128:143], v[44:47], v[32:35], v[128:143]
    ds_read_b64_tr_b16 v[68:69], v16 offset:6144
    ds_read_b64_tr_b16 v[70:71], v16 offset:6656
    v_mfma_f32_32x32x16_bf16 v[144:159], v[44:47], v[36:39], v[144:159]
    v_mfma_f32_32x32x16_bf16 v[160:175], v[48:51], v[32:35], v[160:175]
    v_mfma_f32_32x32x16_bf16 v[176:191], v[48:51], v[36:39], v[176:191]
    s_waitcnt lgkmcnt(0)
    v_mfma_f32_32x32x16_bf16 v[96:111], v[60:63], v[52:55], v[96:111]
    s_barrier
    ds_read_b128 v[32:35], v10 offset:0
    ds_read_b64_tr_b16 v[40:41], v12 offset:12288
    ds_read_b64_tr_b16 v[42:43], v12 offset:12800
    v_mfma_f32_32x32x16_bf16 v[112:127], v[60:63], v[56:59], v[112:127]
    ds_read_b128 v[36:39], v10 offset:4096
    ds_read_b64_tr_b16 v[44:45], v15 offset:16384
    ds_read_b64_tr_b16 v[46:47], v15 offset:16896
    v_mfma_f32_32x32x16_bf16 v[128:143], v[64:67], v[52:55], v[128:143]
    ds_read_b64_tr_b16 v[48:49], v16 offset:16384
    ds_read_b64_tr_b16 v[50:51], v16 offset:16896
    v_mfma_f32_32x32x16_bf16 v[144:159], v[64:67], v[56:59], v[144:159]
    v_mfma_f32_32x32x16_bf16 v[160:175], v[68:71], v[52:55], v[160:175]
    v_mfma_f32_32x32x16_bf16 v[176:191], v[68:71], v[56:59], v[176:191]
    s_waitcnt lgkmcnt(0)
    v_mfma_f32_32x32x16_bf16 v[96:111], v[40:43], v[32:35], v[96:111]
    ds_read_b128 v[52:55], v11 offset:0
    ds_read_b64_tr_b16 v[60:61], v12 offset:14336
    ds_read_b64_tr_b16 v[62:63], v12 offset:14848
    v_mfma_f32_32x32x16_bf16 v[112:127], v[40:43], v[36:39], v[112:127]
    ds_read_b128 v[56:59], v11 offset:4096
    ds_read_b64_tr_b16 v[64:65], v15 offset:18432
    ds_read_b64_tr_b16 v[66:67], v15 offset:18944
    v_mfma_f32_32x32x16_bf16 v[128:143], v[44:47], v[32:35], v[128:143]
    s_bfe_u32 s44, s2, 0x30003
    s_lshl_b32 s44, s44, 1
    s_add_u32 s44, s44, s35
    s_mul_i32 s44, s44, 100352
    s_lshl_b32 s45, s73, 7
    s_add_u32 s44, s44, s45
    v_lshrrev_b32 v29, 1, v1
    v_min_u32 v29, 27, v29
    v_mul_u32_u24 v29, 3584, v29
    v_and_b32 v26, 1, v1
    v_lshl_add_u32 v29, v26, 6, v29
    s_cmp_eq_u32 s36, 0
    s_cbranch_scc1 CA_TG
    buffer_load_dword v29, v29, s[20:23], s44 offen
    s_branch CA_TD
CA_TG:
    buffer_load_dword v29, v29, s[16:19], s44 offen
CA_TD:
    ds_read_b64_tr_b16 v[68:69], v16 offset:18432
    ds_read_b64_tr_b16 v[70:71], v16 offset:18944
    v_mfma_f32_32x32x16_bf16 v[144:159], v[44:47], v[36:39], v[144:159]
    v_mfma_f32_32x32x16_bf16 v[160:175], v[48:51], v[32:35], v[160:175]
    v_mfma_f32_32x32x16_bf16 v[176:191], v[48:51], v[36:39], v[176:191]
    s_waitcnt lgkmcnt(0)
    v_mfma_f32_32x32x16_bf16 v[96:111], v[60:63], v[52:55], v[96:111]
    s_barrier
    ds_read_b128 v[32:35], v8 offset:16384
    ds_read_b64_tr_b16 v[40:41], v12 offset:24576
    ds_read_b64_tr_b16 v[42:43], v12 offset:25088
    v_mfma_f32_32x32x16_bf16 v[112:127], v[60:63], v[56:59], v[112:127]
    ds_read_b128 v[36:39], v8 offset:20480
    ds_read_b64_tr_b16 v[44:45], v15 offset:28672
    ds_read_b64_tr_b16 v[46:47], v15 offset:29184
    v_mfma_f32_32x32x16_bf16 v[128:143], v[64:67], v[52:55], v[128:143]
    ds_read_b64_tr_b16 v[48:49], v16 offset:28672
    ds_read_b64_tr_b16 v[50:51], v16 offset:29184
    v_mfma_f32_32x32x16_bf16 v[144:159], v[64:67], v[56:59], v[144:159]
    v_mfma_f32_32x32x16_bf16 v[160:175], v[68:71], v[52:55], v[160:175]
    v_mfma_f32_32x32x16_bf16 v[176:191], v[68:71], v[56:59], v[176:191]
    s_waitcnt lgkmcnt(0)
    v_mfma_f32_32x32x16_bf16 v[96:111], v[40:43], v[32:35], v[96:111]
    ds_read_b128 v[52:55], v9 offset:16384
    ds_read_b64_tr_b16 v[60:61], v12 offset:26624
    ds_read_b64_tr_b16 v[62:63], v12 offset:27136
    v_mfma_f32_32x32x16_bf16 v[112:127], v[40:43], v[36:39], v[112:127]
    ds_read_b128 v[56:59], v9 offset:20480
    ds_read_b64_tr_b16 v[64:65], v15 offset:30720
    ds_read_b64_tr_b16 v[66:67], v15 offset:31232
    v_mfma_f32_32x32x16_bf16 v[128:143], v[44:47], v[32:35], v[128:143]
    ds_read_b64_tr_b16 v[68:69], v16 offset:30720
    ds_read_b64_tr_b16 v[70:71], v16 offset:31232
    v_mfma_f32_32x32x16_bf16 v[144:159], v[44:47], v[36:39], v[144:159]
    v_mfma_f32_32x32x16_bf16 v[160:175], v[48:51], v[32:35], v[160:175]
    v_mfma_f32_32x32x16_bf16 v[176:191], v[48:51], v[36:39], v[176:191]
    s_waitcnt lgkmcnt(0)
    v_mfma_f32_32x32x16_bf16 v[96:111], v[60:63], v[52:55], v[96:111]
    s_barrier
    ds_read_b128 v[32:35], v10 offset:16384
    ds_read_b64_tr_b16 v[40:41], v12 offset:36864
    ds_read_b64_tr_b16 v[42:43], v12 offset:37376
    v_mfma_f32_32x32x16_bf16 v[112:127], v[60:63], v[56:59], v[112:127]
    ds_read_b128 v[36:39], v10 offset:20480
    ds_read_b64_tr_b16 v[44:45], v15 offset:40960
    ds_read_b64_tr_b16 v[46:47], v15 offset:41472
    v_mfma_f32_32x32x16_bf16 v[128:143], v[64:67], v[52:55], v[128:143]
    ds_read_b64_tr_b16 v[48:49], v16 offset:40960
    ds_read_b64_tr_b16 v[50:51], v16 offset:41472
    v_mfma_f32_32x32x16_bf16 v[144:159], v[64:67], v[56:59], v[144:159]
    v_mfma_f32_32x32x16_bf16 v[160:175], v[68:71], v[52:55], v[160:175]
    v_mfma_f32_32x32x16_bf16 v[176:191], v[68:71], v[56:59], v[176:191]
    s_waitcnt lgkmcnt(0)
    v_mfma_f32_32x32x16_bf16 v[96:111], v[40:43], v[32:35], v[96:111]
    ds_read_b128 v[52:55], v11 offset:16384
    ds_read_b64_tr_b16 v[60:61], v12 offset:38912
    ds_read_b64_tr_b16 v[62:63], v12 offset:39424
    v_mfma_f32_32x32x16_bf16 v[112:127], v[40:43], v[36:39], v[112:127]
    ds_read_b128 v[56:59], v11 offset:20480
    ds_read_b64_tr_b16 v[64:65], v15 offset:43008
    ds_read_b64_tr_b16 v[66:67], v15 offset:43520
    v_mfma_f32_32x32x16_bf16 v[128:143], v[44:47], v[32:35], v[128:143]
    ds_read_b64_tr_b16 v[68:69], v16 offset:43008
    ds_read_b64_tr_b16 v[70:71], v16 offset:43520
    v_mfma_f32_32x32x16_bf16 v[144:159], v[44:47], v[36:39], v[144:159]
    v_mfma_f32_32x32x16_bf16 v[160:175], v[48:51], v[32:35], v[160:175]
    v_mfma_f32_32x32x16_bf16 v[176:191], v[48:51], v[36:39], v[176:191]
    s_waitcnt lgkmcnt(0)
    v_mfma_f32_32x32x16_bf16 v[96:111], v[60:63], v[52:55], v[96:111]
    s_barrier
    ds_read_b128 v[32:35], v8 offset:32768
    ds_read_b64_tr_b16 v[40:41], v12 offset:0
    ds_read_b64_tr_b16 v[42:43], v12 offset:512
    v_mfma_f32_32x32x16_bf16 v[112:127], v[60:63], v[56:59], v[112:127]
    ds_read_b128 v[36:39], v8 offset:36864
    ds_read_b64_tr_b16 v[44:45], v15 offset:4096
    ds_read_b64_tr_b16 v[46:47], v15 offset:4608
    v_mfma_f32_32x32x16_bf16 v[128:143], v[64:67], v[52:55], v[128:143]
    ds_read_b64_tr_b16 v[48:49], v16 offset:4096
    ds_read_b64_tr_b16 v[50:51], v16 offset:4608
    v_mfma_f32_32x32x16_bf16 v[144:159], v[64:67], v[56:59], v[144:159]
    v_mfma_f32_32x32x16_bf16 v[160:175], v[68:71], v[52:55], v[160:175]
    v_mfma_f32_32x32x16_bf16 v[176:191], v[68:71], v[56:59], v[176:191]
    s_waitcnt lgkmcnt(0)
    v_mfma_f32_32x32x16_bf16 v[96:111], v[40:43], v[32:35], v[96:111]
    ds_read_b128 v[52:55], v9 offset:32768
    ds_read_b64_tr_b16 v[60:61], v12 offset:2048
    ds_read_b64_tr_b16 v[62:63], v12 offset:2560
    v_mfma_f32_32x32x16_bf16 v[112:127], v[40:43], v[36:39], v[112:127]
    ds_read_b128 v[56:59], v9 offset:36864
    ds_read_b64_tr_b16 v[64:65], v15 offset:6144
    ds_read_b64_tr_b16 v[66:67], v15 offset:6656
    v_mfma_f32_32x32x16_bf16 v[128:143], v[44:47], v[32:35], v[128:143]
    ds_read_b64_tr_b16 v[68:69], v16 offset:6144
    ds_read_b64_tr_b16 v[70:71], v16 offset:6656
    v_mfma_f32_32x32x16_bf16 v[144:159], v[44:47], v[36:39], v[144:159]
    v_mfma_f32_32x32x16_bf16 v[160:175], v[48:51], v[32:35], v[160:175]
    v_mfma_f32_32x32x16_bf16 v[176:191], v[48:51], v[36:39], v[176:191]
    s_waitcnt lgkmcnt(0)
    v_mfma_f32_32x32x16_bf16 v[96:111], v[60:63], v[52:55], v[96:111]
    s_barrier
    ds_read_b128 v[32:35], v10 offset:32768
    ds_read_b64_tr_b16 v[40:41], v12 offset:12288
    ds_read_b64_tr_b16 v[42:43], v12 offset:12800
    v_mfma_f32_32x32x16_bf16 v[112:127], v[60:63], v[56:59], v[112:127]
    ds_read_b128 v[36:39], v10 offset:36864
    ds_read_b64_tr_b16 v[44:45], v15 offset:16384
    ds_read_b64_tr_b16 v[46:47], v15 offset:16896
    v_mfma_f32_32x32x16_bf16 v[128:143], v[64:67], v[52:55], v[128:143]
    ds_read_b64_tr_b16 v[48:49], v16 offset:16384
    ds_read_b64_tr_b16 v[50:51], v16 offset:16896
    v_mfma_f32_32x32x16_bf16 v[144:159], v[64:67], v[56:59], v[144:159]
    v_mfma_f32_32x32x16_bf16 v[160:175], v[68:71], v[52:55], v[160:175]
    s_waitcnt vmcnt(0)
    s_mov_b32 s47, 1048576
CA_NONCE:
    v_readfirstlane_b32 s74, v30
    s_nop 0
    s_cmp_lg_u32 s74, 0
    s_cbranch_scc1 CA_NONCE_OK
    s_sleep 2
    buffer_load_dword v30, v31, s[68:71], 0 offen sc1
    s_waitcnt vmcnt(0)
    s_sub_u32 s47, s47, 1
    s_cmp_lg_u32 s47, 0
    s_cbranch_scc1 CA_NONCE
CA_NONCE_OK:
    v_mov_b32 v30, s74
    v_mov_b32 v31, s74
    s_mov_b32 s49, 0
    v_mfma_f32_32x32x16_bf16 v[176:191], v[68:71], v[56:59], v[176:191]
    s_waitcnt lgkmcnt(0)
    v_mfma_f32_32x32x16_bf16 v[96:111], v[40:43], v[32:35], v[96:111]
    ds_read_b128 v[52:55], v11 offset:32768
    ds_read_b64_tr_b16 v[60:61], v12 offset:14336
    ds_read_b64_tr_b16 v[62:63], v12 offset:14848
    v_mfma_f32_32x32x16_bf16 v[112:127], v[40:43], v[36:39], v[112:127]
    ds_read_b128 v[56:59], v11 offset:36864
    ds_read_b64_tr_b16 v[64:65], v15 offset:18432
    ds_read_b64_tr_b16 v[66:67], v15 offset:18944
    v_mfma_f32_32x32x16_bf16 v[128:143], v[44:47], v[32:35], v[128:143]
    ds_read_b64_tr_b16 v[68:69], v16 offset:18432
    ds_read_b64_tr_b16 v[70:71], v16 offset:18944
    v_mfma_f32_32x32x16_bf16 v[144:159], v[44:47], v[36:39], v[144:159]
    v_mfma_f32_32x32x16_bf16 v[160:175], v[48:51], v[32:35], v[160:175]
    v_mfma_f32_32x32x16_bf16 v[176:191], v[48:51], v[36:39], v[176:191]
    s_waitcnt lgkmcnt(0)
    v_mfma_f32_32x32x16_bf16 v[96:111], v[60:63], v[52:55], v[96:111]
    s_barrier
    ds_read_b128 v[32:35], v4 offset:0
    ds_read_b64_tr_b16 v[40:41], v15 offset:24576
    ds_read_b64_tr_b16 v[42:43], v15 offset:25088
    v_mfma_f32_32x32x16_bf16 v[112:127], v[60:63], v[56:59], v[112:127]
    ds_read_b128 v[36:39], v4 offset:4096
    ds_read_b64_tr_b16 v[44:45], v16 offset:24576
    ds_read_b64_tr_b16 v[46:47], v16 offset:25088
    v_mfma_f32_32x32x16_bf16 v[128:143], v[64:67], v[52:55], v[128:143]
    v_mfma_f32_32x32x16_bf16 v[144:159], v[64:67], v[56:59], v[144:159]
    v_mfma_f32_32x32x16_bf16 v[160:175], v[68:71], v[52:55], v[160:175]
    v_mfma_f32_32x32x16_bf16 v[176:191], v[68:71], v[56:59], v[176:191]
    s_waitcnt lgkmcnt(0)
    v_mfma_f32_32x32x16_bf16 v[192:207], v[40:43], v[32:35], 0
    s_barrier
    ds_read_b128 v[48:51], v5 offset:0
    ds_read_b64_tr_b16 v[56:57], v15 offset:26624
    ds_read_b64_tr_b16 v[58:59], v15 offset:27136
    ds_read_b128 v[52:55], v5 offset:4096
    s_add_u32 s44, s39, 0
    s_lshl_b32 s44, s44, s42
    s_add_u32 s44, s44, s43
    v_pk_mul_f32 v[96:97], v[96:97], s[92:93]
    v_pk_mul_f32 v[98:99], v[98:99], s[92:93]
    v_pk_mul_f32 v[100:101], v[100:101], s[92:93]
    v_pk_mul_f32 v[102:103], v[102:103], s[92:93]
    v_cvt_pk_bf16_f32 v80, v96, v97
    v_cvt_pk_bf16_f32 v81, v98, v99
    v_cvt_pk_bf16_f32 v82, v100, v101
    v_cvt_pk_bf16_f32 v83, v102, v103
    buffer_store_dwordx4 v[80:83], v2, s[24:27], s44 offen offset:0 sc1
    v_pk_mul_f32 v[104:105], v[104:105], s[92:93]
    v_pk_mul_f32 v[106:107], v[106:107], s[92:93]
    v_pk_mul_f32 v[108:109], v[108:109], s[92:93]
    v_pk_mul_f32 v[110:111], v[110:111], s[92:93]
    v_cvt_pk_bf16_f32 v84, v104, v105
    v_cvt_pk_bf16_f32 v85, v106, v107
    v_cvt_pk_bf16_f32 v86, v108, v109
    v_cvt_pk_bf16_f32 v87, v110, v111
    v_cndmask_b32 v86, v86, v18, s[50:51]
    v_cndmask_b32 v87, v87, v19, s[50:51]
    buffer_store_dwordx4 v[84:87], v2, s[24:27], s44 offen offset:1024 sc1
    s_add_u32 s44, s39, 1
    s_lshl_b32 s44, s44, s42
    s_add_u32 s44, s44, s43
    v_pk_mul_f32 v[112:113], v[112:113], s[92:93]
    v_pk_mul_f32 v[114:115], v[114:115], s[92:93]
    v_pk_mul_f32 v[116:117], v[116:117], s[92:93]
    v_pk_mul_f32 v[118:119], v[118:119], s[92:93]
    v_cvt_pk_bf16_f32 v88, v112, v113
    v_cvt_pk_bf16_f32 v89, v114, v115
    v_cvt_pk_bf16_f32 v90, v116, v117
    v_cvt_pk_bf16_f32 v91, v118, v119
    buffer_store_dwordx4 v[88:91], v2, s[24:27], s44 offen offset:0 sc1
    v_pk_mul_f32 v[120:121], v[120:121], s[92:93]
    v_pk_mul_f32 v[122:123], v[122:123], s[92:93]
    v_pk_mul_f32 v[124:125], v[124:125], s[92:93]
    v_pk_mul_f32 v[126:127], v[126:127], s[92:93]
    v_cvt_pk_bf16_f32 v92, v120, v121
    v_cvt_pk_bf16_f32 v93, v122, v123
    v_cvt_pk_bf16_f32 v94, v124, v125
    v_cvt_pk_bf16_f32 v95, v126, v127
    v_cndmask_b32 v94, v94, v18, s[50:51]
    v_cndmask_b32 v95, v95, v19, s[50:51]
    buffer_store_dwordx4 v[92:95], v2, s[24:27], s44 offen offset:1024 sc1
    v_max_f32 v128, 0, v128
    v_max_f32 v129, 0, v129
    v_max_f32 v130, 0, v130
    v_max_f32 v131, 0, v131
    v_max_f32 v132, 0, v132
    v_max_f32 v133, 0, v133
    v_max_f32 v134, 0, v134
    v_max_f32 v135, 0, v135
    v_mul_f32 v128, v128, v136
    v_mul_f32 v129, v129, v137
    v_mul_f32 v130, v130, v138
    v_mul_f32 v131, v131, v139
    v_mul_f32 v132, v132, v140
    v_mul_f32 v133, v133, v141
    v_mul_f32 v134, v134, v142
    v_mul_f32 v135, v135, v143
    v_mfma_f32_32x32x16_bf16 v[208:223], v[40:43], v[36:39], 0
    ds_read_b64_tr_b16 v[60:61], v16 offset:26624
    ds_read_b64_tr_b16 v[62:63], v16 offset:27136
    ds_read_b128 v[64:67], v6 offset:0
    ds_read_b64_tr_b16 v[72:73], v15 offset:32768
    v_cvt_pk_bf16_f32 v80, v128, v129
    v_mfma_f32_32x32x16_bf16 v[224:239], v[44:47], v[32:35], 0
    ds_read_b64_tr_b16 v[74:75], v15 offset:33280
    ds_read_b128 v[68:71], v6 offset:4096
    ds_read_b64_tr_b16 v[76:77], v16 offset:32768
    ds_read_b64_tr_b16 v[78:79], v16 offset:33280
    v_cvt_pk_bf16_f32 v81, v130, v131
    v_mfma_f32_32x32x16_bf16 v[240:255], v[44:47], v[36:39], 0
    v_cvt_pk_bf16_f32 v82, v132, v133
    v_cvt_pk_bf16_f32 v83, v134, v135
    v_max_f32 v144, 0, v144
    v_max_f32 v145, 0, v145
    v_max_f32 v146, 0, v146
    s_waitcnt lgkmcnt(6)
    v_mfma_f32_32x32x16_bf16 v[192:207], v[56:59], v[48:51], v[192:207]
    ds_read_b128 v[32:35], v7 offset:0
    ds_read_b64_tr_b16 v[40:41], v15 offset:34816
    ds_read_b64_tr_b16 v[42:43], v15 offset:35328
    v_max_f32 v147, 0, v147
    v_max_f32 v148, 0, v148
    v_mfma_f32_32x32x16_bf16 v[208:223], v[56:59], v[52:55], v[208:223]
    ds_read_b128 v[36:39], v7 offset:4096
    ds_read_b64_tr_b16 v[44:45], v16 offset:34816
    ds_read_b64_tr_b16 v[46:47], v16 offset:35328
    v_max_f32 v149, 0, v149
    v_max_f32 v150, 0, v150
    v_mfma_f32_32x32x16_bf16 v[224:239], v[60:63], v[48:51], v[224:239]
    v_max_f32 v151, 0, v151
    v_mul_f32 v144, v144, v152
    v_mul_f32 v145, v145, v153
    v_mul_f32 v146, v146, v154
    v_mul_f32 v147, v147, v155
    v_mfma_f32_32x32x16_bf16 v[240:255], v[60:63], v[52:55], v[240:255]
    v_mul_f32 v148, v148, v156
    v_mul_f32 v149, v149, v157
    v_mul_f32 v150, v150, v158
    v_mul_f32 v151, v151, v159
    v_cvt_pk_bf16_f32 v84, v144, v145
    s_waitcnt lgkmcnt(6)
    v_mfma_f32_32x32x16_bf16 v[192:207], v[72:75], v[64:67], v[192:207]
    s_barrier
    ds_read_b128 v[48:51], v4 offset:16384
    ds_read_b64_tr_b16 v[56:57], v15 offset:40960
    ds_read_b64_tr_b16 v[58:59], v15 offset:41472
    v_cvt_pk_bf16_f32 v85, v146, v147
    v_cvt_pk_bf16_f32 v86, v148, v149
    v_mfma_f32_32x32x16_bf16 v[208:223], v[72:75], v[68:71], v[208:223]
    ds_read_b128 v[52:55], v4 offset:20480
    ds_read_b64_tr_b16 v[60:61], v16 offset:40960
    ds_read_b64_tr_b16 v[62:63], v16 offset:41472
    v_cvt_pk_bf16_f32 v87, v150, v151
    v_max_f32 v160, 0, v160
    s_getreg_b32 s45, hwreg(HW_REG_IB_STS, 0, 4)
    v_mfma_f32_32x32x16_bf16 v[224:239], v[76:79], v[64:67], v[224:239]
    v_max_f32 v161, 0, v161
    v_max_f32 v162, 0, v162
    v_max_f32 v163, 0, v163
    v_max_f32 v164, 0, v164
    v_max_f32 v165, 0, v165
    s_or_b32 s45, s45, s49
    v_mfma_f32_32x32x16_bf16 v[240:255], v[76:79], v[68:71], v[240:255]
    v_max_f32 v166, 0, v166
    v_max_f32 v167, 0, v167
    v_mul_f32 v160, v160, v168
    v_mul_f32 v161, v161, v169
    v_mul_f32 v162, v162, v170
    s_cbranch_scc0 CA_PUB30
CA_PUBR30:
    s_waitcnt lgkmcnt(6)
    v_mfma_f32_32x32x16_bf16 v[192:207], v[40:43], v[32:35], v[192:207]
    ds_read_b128 v[64:67], v5 offset:16384
    ds_read_b64_tr_b16 v[72:73], v15 offset:43008
    ds_read_b64_tr_b16 v[74:75], v15 offset:43520
    v_mul_f32 v163, v163, v171
    v_mul_f32 v164, v164, v172
    v_mfma_f32_32x32x16_bf16 v[208:223], v[40:43], v[36:39], v[208:223]
    ds_read_b128 v[68:71], v5 offset:20480
    ds_read_b64_tr_b16 v[76:77], v16 offset:43008
    ds_read_b64_tr_b16 v[78:79], v16 offset:43520
    v_mul_f32 v165, v165, v173
    v_mul_f32 v166, v166, v174
    s_getreg_b32 s45, hwreg(HW_REG_IB_STS, 0, 4)
    v_mfma_f32_32x32x16_bf16 v[224:239], v[44:47], v[32:35], v[224:239]
    v_mul_f32 v167, v167, v175
    v_cvt_pk_bf16_f32 v88, v160, v161
    v_cvt_pk_bf16_f32 v89, v162, v163
    v_cvt_pk_bf16_f32 v90, v164, v165
    v_cvt_pk_bf16_f32 v91, v166, v167
    s_or_b32 s45, s45, s49
    v_mfma_f32_32x32x16_bf16 v[240:255], v[44:47], v[36:39], v[240:255]
    v_max_f32 v176, 0, v176
    v_max_f32 v177, 0, v177
    v_max_f32 v178, 0, v178
    v_max_f32 v179, 0, v179
    v_max_f32 v180, 0, v180
    s_cbranch_scc0 CA_PUB31
CA_PUBR31:
    s_waitcnt lgkmcnt(6)
    v_mfma_f32_32x32x16_bf16 v[192:207], v[56:59], v[48:51], v[192:207]
    s_barrier
    ds_read_b128 v[32:35], v6 offset:16384
    ds_read_b64_tr_b16 v[40:41], v15 offset:0
    ds_read_b64_tr_b16 v[42:43], v15 offset:512
    v_max_f32 v181, 0, v181
    v_max_f32 v182, 0, v182
    v_mfma_f32_32x32x16_bf16 v[208:223], v[56:59], v[52:55], v[208:223]
    ds_read_b128 v[36:39], v6 offset:20480
    ds_read_b64_tr_b16 v[44:45], v16 offset:0
    ds_read_b64_tr_b16 v[46:47], v16 offset:512
    v_max_f32 v183, 0, v183
    v_mul_f32 v176, v176, v184
    s_getreg_b32 s45, hwreg(HW_REG_IB_STS, 0, 4)
    v_mfma_f32_32x32x16_bf16 v[224:239], v[60:63], v[48:51], v[224:239]
    v_mul_f32 v177, v177, v185
    v_mul_f32 v178, v178, v186
    v_mul_f32 v179, v179, v187
    v_mul_f32 v180, v180, v188
    v_mul_f32 v181, v181, v189
    s_or_b32 s45, s45, s49
    v_mfma_f32_32x32x16_bf16 v[240:255], v[60:63], v[52:55], v[240:255]
    v_mul_f32 v182, v182, v190
    v_mul_f32 v183, v183, v191
    v_cvt_pk_bf16_f32 v92, v176, v177
    v_cvt_pk_bf16_f32 v93, v178, v179
    v_cvt_pk_bf16_f32 v94, v180, v181
    s_cbranch_scc0 CA_PUB32
CA_PUBR32:
    s_waitcnt lgkmcnt(6)
    v_mfma_f32_32x32x16_bf16 v[192:207], v[72:75], v[64:67], v[192:207]
    ds_read_b128 v[48:51], v7 offset:16384
    ds_read_b64_tr_b16 v[56:57], v15 offset:2048
    ds_read_b64_tr_b16 v[58:59], v15 offset:2560
    v_cvt_pk_bf16_f32 v95, v182, v183
    v_mfma_f32_32x32x16_bf16 v[208:223], v[72:75], v[68:71], v[208:223]
    ds_read_b128 v[52:55], v7 offset:20480
    ds_read_b64_tr_b16 v[60:61], v16 offset:2048
    ds_read_b64_tr_b16 v[62:63], v16 offset:2560
    s_getreg_b32 s45, hwreg(HW_REG_IB_STS, 0, 4)
    v_mfma_f32_32x32x16_bf16 v[224:239], v[76:79], v[64:67], v[224:239]
    s_or_b32 s45, s45, s49
    v_mfma_f32_32x32x16_bf16 v[240:255], v[76:79], v[68:71], v[240:255]
    s_cbranch_scc0 CA_PUB33
CA_PUBR33:
    s_waitcnt lgkmcnt(6)
    v_mfma_f32_32x32x16_bf16 v[192:207], v[40:43], v[32:35], v[192:207]
    s_barrier
    ds_read_b128 v[64:67], v4 offset:32768
    ds_read_b64_tr_b16 v[72:73], v15 offset:8192
    ds_read_b64_tr_b16 v[74:75], v15 offset:8704
    v_mfma_f32_32x32x16_bf16 v[208:223], v[40:43], v[36:39], v[208:223]
    ds_read_b128 v[68:71], v4 offset:36864
    ds_read_b64_tr_b16 v[76:77], v16 offset:8192
    ds_read_b64_tr_b16 v[78:79], v16 offset:8704
    s_getreg_b32 s45, hwreg(HW_REG_IB_STS, 0, 4)
    v_mfma_f32_32x32x16_bf16 v[224:239], v[44:47], v[32:35], v[224:239]
    s_or_b32 s45, s45, s49
    v_mfma_f32_32x32x16_bf16 v[240:255], v[44:47], v[36:39], v[240:255]
    s_cbranch_scc0 CA_PUB34
CA_PUBR34:
    s_waitcnt lgkmcnt(6)
    v_mfma_f32_32x32x16_bf16 v[192:207], v[56:59], v[48:51], v[192:207]
    ds_read_b128 v[32:35], v5 offset:32768
    ds_read_b64_tr_b16 v[40:41], v15 offset:10240
    ds_read_b64_tr_b16 v[42:43], v15 offset:10752
    v_mfma_f32_32x32x16_bf16 v[208:223], v[56:59], v[52:55], v[208:223]
    ds_read_b128 v[36:39], v5 offset:36864
    ds_read_b64_tr_b16 v[44:45], v16 offset:10240
    ds_read_b64_tr_b16 v[46:47], v16 offset:10752
    s_getreg_b32 s45, hwreg(HW_REG_IB_STS, 0, 4)
    v_mfma_f32_32x32x16_bf16 v[224:239], v[60:63], v[48:51], v[224:239]
    s_or_b32 s45, s45, s49
    v_mfma_f32_32x32x16_bf16 v[240:255], v[60:63], v[52:55], v[240:255]
    s_cbranch_scc0 CA_PUB35
CA_PUBR35:
    s_waitcnt lgkmcnt(6)
    v_mfma_f32_32x32x16_bf16 v[192:207], v[72:75], v[64:67], v[192:207]
    s_barrier
    ds_read_b128 v[48:51], v6 offset:32768
    ds_read_b64_tr_b16 v[56:57], v15 offset:16384
    ds_read_b64_tr_b16 v[58:59], v15 offset:16896
    v_mfma_f32_32x32x16_bf16 v[208:223], v[72:75], v[68:71], v[208:223]
    ds_read_b128 v[52:55], v6 offset:36864
    ds_read_b64_tr_b16 v[60:61], v16 offset:16384
    ds_read_b64_tr_b16 v[62:63], v16 offset:16896
    s_getreg_b32 s45, hwreg(HW_REG_IB_STS, 0, 4)
    v_mfma_f32_32x32x16_bf16 v[224:239], v[76:79], v[64:67], v[224:239]
    s_or_b32 s45, s45, s49
    v_mfma_f32_32x32x16_bf16 v[240:255], v[76:79], v[68:71], v[240:255]
    s_cbranch_scc0 CA_PUB36
CA_PUBR36:
    s_waitcnt lgkmcnt(6)
    v_mfma_f32_32x32x16_bf16 v[192:207], v[40:43], v[32:35], v[192:207]
    ds_read_b128 v[64:67], v7 offset:32768
    ds_read_b64_tr_b16 v[72:73], v15 offset:18432
    ds_read_b64_tr_b16 v[74:75], v15 offset:18944
    v_mfma_f32_32x32x16_bf16 v[208:223], v[40:43], v[36:39], v[208:223]
    ds_read_b128 v[68:71], v7 offset:36864
    ds_read_b64_tr_b16 v[76:77], v16 offset:18432
    ds_read_b64_tr_b16 v[78:79], v16 offset:18944
    s_getreg_b32 s45, hwreg(HW_REG_IB_STS, 0, 4)
    v_mfma_f32_32x32x16_bf16 v[224:239], v[44:47], v[32:35], v[224:239]
    s_or_b32 s45, s45, s49
    v_mfma_f32_32x32x16_bf16 v[240:255], v[44:47], v[36:39], v[240:255]
    s_cbranch_scc0 CA_PUB37
CA_PUBR37:
    s_waitcnt lgkmcnt(6)
    v_mfma_f32_32x32x16_bf16 v[192:207], v[56:59], v[48:51], v[192:207]
    s_barrier
    ds_read_b128 v[32:35], v4 offset:49152
    ds_read_b64_tr_b16 v[40:41], v15 offset:24576
    ds_read_b64_tr_b16 v[42:43], v15 offset:25088
    v_mfma_f32_32x32x16_bf16 v[208:223], v[56:59], v[52:55], v[208:223]
    ds_read_b128 v[36:39], v4 offset:53248
    ds_read_b64_tr_b16 v[44:45], v16 offset:24576
    ds_read_b64_tr_b16 v[46:47], v16 offset:25088
    s_getreg_b32 s45, hwreg(HW_REG_IB_STS, 0, 4)
    v_mfma_f32_32x32x16_bf16 v[224:239], v[60:63], v[48:51], v[224:239]
    s_or_b32 s45, s45, s49
    v_mfma_f32_32x32x16_bf16 v[240:255], v[60:63], v[52:55], v[240:255]
    s_cbranch_scc0 CA_PUB38
CA_PUBR38:
    s_waitcnt lgkmcnt(6)
    v_mfma_f32_32x32x16_bf16 v[192:207], v[72:75], v[64:67], v[192:207]
    ds_read_b128 v[48:51], v5 offset:49152
    ds_read_b64_tr_b16 v[56:57], v15 offset:26624
    ds_read_b64_tr_b16 v[58:59], v15 offset:27136
    v_mfma_f32_32x32x16_bf16 v[208:223], v[72:75], v[68:71], v[208:223]
    ds_read_b128 v[52:55], v5 offset:53248
    ds_read_b64_tr_b16 v[60:61], v16 offset:26624
    ds_read_b64_tr_b16 v[62:63], v16 offset:27136
    s_getreg_b32 s45, hwreg(HW_REG_IB_STS, 0, 4)
    v_mfma_f32_32x32x16_bf16 v[224:239], v[76:79], v[64:67], v[224:239]
    s_or_b32 s45, s45, s49
    v_mfma_f32_32x32x16_bf16 v[240:255], v[76:79], v[68:71], v[240:255]
    s_cbranch_scc0 CA_PUB39
CA_PUBR39:
    s_waitcnt lgkmcnt(6)
    v_mfma_f32_32x32x16_bf16 v[192:207], v[40:43], v[32:35], v[192:207]
    s_barrier
    ds_read_b128 v[64:67], v6 offset:49152
    ds_read_b64_tr_b16 v[72:73], v15 offset:32768
    ds_read_b64_tr_b16 v[74:75], v15 offset:33280
    v_mfma_f32_32x32x16_bf16 v[208:223], v[40:43], v[36:39], v[208:223]
    ds_read_b128 v[68:71], v6 offset:53248
    ds_read_b64_tr_b16 v[76:77], v16 offset:32768
    ds_read_b64_tr_b16 v[78:79], v16 offset:33280
    s_getreg_b32 s45, hwreg(HW_REG_IB_STS, 0, 4)
    v_mfma_f32_32x32x16_bf16 v[224:239], v[44:47], v[32:35], v[224:239]
    s_or_b32 s45, s45, s49
    v_mfma_f32_32x32x16_bf16 v[240:255], v[44:47], v[36:39], v[240:255]
    s_cbranch_scc0 CA_PUB40
CA_PUBR40:
    s_waitcnt lgkmcnt(6)
    v_mfma_f32_32x32x16_bf16 v[192:207], v[56:59], v[48:51], v[192:207]
    ds_read_b128 v[32:35], v7 offset:49152
    ds_read_b64_tr_b16 v[40:41], v15 offset:34816
    ds_read_b64_tr_b16 v[42:43], v15 offset:35328
    v_mfma_f32_32x32x16_bf16 v[208:223], v[56:59], v[52:55], v[208:223]
    ds_read_b128 v[36:39], v7 offset:53248
    ds_read_b64_tr_b16 v[44:45], v16 offset:34816
    ds_read_b64_tr_b16 v[46:47], v16 offset:35328
    s_getreg_b32 s45, hwreg(HW_REG_IB_STS, 0, 4)
    v_mfma_f32_32x32x16_bf16 v[224:239], v[60:63], v[48:51], v[224:239]
    s_or_b32 s45, s45, s49
    v_mfma_f32_32x32x16_bf16 v[240:255], v[60:63], v[52:55], v[240:255]
    s_cbranch_scc0 CA_PUB41
CA_PUBR41:
    s_waitcnt lgkmcnt(6)
    v_mfma_f32_32x32x16_bf16 v[192:207], v[72:75], v[64:67], v[192:207]
    s_barrier
    ds_read_b128 v[48:51], v8 offset:0
    ds_read_b64_tr_b16 v[56:57], v15 offset:40960
    ds_read_b64_tr_b16 v[58:59], v15 offset:41472
    v_mfma_f32_32x32x16_bf16 v[208:223], v[72:75], v[68:71], v[208:223]
    ds_read_b128 v[52:55], v8 offset:4096
    ds_read_b64_tr_b16 v[60:61], v16 offset:40960
    ds_read_b64_tr_b16 v[62:63], v16 offset:41472
    s_getreg_b32 s45, hwreg(HW_REG_IB_STS, 0, 4)
    v_mfma_f32_32x32x16_bf16 v[224:239], v[76:79], v[64:67], v[224:239]
    s_or_b32 s45, s45, s49
    v_mfma_f32_32x32x16_bf16 v[240:255], v[76:79], v[68:71], v[240:255]
    s_cbranch_scc0 CA_PUB42
CA_PUBR42:
    s_waitcnt lgkmcnt(6)
    v_mfma_f32_32x32x16_bf16 v[192:207], v[40:43], v[32:35], v[192:207]
    ds_read_b128 v[64:67], v9 offset:0
    ds_read_b64_tr_b16 v[72:73], v15 offset:43008
    ds_read_b64_tr_b16 v[74:75], v15 offset:43520
    v_mfma_f32_32x32x16_bf16 v[208:223], v[40:43], v[36:39], v[208:223]
    ds_read_b128 v[68:71], v9 offset:4096
    ds_read_b64_tr_b16 v[76:77], v16 offset:43008
    ds_read_b64_tr_b16 v[78:79], v16 offset:43520
    s_getreg_b32 s45, hwreg(HW_REG_IB_STS, 0, 4)
    v_mfma_f32_32x32x16_bf16 v[224:239], v[44:47], v[32:35], v[224:239]
    s_or_b32 s45, s45, s49
    v_mfma_f32_32x32x16_bf16 v[240:255], v[44:47], v[36:39], v[240:255]
    s_cbranch_scc0 CA_PUB43
CA_PUBR43:
    s_waitcnt lgkmcnt(6)
    v_mfma_f32_32x32x16_bf16 v[192:207], v[56:59], v[48:51], v[192:207]
    s_barrier
    ds_read_b128 v[32:35], v10 offset:0
    ds_read_b64_tr_b16 v[40:41], v15 offset:0
    ds_read_b64_tr_b16 v[42:43], v15 offset:512
    v_mfma_f32_32x32x16_bf16 v[208:223], v[56:59], v[52:55], v[208:223]
    ds_read_b128 v[36:39], v10 offset:4096
    ds_read_b64_tr_b16 v[44:45], v16 offset:0
    ds_read_b64_tr_b16 v[46:47], v16 offset:512
    s_getreg_b32 s45, hwreg(HW_REG_IB_STS, 0, 4)
    v_mfma_f32_32x32x16_bf16 v[224:239], v[60:63], v[48:51], v[224:239]
    s_or_b32 s45, s45, s49
    v_mfma_f32_32x32x16_bf16 v[240:255], v[60:63], v[52:55], v[240:255]
    s_cbranch_scc0 CA_PUB44
CA_PUBR44:
    s_waitcnt lgkmcnt(6)
    v_mfma_f32_32x32x16_bf16 v[192:207], v[72:75], v[64:67], v[192:207]
    ds_read_b128 v[48:51], v11 offset:0
    ds_read_b64_tr_b16 v[56:57], v15 offset:2048
    ds_read_b64_tr_b16 v[58:59], v15 offset:2560
    v_mfma_f32_32x32x16_bf16 v[208:223], v[72:75], v[68:71], v[208:223]
    ds_read_b128 v[52:55], v11 offset:4096
    ds_read_b64_tr_b16 v[60:61], v16 offset:2048
    ds_read_b64_tr_b16 v[62:63], v16 offset:2560
    s_getreg_b32 s45, hwreg(HW_REG_IB_STS, 0, 4)
    v_mfma_f32_32x32x16_bf16 v[224:239], v[76:79], v[64:67], v[224:239]
    s_or_b32 s45, s45, s49
    v_mfma_f32_32x32x16_bf16 v[240:255], v[76:79], v[68:71], v[240:255]
    s_cbranch_scc0 CA_PUB45
CA_PUBR45:
    s_waitcnt lgkmcnt(6)
    v_mfma_f32_32x32x16_bf16 v[192:207], v[40:43], v[32:35], v[192:207]
    s_barrier
    ds_read_b128 v[64:67], v8 offset:16384
    ds_read_b64_tr_b16 v[72:73], v15 offset:8192
    ds_read_b64_tr_b16 v[74:75], v15 offset:8704
    v_mfma_f32_32x32x16_bf16 v[208:223], v[40:43], v[36:39], v[208:223]
    ds_read_b128 v[68:71], v8 offset:20480
    ds_read_b64_tr_b16 v[76:77], v16 offset:8192
    ds_read_b64_tr_b16 v[78:79], v16 offset:8704
    s_getreg_b32 s45, hwreg(HW_REG_IB_STS, 0, 4)
    v_mfma_f32_32x32x16_bf16 v[224:239], v[44:47], v[32:35], v[224:239]
    s_or_b32 s45, s45, s49
    v_mfma_f32_32x32x16_bf16 v[240:255], v[44:47], v[36:39], v[240:255]
    s_cbranch_scc0 CA_PUB46
CA_PUBR46:
    s_waitcnt lgkmcnt(6)
    v_mfma_f32_32x32x16_bf16 v[192:207], v[56:59], v[48:51], v[192:207]
    ds_read_b128 v[32:35], v9 offset:16384
    ds_read_b64_tr_b16 v[40:41], v15 offset:10240
    ds_read_b64_tr_b16 v[42:43], v15 offset:10752
    v_mfma_f32_32x32x16_bf16 v[208:223], v[56:59], v[52:55], v[208:223]
    ds_read_b128 v[36:39], v9 offset:20480
    ds_read_b64_tr_b16 v[44:45], v16 offset:10240
    ds_read_b64_tr_b16 v[46:47], v16 offset:10752
    s_getreg_b32 s45, hwreg(HW_REG_IB_STS, 0, 4)
    v_mfma_f32_32x32x16_bf16 v[224:239], v[60:63], v[48:51], v[224:239]
    s_or_b32 s45, s45, s49
    v_mfma_f32_32x32x16_bf16 v[240:255], v[60:63], v[52:55], v[240:255]
    s_cbranch_scc0 CA_PUB47
CA_PUBR47:
    s_waitcnt lgkmcnt(6)
    v_mfma_f32_32x32x16_bf16 v[192:207], v[72:75], v[64:67], v[192:207]
    s_barrier
    ds_read_b128 v[48:51], v10 offset:16384
    ds_read_b64_tr_b16 v[56:57], v15 offset:16384
    ds_read_b64_tr_b16 v[58:59], v15 offset:16896
    v_mfma_f32_32x32x16_bf16 v[208:223], v[72:75], v[68:71], v[208:223]
    ds_read_b128 v[52:55], v10 offset:20480
    ds_read_b64_tr_b16 v[60:61], v16 offset:16384
    ds_read_b64_tr_b16 v[62:63], v16 offset:16896
    s_getreg_b32 s45, hwreg(HW_REG_IB_STS, 0, 4)
    v_mfma_f32_32x32x16_bf16 v[224:239], v[76:79], v[64:67], v[224:239]
    s_or_b32 s45, s45, s49
    v_mfma_f32_32x32x16_bf16 v[240:255], v[76:79], v[68:71], v[240:255]
    s_cbranch_scc0 CA_PUB48
CA_PUBR48:
    s_waitcnt lgkmcnt(6)
    v_mfma_f32_32x32x16_bf16 v[192:207], v[40:43], v[32:35], v[192:207]
    ds_read_b128 v[64:67], v11 offset:16384
    ds_read_b64_tr_b16 v[72:73], v15 offset:18432
    ds_read_b64_tr_b16 v[74:75], v15 offset:18944
    v_mfma_f32_32x32x16_bf16 v[208:223], v[40:43], v[36:39], v[208:223]
    ds_read_b128 v[68:71], v11 offset:20480
    ds_read_b64_tr_b16 v[76:77], v16 offset:18432
    ds_read_b64_tr_b16 v[78:79], v16 offset:18944
    s_getreg_b32 s45, hwreg(HW_REG_IB_STS, 0, 4)
    v_mfma_f32_32x32x16_bf16 v[224:239], v[44:47], v[32:35], v[224:239]
    s_or_b32 s45, s45, s49
    v_mfma_f32_32x32x16_bf16 v[240:255], v[44:47], v[36:39], v[240:255]
    s_cbranch_scc0 CA_PUB49
CA_PUBR49:
    s_waitcnt lgkmcnt(6)
    v_mfma_f32_32x32x16_bf16 v[192:207], v[56:59], v[48:51], v[192:207]
    s_barrier
    ds_read_b128 v[32:35], v8 offset:32768
    ds_read_b64_tr_b16 v[40:41], v15 offset:24576
    ds_read_b64_tr_b16 v[42:43], v15 offset:25088
    v_mfma_f32_32x32x16_bf16 v[208:223], v[56:59], v[52:55], v[208:223]
    ds_read_b128 v[36:39], v8 offset:36864
    ds_read_b64_tr_b16 v[44:45], v16 offset:24576
    ds_read_b64_tr_b16 v[46:47], v16 offset:25088
    s_getreg_b32 s45, hwreg(HW_REG_IB_STS, 0, 4)
    v_mfma_f32_32x32x16_bf16 v[224:239], v[60:63], v[48:51], v[224:239]
    s_or_b32 s45, s45, s49
    v_mfma_f32_32x32x16_bf16 v[240:255], v[60:63], v[52:55], v[240:255]
    s_cbranch_scc0 CA_PUB50
CA_PUBR50:
    s_waitcnt lgkmcnt(6)
    v_mfma_f32_32x32x16_bf16 v[192:207], v[72:75], v[64:67], v[192:207]
    ds_read_b128 v[48:51], v9 offset:32768
    ds_read_b64_tr_b16 v[56:57], v15 offset:26624
    ds_read_b64_tr_b16 v[58:59], v15 offset:27136
    v_mfma_f32_32x32x16_bf16 v[208:223], v[72:75], v[68:71], v[208:223]
    ds_read_b128 v[52:55], v9 offset:36864
    ds_read_b64_tr_b16 v[60:61], v16 offset:26624
    ds_read_b64_tr_b16 v[62:63], v16 offset:27136
    s_getreg_b32 s45, hwreg(HW_REG_IB_STS, 0, 4)
    v_mfma_f32_32x32x16_bf16 v[224:239], v[76:79], v[64:67], v[224:239]
    s_or_b32 s45, s45, s49
    v_mfma_f32_32x32x16_bf16 v[240:255], v[76:79], v[68:71], v[240:255]
    s_cbranch_scc0 CA_PUB51
CA_PUBR51:
    s_waitcnt lgkmcnt(6)
    v_mfma_f32_32x32x16_bf16 v[192:207], v[40:43], v[32:35], v[192:207]
    s_barrier
    ds_read_b128 v[64:67], v10 offset:32768
    ds_read_b64_tr_b16 v[72:73], v15 offset:32768
    ds_read_b64_tr_b16 v[74:75], v15 offset:33280
    v_mfma_f32_32x32x16_bf16 v[208:223], v[40:43], v[36:39], v[208:223]
    ds_read_b128 v[68:71], v10 offset:36864
    ds_read_b64_tr_b16 v[76:77], v16 offset:32768
    ds_read_b64_tr_b16 v[78:79], v16 offset:33280
    s_getreg_b32 s45, hwreg(HW_REG_IB_STS, 0, 4)
    v_mfma_f32_32x32x16_bf16 v[224:239], v[44:47], v[32:35], v[224:239]
    s_or_b32 s45, s45, s49
    v_mfma_f32_32x32x16_bf16 v[240:255], v[44:47], v[36:39], v[240:255]
    s_cbranch_scc0 CA_PUB52
CA_PUBR52:
    s_waitcnt lgkmcnt(6)
    v_mfma_f32_32x32x16_bf16 v[192:207], v[56:59], v[48:51], v[192:207]
    ds_read_b128 v[32:35], v11 offset:32768
    ds_read_b64_tr_b16 v[40:41], v15 offset:34816
    ds_read_b64_tr_b16 v[42:43], v15 offset:35328
    v_mfma_f32_32x32x16_bf16 v[208:223], v[56:59], v[52:55], v[208:223]
    ds_read_b128 v[36:39], v11 offset:36864
    ds_read_b64_tr_b16 v[44:45], v16 offset:34816
    ds_read_b64_tr_b16 v[46:47], v16 offset:35328
    s_getreg_b32 s45, hwreg(HW_REG_IB_STS, 0, 4)
    v_mfma_f32_32x32x16_bf16 v[224:239], v[60:63], v[48:51], v[224:239]
    s_or_b32 s45, s45, s49
    v_mfma_f32_32x32x16_bf16 v[240:255], v[60:63], v[52:55], v[240:255]
    s_cbranch_scc0 CA_PUB53
CA_PUBR53:
    s_waitcnt lgkmcnt(6)
    v_mfma_f32_32x32x16_bf16 v[192:207], v[72:75], v[64:67], v[192:207]
    v_mfma_f32_32x32x16_bf16 v[208:223], v[72:75], v[68:71], v[208:223]
    s_cmp_lg_u32 s49, 0
    s_cbranch_scc1 CA_W54
    s_waitcnt vmcnt(0)
CA_W54:
    s_getreg_b32 s45, hwreg(HW_REG_IB_STS, 0, 4)
    v_mfma_f32_32x32x16_bf16 v[224:239], v[76:79], v[64:67], v[224:239]
    s_or_b32 s45, s45, s49
    v_mfma_f32_32x32x16_bf16 v[240:255], v[76:79], v[68:71], v[240:255]
    s_cbranch_scc0 CA_PUB54
CA_PUBR54:
    s_waitcnt lgkmcnt(0)
    v_mfma_f32_32x32x16_bf16 v[192:207], v[40:43], v[32:35], v[192:207]
    v_mfma_f32_32x32x16_bf16 v[208:223], v[40:43], v[36:39], v[208:223]
    v_mfma_f32_32x32x16_bf16 v[224:239], v[44:47], v[32:35], v[224:239]
    v_mfma_f32_32x32x16_bf16 v[240:255], v[44:47], v[36:39], v[240:255]
    s_branch ROLE_A
CA_PUB30:
    s_mov_b64 exec, 0xffff
    buffer_store_dwordx2 v[30:31], v17, s[24:27], s48 offen sc1
    s_mov_b64 exec, -1
    s_mov_b32 s49, 1
    s_branch CA_PUBR30
CA_PUB31:
    s_mov_b64 exec, 0xffff
    buffer_store_dwordx2 v[30:31], v17, s[24:27], s48 offen sc1
    s_mov_b64 exec, -1
    s_mov_b32 s49, 1
    s_branch CA_PUBR31
CA_PUB32:
    s_mov_b64 exec, 0xffff
    buffer_store_dwordx2 v[30:31], v17, s[24:27], s48 offen sc1
    s_mov_b64 exec, -1
    s_mov_b32 s49, 1
    s_branch CA_PUBR32
CA_PUB33:
    s_mov_b64 exec, 0xffff
    buffer_store_dwordx2 v[30:31], v17, s[24:27], s48 offen sc1
    s_mov_b64 exec, -1
    s_mov_b32 s49, 1
    s_branch CA_PUBR33
CA_PUB34:
    s_mov_b64 exec, 0xffff
    buffer_store_dwordx2 v[30:31], v17, s[24:27], s48 offen sc1
    s_mov_b64 exec, -1
    s_mov_b32 s49, 1
    s_branch CA_PUBR34
CA_PUB35:
    s_mov_b64 exec, 0xffff
    buffer_store_dwordx2 v[30:31], v17, s[24:27], s48 offen sc1
    s_mov_b64 exec, -1
    s_mov_b32 s49, 1
    s_branch CA_PUBR35
CA_PUB36:
    s_mov_b64 exec, 0xffff
    buffer_store_dwordx2 v[30:31], v17, s[24:27], s48 offen sc1
    s_mov_b64 exec, -1
    s_mov_b32 s49, 1
    s_branch CA_PUBR36
CA_PUB37:
    s_mov_b64 exec, 0xffff
    buffer_store_dwordx2 v[30:31], v17, s[24:27], s48 offen sc1
    s_mov_b64 exec, -1
    s_mov_b32 s49, 1
    s_branch CA_PUBR37
CA_PUB38:
    s_mov_b64 exec, 0xffff
    buffer_store_dwordx2 v[30:31], v17, s[24:27], s48 offen sc1
    s_mov_b64 exec, -1
    s_mov_b32 s49, 1
    s_branch CA_PUBR38
CA_PUB39:
    s_mov_b64 exec, 0xffff
    buffer_store_dwordx2 v[30:31], v17, s[24:27], s48 offen sc1
    s_mov_b64 exec, -1
    s_mov_b32 s49, 1
    s_branch CA_PUBR39
CA_PUB40:
    s_mov_b64 exec, 0xffff
    buffer_store_dwordx2 v[30:31], v17, s[24:27], s48 offen sc1
    s_mov_b64 exec, -1
    s_mov_b32 s49, 1
    s_branch CA_PUBR40
CA_PUB41:
    s_mov_b64 exec, 0xffff
    buffer_store_dwordx2 v[30:31], v17, s[24:27], s48 offen sc1
    s_mov_b64 exec, -1
    s_mov_b32 s49, 1
    s_branch CA_PUBR41
CA_PUB42:
    s_mov_b64 exec, 0xffff
    buffer_store_dwordx2 v[30:31], v17, s[24:27], s48 offen sc1
    s_mov_b64 exec, -1
    s_mov_b32 s49, 1
    s_branch CA_PUBR42
CA_PUB43:
    s_mov_b64 exec, 0xffff
    buffer_store_dwordx2 v[30:31], v17, s[24:27], s48 offen sc1
    s_mov_b64 exec, -1
    s_mov_b32 s49, 1
    s_branch CA_PUBR43
CA_PUB44:
    s_mov_b64 exec, 0xffff
    buffer_store_dwordx2 v[30:31], v17, s[24:27], s48 offen sc1
    s_mov_b64 exec, -1
    s_mov_b32 s49, 1
    s_branch CA_PUBR44
CA_PUB45:
    s_mov_b64 exec, 0xffff
    buffer_store_dwordx2 v[30:31], v17, s[24:27], s48 offen sc1
    s_mov_b64 exec, -1
    s_mov_b32 s49, 1
    s_branch CA_PUBR45
CA_PUB46:
    s_mov_b64 exec, 0xffff
    buffer_store_dwordx2 v[30:31], v17, s[24:27], s48 offen sc1
    s_mov_b64 exec, -1
    s_mov_b32 s49, 1
    s_branch CA_PUBR46
CA_PUB47:
    s_mov_b64 exec, 0xffff
    buffer_store_dwordx2 v[30:31], v17, s[24:27], s48 offen sc1
    s_mov_b64 exec, -1
    s_mov_b32 s49, 1
    s_branch CA_PUBR47
CA_PUB48:
    s_mov_b64 exec, 0xffff
    buffer_store_dwordx2 v[30:31], v17, s[24:27], s48 offen sc1
    s_mov_b64 exec, -1
    s_mov_b32 s49, 1
    s_branch CA_PUBR48
CA_PUB49:
    s_mov_b64 exec, 0xffff
    buffer_store_dwordx2 v[30:31], v17, s[24:27], s48 offen sc1
    s_mov_b64 exec, -1
    s_mov_b32 s49, 1
    s_branch CA_PUBR49
CA_PUB50:
    s_mov_b64 exec, 0xffff
    buffer_store_dwordx2 v[30:31], v17, s[24:27], s48 offen sc1
    s_mov_b64 exec, -1
    s_mov_b32 s49, 1
    s_branch CA_PUBR50
CA_PUB51:
    s_mov_b64 exec, 0xffff
    buffer_store_dwordx2 v[30:31], v17, s[24:27], s48 offen sc1
    s_mov_b64 exec, -1
    s_mov_b32 s49, 1
    s_branch CA_PUBR51
CA_PUB52:
    s_mov_b64 exec, 0xffff
    buffer_store_dwordx2 v[30:31], v17, s[24:27], s48 offen sc1
    s_mov_b64 exec, -1
    s_mov_b32 s49, 1
    s_branch CA_PUBR52
CA_PUB53:
    s_mov_b64 exec, 0xffff
    buffer_store_dwordx2 v[30:31], v17, s[24:27], s48 offen sc1
    s_mov_b64 exec, -1
    s_mov_b32 s49, 1
    s_branch CA_PUBR53
CA_PUB54:
    s_mov_b64 exec, 0xffff
    buffer_store_dwordx2 v[30:31], v17, s[24:27], s48 offen sc1
    s_mov_b64 exec, -1
    s_mov_b32 s49, 1
    s_branch CA_PUBR54
K_CB:
    s_waitcnt vmcnt(4)
    s_barrier
    ds_read_b128 v[32:35], v4 offset:0
    ds_read_b64_tr_b16 v[40:41], v12 offset:0
    ds_read_b64_tr_b16 v[42:43], v12 offset:512
    ds_read_b128 v[36:39], v4 offset:4096
    ds_read_b64_tr_b16 v[44:45], v15 offset:4096
    ds_read_b64_tr_b16 v[46:47], v15 offset:4608
    ds_read_b64_tr_b16 v[48:49], v16 offset:4096
    ds_read_b64_tr_b16 v[50:51], v16 offset:4608
    s_waitcnt lgkmcnt(0)
    v_mfma_f32_32x32x16_bf16 v[96:111], v[32:35], v[40:43], 0
    ds_read_b128 v[52:55], v5 offset:0
    ds_read_b64_tr_b16 v[60:61], v12 offset:2048
    ds_read_b64_tr_b16 v[62:63], v12 offset:2560
    v_mfma_f32_32x32x16_bf16 v[112:127], v[36:39], v[40:43], 0
    ds_read_b128 v[56:59], v5 offset:4096
    ds_read_b64_tr_b16 v[64:65], v15 offset:6144
    ds_read_b64_tr_b16 v[66:67], v15 offset:6656
    v_mfma_f32_32x32x16_bf16 v[128:143], v[44:47], v[32:35], 0
    ds_read_b64_tr_b16 v[68:69], v16 offset:6144
    ds_read_b64_tr_b16 v[70:71], v16 offset:6656
    v_mfma_f32_32x32x16_bf16 v[144:159], v[44:47], v[36:39], 0
    v_mfma_f32_32x32x16_bf16 v[160:175], v[48:51], v[32:35], 0
    v_mfma_f32_32x32x16_bf16 v[176:191], v[48:51], v[36:39], 0
    s_waitcnt lgkmcnt(0)
    v_mfma_f32_32x32x16_bf16 v[96:111], v[52:55], v[60:63], v[96:111]
    s_waitcnt vmcnt(1)
    s_barrier
    ds_read_b128 v[32:35], v6 offset:0
    ds_read_b64_tr_b16 v[40:41], v12 offset:12288
    ds_read_b64_tr_b16 v[42:43], v12 offset:12800
    v_add_u32 v8, 0x10000, v4
    v_add_u32 v9, 0x10000, v5
    v_add_u32 v10, 0x10000, v6
    v_mfma_f32_32x32x16_bf16 v[112:127], v[56:59], v[60:63], v[112:127]
    ds_read_b128 v[36:39], v6 offset:4096
    ds_read_b64_tr_b16 v[44:45], v15 offset:16384
    ds_read_b64_tr_b16 v[46:47], v15 offset:16896
    v_add_u32 v11, 0x10000, v7
    s_mov_b32 s30, 896
    s_mov_b32 s31, 0x00020000
    v_mfma_f32_32x32x16_bf16 v[128:143], v[64:67], v[52:55], v[128:143]
    ds_read_b64_tr_b16 v[48:49], v16 offset:16384
    ds_read_b64_tr_b16 v[50:51], v16 offset:16896
    s_mov_b32 s26, 17498112
    s_mov_b32 s27, 0x00020000
    s_mov_b32 s58, 1605632
    v_mfma_f32_32x32x16_bf16 v[144:159], v[64:67], v[56:59], v[144:159]
    s_mov_b32 s59, 0x00020000
    s_mov_b32 s62, 401408
    s_mov_b32 s63, 0x00020000
    v_mfma_f32_32x32x16_bf16 v[160:175], v[68:71], v[52:55], v[160:175]
    s_mov_b32 s66, 1835008
    s_mov_b32 s67, 0x00020000
    s_mov_b32 s70, 256
    v_mfma_f32_32x32x16_bf16 v[176:191], v[68:71], v[56:59], v[176:191]
    s_mov_b32 s71, 0x00020000
    s_and_b32 s4, s2, 7
    s_lshl_b32 s4, s4, 1
    s_waitcnt lgkmcnt(0)
    v_mfma_f32_32x32x16_bf16 v[96:111], v[32:35], v[40:43], v[96:111]
    ds_read_b128 v[52:55], v7 offset:0
    ds_read_b64_tr_b16 v[60:61], v12 offset:14336
    ds_read_b64_tr_b16 v[62:63], v12 offset:14848
    s_lshr_b32 s5, s2, 7
    s_add_u32 s37, s4, s5
    s_bfe_u32 s38, s2, 0x40003
    v_mfma_f32_32x32x16_bf16 v[112:127], v[36:39], v[40:43], v[112:127]
    ds_read_b128 v[56:59], v7 offset:4096
    ds_read_b64_tr_b16 v[64:65], v15 offset:18432
    ds_read_b64_tr_b16 v[66:67], v15 offset:18944
    s_lshl_b32 s6, s37, 18
    s_add_u32 s6, s6, 2097152
    s_lshl_b32 s5, s3, 16
    v_mfma_f32_32x32x16_bf16 v[128:143], v[44:47], v[32:35], v[128:143]
    ds_read_b64_tr_b16 v[68:69], v16 offset:18432
    ds_read_b64_tr_b16 v[70:71], v16 offset:18944
    s_add_u32 s39, s6, s5
    s_mov_b32 s99, s39
    v_mov_b32 v28, 0
    v_mfma_f32_32x32x16_bf16 v[144:159], v[44:47], v[36:39], v[144:159]
    v_mov_b32 v27, 1
    v_lshlrev_b32 v24, 2, v1
    s_lshl_b32 s4, s3, 12
    v_mfma_f32_32x32x16_bf16 v[160:175], v[48:51], v[32:35], v[160:175]
    v_add_u32 v3, s4, v2
    s_lshl_b32 s4, s3, 8
    v_add_u32 v25, s4, v24
    v_mfma_f32_32x32x16_bf16 v[176:191], v[48:51], v[36:39], v[176:191]
    s_add_u32 s4, s38, 0
    s_and_b32 s4, s4, 15
    s_lshl_b32 s4, s4, 12
    s_waitcnt lgkmcnt(0)
    v_mfma_f32_32x32x16_bf16 v[96:111], v[52:55], v[60:63], v[96:111]
    s_barrier
    ds_read_b128 v[32:35], v4 offset:16384
    ds_read_b64_tr_b16 v[40:41], v12 offset:24576
    ds_read_b64_tr_b16 v[42:43], v12 offset:25088
    s_add_u32 s8, s4, s39
    s_add_u32 s4, s38, 1
    v_mfma_f32_32x32x16_bf16 v[112:127], v[56:59], v[60:63], v[112:127]
    ds_read_b128 v[36:39], v4 offset:20480
    ds_read_b64_tr_b16 v[44:45], v15 offset:28672
    ds_read_b64_tr_b16 v[46:47], v15 offset:29184
    s_and_b32 s4, s4, 15
    s_lshl_b32 s4, s4, 12
    v_mfma_f32_32x32x16_bf16 v[128:143], v[64:67], v[52:55], v[128:143]
    ds_read_b64_tr_b16 v[48:49], v16 offset:28672
    ds_read_b64_tr_b16 v[50:51], v16 offset:29184
    s_add_u32 s9, s4, s39
    s_add_u32 s4, s38, 2
    v_mfma_f32_32x32x16_bf16 v[144:159], v[64:67], v[56:59], v[144:159]
    s_and_b32 s4, s4, 15
    s_lshl_b32 s4, s4, 12
    v_mfma_f32_32x32x16_bf16 v[160:175], v[68:71], v[52:55], v[160:175]
    s_add_u32 s10, s4, s39
    s_add_u32 s4, s38, 3
    v_mfma_f32_32x32x16_bf16 v[176:191], v[68:71], v[56:59], v[176:191]
    s_and_b32 s4, s4, 15
    s_lshl_b32 s4, s4, 12
    s_waitcnt lgkmcnt(0)
    v_mfma_f32_32x32x16_bf16 v[96:111], v[32:35], v[40:43], v[96:111]
    ds_read_b128 v[52:55], v5 offset:16384
    ds_read_b64_tr_b16 v[60:61], v12 offset:26624
    ds_read_b64_tr_b16 v[62:63], v12 offset:27136
    s_add_u32 s11, s4, s39
    s_add_u32 s4, s38, 4
    v_mfma_f32_32x32x16_bf16 v[112:127], v[36:39], v[40:43], v[112:127]
    ds_read_b128 v[56:59], v5 offset:20480
    ds_read_b64_tr_b16 v[64:65], v15 offset:30720
    ds_read_b64_tr_b16 v[66:67], v15 offset:31232
    s_and_b32 s4, s4, 15
    s_lshl_b32 s4, s4, 12
    v_mfma_f32_32x32x16_bf16 v[128:143], v[44:47], v[32:35], v[128:143]
    ds_read_b64_tr_b16 v[68:69], v16 offset:30720
    ds_read_b64_tr_b16 v[70:71], v16 offset:31232
    s_add_u32 s12, s4, s39
    s_add_u32 s4, s38, 5
    v_mfma_f32_32x32x16_bf16 v[144:159], v[44:47], v[36:39], v[144:159]
    s_and_b32 s4, s4, 15
    s_lshl_b32 s4, s4, 12
    v_mfma_f32_32x32x16_bf16 v[160:175], v[48:51], v[32:35], v[160:175]
    s_add_u32 s13, s4, s39
    s_add_u32 s4, s38, 6
    v_mfma_f32_32x32x16_bf16 v[176:191], v[48:51], v[36:39], v[176:191]
    s_and_b32 s4, s4, 15
    s_lshl_b32 s4, s4, 12
    s_waitcnt lgkmcnt(0)
    v_mfma_f32_32x32x16_bf16 v[96:111], v[52:55], v[60:63], v[96:111]
    s_barrier
    ds_read_b128 v[32:35], v6 offset:16384
    ds_read_b64_tr_b16 v[40:41], v12 offset:36864
    ds_read_b64_tr_b16 v[42:43], v12 offset:37376
    s_add_u32 s14, s4, s39
    s_add_u32 s4, s38, 7
    v_mfma_f32_32x32x16_bf16 v[112:127], v[56:59], v[60:63], v[112:127]
    ds_read_b128 v[36:39], v6 offset:20480
    ds_read_b64_tr_b16 v[44:45], v15 offset:40960
    ds_read_b64_tr_b16 v[46:47], v15 offset:41472
    s_and_b32 s4, s4, 15
    s_lshl_b32 s4, s4, 12
    v_mfma_f32_32x32x16_bf16 v[128:143], v[64:67], v[52:55], v[128:143]
    ds_read_b64_tr_b16 v[48:49], v16 offset:40960
    ds_read_b64_tr_b16 v[50:51], v16 offset:41472
    s_add_u32 s15, s4, s39
    s_add_u32 s4, s38, 8
    v_mfma_f32_32x32x16_bf16 v[144:159], v[64:67], v[56:59], v[144:159]
    s_and_b32 s4, s4, 15
    s_lshl_b32 s4, s4, 12
    v_mfma_f32_32x32x16_bf16 v[160:175], v[68:71], v[52:55], v[160:175]
    s_add_u32 s28, s4, s39
    s_add_u32 s4, s38, 9
    v_mfma_f32_32x32x16_bf16 v[176:191], v[68:71], v[56:59], v[176:191]
    s_and_b32 s4, s4, 15
    s_lshl_b32 s4, s4, 12
    s_waitcnt lgkmcnt(0)
    v_mfma_f32_32x32x16_bf16 v[96:111], v[32:35], v[40:43], v[96:111]
    ds_read_b128 v[52:55], v7 offset:16384
    ds_read_b64_tr_b16 v[60:61], v12 offset:38912
    ds_read_b64_tr_b16 v[62:63], v12 offset:39424
    s_add_u32 s29, s4, s39
    s_add_u32 s4, s38, 10
    v_mfma_f32_32x32x16_bf16 v[112:127], v[36:39], v[40:43], v[112:127]
    ds_read_b128 v[56:59], v7 offset:20480
    ds_read_b64_tr_b16 v[64:65], v15 offset:43008
    ds_read_b64_tr_b16 v[66:67], v15 offset:43520
    s_and_b32 s4, s4, 15
    s_lshl_b32 s4, s4, 12
    v_mfma_f32_32x32x16_bf16 v[128:143], v[44:47], v[32:35], v[128:143]
    ds_read_b64_tr_b16 v[68:69], v16 offset:43008
    ds_read_b64_tr_b16 v[70:71], v16 offset:43520
    s_add_u32 s30, s4, s39
    s_add_u32 s4, s38, 11
    v_mfma_f32_32x32x16_bf16 v[144:159], v[44:47], v[36:39], v[144:159]
    s_and_b32 s4, s4, 15
    s_lshl_b32 s4, s4, 12
    v_mfma_f32_32x32x16_bf16 v[160:175], v[48:51], v[32:35], v[160:175]
    s_add_u32 s31, s4, s39
    s_add_u32 s4, s38, 12
    v_mfma_f32_32x32x16_bf16 v[176:191], v[48:51], v[36:39], v[176:191]
    s_and_b32 s4, s4, 15
    s_lshl_b32 s4, s4, 12
    s_waitcnt lgkmcnt(0)
    v_mfma_f32_32x32x16_bf16 v[96:111], v[52:55], v[60:63], v[96:111]
    s_barrier
    ds_read_b128 v[32:35], v4 offset:32768
    ds_read_b64_tr_b16 v[40:41], v12 offset:0
    ds_read_b64_tr_b16 v[42:43], v12 offset:512
    s_add_u32 s64, s4, s39
    s_add_u32 s4, s38, 13
    v_mfma_f32_32x32x16_bf16 v[112:127], v[56:59], v[60:63], v[112:127]
    ds_read_b128 v[36:39], v4 offset:36864
    ds_read_b64_tr_b16 v[44:45], v15 offset:4096
    ds_read_b64_tr_b16 v[46:47], v15 offset:4608
    s_and_b32 s4, s4, 15
    s_lshl_b32 s4, s4, 12
    v_mfma_f32_32x32x16_bf16 v[128:143], v[64:67], v[52:55], v[128:143]
    ds_read_b64_tr_b16 v[48:49], v16 offset:4096
    ds_read_b64_tr_b16 v[50:51], v16 offset:4608
    s_add_u32 s65, s4, s39
    s_add_u32 s4, s38, 14
    v_mfma_f32_32x32x16_bf16 v[144:159], v[64:67], v[56:59], v[144:159]
    s_and_b32 s4, s4, 15
    s_lshl_b32 s4, s4, 12
    v_mfma_f32_32x32x16_bf16 v[160:175], v[68:71], v[52:55], v[160:175]
    s_add_u32 s66, s4, s39
    s_add_u32 s4, s38, 15
    v_mfma_f32_32x32x16_bf16 v[176:191], v[68:71], v[56:59], v[176:191]
    s_and_b32 s4, s4, 15
    s_lshl_b32 s4, s4, 12
    s_waitcnt lgkmcnt(0)
    v_mfma_f32_32x32x16_bf16 v[96:111], v[32:35], v[40:43], v[96:111]
    ds_read_b128 v[52:55], v5 offset:32768
    ds_read_b64_tr_b16 v[60:61], v12 offset:2048
    ds_read_b64_tr_b16 v[62:63], v12 offset:2560
    s_add_u32 s67, s4, s39
    s_add_u32 s4, s3, 1
    v_mfma_f32_32x32x16_bf16 v[112:127], v[36:39], v[40:43], v[112:127]
    ds_read_b128 v[56:59], v5 offset:36864
    ds_read_b64_tr_b16 v[64:65], v15 offset:6144
    ds_read_b64_tr_b16 v[66:67], v15 offset:6656
    s_and_b32 s4, s4, 3
    s_lshl_b32 s4, s4, 11
    v_mfma_f32_32x32x16_bf16 v[128:143], v[44:47], v[32:35], v[128:143]
    ds_read_b64_tr_b16 v[68:69], v16 offset:6144
    ds_read_b64_tr_b16 v[70:71], v16 offset:6656
    v_add_u32 v20, s4, v2
    s_add_u32 s4, s3, 2
    v_mfma_f32_32x32x16_bf16 v[144:159], v[44:47], v[36:39], v[144:159]
    s_and_b32 s4, s4, 3
    s_lshl_b32 s4, s4, 11
    v_mfma_f32_32x32x16_bf16 v[160:175], v[48:51], v[32:35], v[160:175]
    v_add_u32 v21, s4, v2
    s_add_u32 s4, s3, 3
    v_mfma_f32_32x32x16_bf16 v[176:191], v[48:51], v[36:39], v[176:191]
    s_and_b32 s4, s4, 3
    s_lshl_b32 s4, s4, 11
    s_waitcnt lgkmcnt(0)
    v_mfma_f32_32x32x16_bf16 v[96:111], v[52:55], v[60:63], v[96:111]
    s_barrier
    ds_read_b128 v[32:35], v6 offset:32768
    ds_read_b64_tr_b16 v[40:41], v12 offset:12288
    ds_read_b64_tr_b16 v[42:43], v12 offset:12800
    v_add_u32 v22, s4, v2
    s_add_u32 s4, s3, 4
    v_mfma_f32_32x32x16_bf16 v[112:127], v[56:59], v[60:63], v[112:127]
    ds_read_b128 v[36:39], v6 offset:36864
    ds_read_b64_tr_b16 v[44:45], v15 offset:16384
    ds_read_b64_tr_b16 v[46:47], v15 offset:16896
    s_and_b32 s4, s4, 3
    s_lshl_b32 s4, s4, 11
    v_mfma_f32_32x32x16_bf16 v[128:143], v[64:67], v[52:55], v[128:143]
    v_mov_b32 v31, 0
    buffer_load_dword v30, v31, s[68:71], 0 offen sc1
    ds_read_b64_tr_b16 v[48:49], v16 offset:16384
    ds_read_b64_tr_b16 v[50:51], v16 offset:16896
    v_add_u32 v23, s4, v2
    s_lshl_b32 s5, s38, 2
    v_mfma_f32_32x32x16_bf16 v[144:159], v[64:67], v[56:59], v[144:159]
    s_add_u32 s5, s5, s3
    s_lshl_b32 s5, s5, 4
    v_mfma_f32_32x32x16_bf16 v[160:175], v[68:71], v[52:55], v[160:175]
    s_add_u32 s5, s5, s37
    s_lshl_b32 s96, s5, 11
    v_mfma_f32_32x32x16_bf16 v[176:191], v[68:71], v[56:59], v[176:191]
    s_add_u32 s96, s96, 14680064
    s_mov_b32 s100, s96
    s_waitcnt lgkmcnt(0)
    v_mfma_f32_32x32x16_bf16 v[96:111], v[32:35], v[40:43], v[96:111]
    ds_read_b128 v[52:55], v7 offset:32768
    ds_read_b64_tr_b16 v[60:61], v12 offset:14336
    ds_read_b64_tr_b16 v[62:63], v12 offset:14848
    s_lshl_b32 s97, s5, 7
    s_add_u32 s97, s97, 17367040
    v_mfma_f32_32x32x16_bf16 v[112:127], v[36:39], v[40:43], v[112:127]
    ds_read_b128 v[56:59], v7 offset:36864
    ds_read_b64_tr_b16 v[64:65], v15 offset:18432
    ds_read_b64_tr_b16 v[66:67], v15 offset:18944
    s_lshl_b32 s4, s32, 6
    s_lshl_b32 s5, s33, 2
    v_mfma_f32_32x32x16_bf16 v[128:143], v[44:47], v[32:35], v[128:143]
    s_lshl_b32 s44, s2, 2
    s_add_u32 s44, s44, s3
    s_mul_i32 s45, s44, 1600
    v_min_u32 v29, 24, v1
    v_lshlrev_b32 v29, 6, v29
    buffer_load_dword v95, v29, s[56:59], s45 offen
    s_mul_i32 s45, s44, 448
    v_min_u32 v29, 384, v29
    buffer_load_dword v95, v29, s[60:63], s45 offen
    ds_read_b64_tr_b16 v[68:69], v16 offset:18432
    ds_read_b64_tr_b16 v[70:71], v16 offset:18944
    s_add_u32 s4, s4, s5
    s_add_u32 s4, s4, s3
    v_mfma_f32_32x32x16_bf16 v[144:159], v[44:47], v[36:39], v[144:159]
    s_lshl_b32 s4, s4, 7
    s_add_u32 s98, s4, 17235968
    v_mfma_f32_32x32x16_bf16 v[160:175], v[48:51], v[32:35], v[160:175]
    s_lshl_b32 s37, s32, 2
    s_lshl_b32 s38, s35, 1
    v_mfma_f32_32x32x16_bf16 v[176:191], v[48:51], v[36:39], v[176:191]
    s_add_u32 s37, s37, s38
    s_mul_i32 s39, s36, 1
    s_waitcnt lgkmcnt(0)
    v_mfma_f32_32x32x16_bf16 v[96:111], v[52:55], v[60:63], v[96:111]
    s_barrier
    ds_read_b128 v[32:35], v4 offset:49152
    ds_read_b64_tr_b16 v[40:41], v12 offset:24576
    ds_read_b64_tr_b16 v[42:43], v12 offset:25088
    s_add_u32 s39, s39, s34
    v_lshrrev_b32 v17, 4, v1
    v_mfma_f32_32x32x16_bf16 v[112:127], v[56:59], v[60:63], v[112:127]
    ds_read_b128 v[36:39], v4 offset:53248
    ds_read_b64_tr_b16 v[44:45], v15 offset:28672
    ds_read_b64_tr_b16 v[46:47], v15 offset:29184
    v_add_u32 v17, s39, v17
    v_and_b32 v18, 15, v17
    v_mfma_f32_32x32x16_bf16 v[128:143], v[64:67], v[52:55], v[128:143]
    ds_read_b64_tr_b16 v[48:49], v16 offset:28672
    ds_read_b64_tr_b16 v[50:51], v16 offset:29184
    v_lshrrev_b32 v17, 4, v17
    v_mul_u32_u24 v18, 3, v18
    v_mfma_f32_32x32x16_bf16 v[144:159], v[64:67], v[56:59], v[144:159]
    v_add_u32 v17, v17, v18
    v_lshlrev_b32 v17, 12, v17
    v_mfma_f32_32x32x16_bf16 v[160:175], v[68:71], v[52:55], v[160:175]
    v_and_b32 v18, 15, v1
    v_lshl_add_u32 v17, v18, 3, v17
    v_mfma_f32_32x32x16_bf16 v[176:191], v[68:71], v[56:59], v[176:191]
    s_lshl_b32 s48, s37, 6
    s_add_u32 s48, s48, 17039360
    s_waitcnt lgkmcnt(0)
    v_mfma_f32_32x32x16_bf16 v[96:111], v[32:35], v[40:43], v[96:111]
    ds_read_b128 v[52:55], v5 offset:49152
    ds_read_b64_tr_b16 v[60:61], v12 offset:26624
    ds_read_b64_tr_b16 v[62:63], v12 offset:27136
    s_and_b32 s39, s39, 15
    s_lshl_b32 s39, s39, 6
    v_mfma_f32_32x32x16_bf16 v[112:127], v[36:39], v[40:43], v[112:127]
    ds_read_b128 v[56:59], v5 offset:53248
    ds_read_b64_tr_b16 v[64:65], v15 offset:30720
    ds_read_b64_tr_b16 v[66:67], v15 offset:31232
    s_add_u32 s39, s39, s37
    s_mov_b32 s50, 0
    v_mfma_f32_32x32x16_bf16 v[128:143], v[44:47], v[32:35], v[128:143]
    ds_read_b64_tr_b16 v[68:69], v16 offset:30720
    ds_read_b64_tr_b16 v[70:71], v16 offset:31232
    s_mov_b32 s51, -1
    s_mov_b32 s42, 12
    v_mfma_f32_32x32x16_bf16 v[144:159], v[44:47], v[36:39], v[144:159]
    s_mov_b32 s43, 2097152
    v_and_b32 v19, 31, v1
    v_mfma_f32_32x32x16_bf16 v[160:175], v[48:51], v[32:35], v[160:175]
    v_mov_b32 v18, 0x3f803f80
    v_cmp_eq_u32 vcc, 28, v19
    v_mfma_f32_32x32x16_bf16 v[176:191], v[48:51], v[36:39], v[176:191]
    v_cmp_lt_u32 s[52:53], 27, v19
    s_nop 1
    s_waitcnt lgkmcnt(0)
    v_mfma_f32_32x32x16_bf16 v[96:111], v[52:55], v[60:63], v[96:111]
    s_barrier
    ds_read_b128 v[32:35], v6 offset:49152
    ds_read_b64_tr_b16 v[40:41], v12 offset:36864
    ds_read_b64_tr_b16 v[42:43], v12 offset:37376
    v_cndmask_b32 v18, 0, v18, vcc
    s_mul_i32 s40, s37, 112
    v_mfma_f32_32x32x16_bf16 v[112:127], v[56:59], v[60:63], v[112:127]
    ds_read_b128 v[36:39], v6 offset:53248
    ds_read_b64_tr_b16 v[44:45], v15 offset:40960
    ds_read_b64_tr_b16 v[46:47], v15 offset:41472
    s_lshl_b32 s41, s36, 1
    s_add_u32 s40, s40, s41
    v_mfma_f32_32x32x16_bf16 v[128:143], v[64:67], v[52:55], v[128:143]
    ds_read_b64_tr_b16 v[48:49], v16 offset:40960
    ds_read_b64_tr_b16 v[50:51], v16 offset:41472
    s_lshl_b32 s41, s73, 2
    s_add_u32 s54, s40, s41
    v_mfma_f32_32x32x16_bf16 v[144:159], v[64:67], v[56:59], v[144:159]
    s_lshl_b32 s54, s54, 10
    s_add_u32 s54, s54, 6291456
    v_mfma_f32_32x32x16_bf16 v[160:175], v[68:71], v[52:55], v[160:175]
    s_add_u32 s55, s54, 114688
    s_lshl_b32 s41, s72, 2
    v_mfma_f32_32x32x16_bf16 v[176:191], v[68:71], v[56:59], v[176:191]
    s_add_u32 s40, s40, s41
    s_lshl_b32 s40, s40, 10
    s_waitcnt lgkmcnt(0)
    v_mfma_f32_32x32x16_bf16 v[96:111], v[32:35], v[40:43], v[96:111]
    ds_read_b128 v[52:55], v7 offset:49152
    ds_read_b64_tr_b16 v[60:61], v12 offset:38912
    ds_read_b64_tr_b16 v[62:63], v12 offset:39424
    s_add_u32 s40, s40, 6291456
    s_add_u32 s41, s40, 114688
    v_mfma_f32_32x32x16_bf16 v[112:127], v[36:39], v[40:43], v[112:127]
    ds_read_b128 v[56:59], v7 offset:53248
    ds_read_b64_tr_b16 v[64:65], v15 offset:43008
    ds_read_b64_tr_b16 v[66:67], v15 offset:43520
    v_mfma_f32_32x32x16_bf16 v[128:143], v[44:47], v[32:35], v[128:143]
    ds_read_b64_tr_b16 v[68:69], v16 offset:43008
    ds_read_b64_tr_b16 v[70:71], v16 offset:43520
    v_mfma_f32_32x32x16_bf16 v[144:159], v[44:47], v[36:39], v[144:159]
    v_mfma_f32_32x32x16_bf16 v[160:175], v[48:51], v[32:35], v[160:175]
    v_mfma_f32_32x32x16_bf16 v[176:191], v[48:51], v[36:39], v[176:191]
    s_waitcnt lgkmcnt(0)
    v_mfma_f32_32x32x16_bf16 v[96:111], v[52:55], v[60:63], v[96:111]
    s_barrier
    ds_read_b128 v[32:35], v8 offset:0
    ds_read_b64_tr_b16 v[40:41], v12 offset:0
    ds_read_b64_tr_b16 v[42:43], v12 offset:512
    v_mfma_f32_32x32x16_bf16 v[112:127], v[56:59], v[60:63], v[112:127]
    ds_read_b128 v[36:39], v8 offset:4096
    ds_read_b64_tr_b16 v[44:45], v15 offset:4096
    ds_read_b64_tr_b16 v[46:47], v15 offset:4608
    v_mfma_f32_32x32x16_bf16 v[128:143], v[64:67], v[52:55], v[128:143]
    ds_read_b64_tr_b16 v[48:49], v16 offset:4096
    ds_read_b64_tr_b16 v[50:51], v16 offset:4608
    v_mfma_f32_32x32x16_bf16 v[144:159], v[64:67], v[56:59], v[144:159]
    v_mfma_f32_32x32x16_bf16 v[160:175], v[68:71], v[52:55], v[160:175]
    v_mfma_f32_32x32x16_bf16 v[176:191], v[68:71], v[56:59], v[176:191]
    s_waitcnt lgkmcnt(0)
    v_mfma_f32_32x32x16_bf16 v[96:111], v[32:35], v[40:43], v[96:111]
    ds_read_b128 v[52:55], v9 offset:0
    ds_read_b64_tr_b16 v[60:61], v12 offset:2048
    ds_read_b64_tr_b16 v[62:63], v12 offset:2560
    v_mfma_f32_32x32x16_bf16 v[112:127], v[36:39], v[40:43], v[112:127]
    ds_read_b128 v[56:59], v9 offset:4096
    ds_read_b64_tr_b16 v[64:65], v15 offset:6144
    ds_read_b64_tr_b16 v[66:67], v15 offset:6656
    v_mfma_f32_32x32x16_bf16 v[128:143], v[44:47], v[32:35], v[128:143]
    ds_read_b64_tr_b16 v[68:69], v16 offset:6144
    ds_read_b64_tr_b16 v[70:71], v16 offset:6656
    v_mfma_f32_32x32x16_bf16 v[144:159], v[44:47], v[36:39], v[144:159]
    v_mfma_f32_32x32x16_bf16 v[160:175], v[48:51], v[32:35], v[160:175]
    v_mfma_f32_32x32x16_bf16 v[176:191], v[48:51], v[36:39], v[176:191]
    s_waitcnt lgkmcnt(0)
    v_mfma_f32_32x32x16_bf16 v[96:111], v[52:55], v[60:63], v[96:111]
    s_barrier
    ds_read_b128 v[32:35], v10 offset:0
    ds_read_b64_tr_b16 v[40:41], v12 offset:12288
    ds_read_b64_tr_b16 v[42:43], v12 offset:12800
    v_mfma_f32_32x32x16_bf16 v[112:127], v[56:59], v[60:63], v[112:127]
    ds_read_b128 v[36:39], v10 offset:4096
    ds_read_b64_tr_b16 v[44:45], v15 offset:16384
    ds_read_b64_tr_b16 v[46:47], v15 offset:16896
    v_mfma_f32_32x32x16_bf16 v[128:143], v[64:67], v[52:55], v[128:143]
    ds_read_b64_tr_b16 v[48:49], v16 offset:16384
    ds_read_b64_tr_b16 v[50:51], v16 offset:16896
    v_mfma_f32_32x32x16_bf16 v[144:159], v[64:67], v[56:59], v[144:159]
    v_mfma_f32_32x32x16_bf16 v[160:175], v[68:71], v[52:55], v[160:175]
    v_mfma_f32_32x32x16_bf16 v[176:191], v[68:71], v[56:59], v[176:191]
    s_waitcnt lgkmcnt(0)
    v_mfma_f32_32x32x16_bf16 v[96:111], v[32:35], v[40:43], v[96:111]
    ds_read_b128 v[52:55], v11 offset:0
    ds_read_b64_tr_b16 v[60:61], v12 offset:14336
    ds_read_b64_tr_b16 v[62:63], v12 offset:14848
    v_mfma_f32_32x32x16_bf16 v[112:127], v[36:39], v[40:43], v[112:127]
    ds_read_b128 v[56:59], v11 offset:4096
    ds_read_b64_tr_b16 v[64:65], v15 offset:18432
    ds_read_b64_tr_b16 v[66:67], v15 offset:18944
    v_mfma_f32_32x32x16_bf16 v[128:143], v[44:47], v[32:35], v[128:143]
    s_bfe_u32 s44, s2, 0x30003
    s_lshl_b32 s44, s44, 1
    s_add_u32 s44, s44, s35
    s_mul_i32 s44, s44, 100352
    s_lshl_b32 s45, s73, 7
    s_add_u32 s44, s44, s45
    v_lshrrev_b32 v29, 1, v1
    v_min_u32 v29, 27, v29
    v_mul_u32_u24 v29, 3584, v29
    v_and_b32 v26, 1, v1
    v_lshl_add_u32 v29, v26, 6, v29
    s_cmp_eq_u32 s36, 0
    s_cbranch_scc1 CB_TG
    buffer_load_dword v29, v29, s[20:23], s44 offen
    s_branch CB_TD
CB_TG:
    buffer_load_dword v29, v29, s[16:19], s44 offen
CB_TD:
    ds_read_b64_tr_b16 v[68:69], v16 offset:18432
    ds_read_b64_tr_b16 v[70:71], v16 offset:18944
    v_mfma_f32_32x32x16_bf16 v[144:159], v[44:47], v[36:39], v[144:159]
    v_mfma_f32_32x32x16_bf16 v[160:175], v[48:51], v[32:35], v[160:175]
    v_mfma_f32_32x32x16_bf16 v[176:191], v[48:51], v[36:39], v[176:191]
    s_waitcnt lgkmcnt(0)
    v_mfma_f32_32x32x16_bf16 v[96:111], v[52:55], v[60:63], v[96:111]
    s_barrier
    ds_read_b128 v[32:35], v8 offset:16384
    ds_read_b64_tr_b16 v[40:41], v12 offset:24576
    ds_read_b64_tr_b16 v[42:43], v12 offset:25088
    v_mfma_f32_32x32x16_bf16 v[112:127], v[56:59], v[60:63], v[112:127]
    ds_read_b128 v[36:39], v8 offset:20480
    ds_read_b64_tr_b16 v[44:45], v15 offset:28672
    ds_read_b64_tr_b16 v[46:47], v15 offset:29184
    v_mfma_f32_32x32x16_bf16 v[128:143], v[64:67], v[52:55], v[128:143]
    ds_read_b64_tr_b16 v[48:49], v16 offset:28672
    ds_read_b64_tr_b16 v[50:51], v16 offset:29184
    v_mfma_f32_32x32x16_bf16 v[144:159], v[64:67], v[56:59], v[144:159]
    v_mfma_f32_32x32x16_bf16 v[160:175], v[68:71], v[52:55], v[160:175]
    v_mfma_f32_32x32x16_bf16 v[176:191], v[68:71], v[56:59], v[176:191]
    s_waitcnt lgkmcnt(0)
    v_mfma_f32_32x32x16_bf16 v[96:111], v[32:35], v[40:43], v[96:111]
    ds_read_b128 v[52:55], v9 offset:16384
    ds_read_b64_tr_b16 v[60:61], v12 offset:26624
    ds_read_b64_tr_b16 v[62:63], v12 offset:27136
    v_mfma_f32_32x32x16_bf16 v[112:127], v[36:39], v[40:43], v[112:127]
    ds_read_b128 v[56:59], v9 offset:20480
    ds_read_b64_tr_b16 v[64:65], v15 offset:30720
    ds_read_b64_tr_b16 v[66:67], v15 offset:31232
    v_mfma_f32_32x32x16_bf16 v[128:143], v[44:47], v[32:35], v[128:143]
    ds_read_b64_tr_b16 v[68:69], v16 offset:30720
    ds_read_b64_tr_b16 v[70:71], v16 offset:31232
    v_mfma_f32_32x32x16_bf16 v[144:159], v[44:47], v[36:39], v[144:159]
    v_mfma_f32_32x32x16_bf16 v[160:175], v[48:51], v[32:35], v[160:175]
    v_mfma_f32_32x32x16_bf16 v[176:191], v[48:51], v[36:39], v[176:191]
    s_waitcnt lgkmcnt(0)
    v_mfma_f32_32x32x16_bf16 v[96:111], v[52:55], v[60:63], v[96:111]
    s_barrier
    ds_read_b128 v[32:35], v10 offset:16384
    ds_read_b64_tr_b16 v[40:41], v12 offset:36864
    ds_read_b64_tr_b16 v[42:43], v12 offset:37376
    v_mfma_f32_32x32x16_bf16 v[112:127], v[56:59], v[60:63], v[112:127]
    ds_read_b128 v[36:39], v10 offset:20480
    ds_read_b64_tr_b16 v[44:45], v15 offset:40960
    ds_read_b64_tr_b16 v[46:47], v15 offset:41472
    v_mfma_f32_32x32x16_bf16 v[128:143], v[64:67], v[52:55], v[128:143]
    ds_read_b64_tr_b16 v[48:49], v16 offset:40960
    ds_read_b64_tr_b16 v[50:51], v16 offset:41472
    v_mfma_f32_32x32x16_bf16 v[144:159], v[64:67], v[56:59], v[144:159]
    v_mfma_f32_32x32x16_bf16 v[160:175], v[68:71], v[52:55], v[160:175]
    v_mfma_f32_32x32x16_bf16 v[176:191], v[68:71], v[56:59], v[176:191]
    s_waitcnt lgkmcnt(0)
    v_mfma_f32_32x32x16_bf16 v[96:111], v[32:35], v[40:43], v[96:111]
    ds_read_b128 v[52:55], v11 offset:16384
    ds_read_b64_tr_b16 v[60:61], v12 offset:38912
    ds_read_b64_tr_b16 v[62:63], v12 offset:39424
    v_mfma_f32_32x32x16_bf16 v[112:127], v[36:39], v[40:43], v[112:127]
    ds_read_b128 v[56:59], v11 offset:20480
    ds_read_b64_tr_b16 v[64:65], v15 offset:43008
    ds_read_b64_tr_b16 v[66:67], v15 offset:43520
    v_mfma_f32_32x32x16_bf16 v[128:143], v[44:47], v[32:35], v[128:143]
    ds_read_b64_tr_b16 v[68:69], v16 offset:43008
    ds_read_b64_tr_b16 v[70:71], v16 offset:43520
    v_mfma_f32_32x32x16_bf16 v[144:159], v[44:47], v[36:39], v[144:159]
    v_mfma_f32_32x32x16_bf16 v[160:175], v[48:51], v[32:35], v[160:175]
    v_mfma_f32_32x32x16_bf16 v[176:191], v[48:51], v[36:39], v[176:191]
    s_waitcnt lgkmcnt(0)
    v_mfma_f32_32x32x16_bf16 v[96:111], v[52:55], v[60:63], v[96:111]
    s_barrier
    ds_read_b128 v[32:35], v8 offset:32768
    ds_read_b64_tr_b16 v[40:41], v12 offset:0
    ds_read_b64_tr_b16 v[42:43], v12 offset:512
    v_mfma_f32_32x32x16_bf16 v[112:127], v[56:59], v[60:63], v[112:127]
    ds_read_b128 v[36:39], v8 offset:36864
    ds_read_b64_tr_b16 v[44:45], v15 offset:4096
    ds_read_b64_tr_b16 v[46:47], v15 offset:4608
    v_mfma_f32_32x32x16_bf16 v[128:143], v[64:67], v[52:55], v[128:143]
    ds_read_b64_tr_b16 v[48:49], v16 offset:4096
    ds_read_b64_tr_b16 v[50:51], v16 offset:4608
    v_mfma_f32_32x32x16_bf16 v[144:159], v[64:67], v[56:59], v[144:159]
    v_mfma_f32_32x32x16_bf16 v[160:175], v[68:71], v[52:55], v[160:175]
    v_mfma_f32_32x32x16_bf16 v[176:191], v[68:71], v[56:59], v[176:191]
    s_waitcnt lgkmcnt(0)
    v_mfma_f32_32x32x16_bf16 v[96:111], v[32:35], v[40:43], v[96:111]
    ds_read_b128 v[52:55], v9 offset:32768
    ds_read_b64_tr_b16 v[60:61], v12 offset:2048
    ds_read_b64_tr_b16 v[62:63], v12 offset:2560
    v_mfma_f32_32x32x16_bf16 v[112:127], v[36:39], v[40:43], v[112:127]
    ds_read_b128 v[56:59], v9 offset:36864
    ds_read_b64_tr_b16 v[64:65], v15 offset:6144
    ds_read_b64_tr_b16 v[66:67], v15 offset:6656
    v_mfma_f32_32x32x16_bf16 v[128:143], v[44:47], v[32:35], v[128:143]
    ds_read_b64_tr_b16 v[68:69], v16 offset:6144
    ds_read_b64_tr_b16 v[70:71], v16 offset:6656
    v_mfma_f32_32x32x16_bf16 v[144:159], v[44:47], v[36:39], v[144:159]
    v_mfma_f32_32x32x16_bf16 v[160:175], v[48:51], v[32:35], v[160:175]
    v_mfma_f32_32x32x16_bf16 v[176:191], v[48:51], v[36:39], v[176:191]
    s_waitcnt lgkmcnt(0)
    v_mfma_f32_32x32x16_bf16 v[96:111], v[52:55], v[60:63], v[96:111]
    s_barrier
    ds_read_b128 v[32:35], v10 offset:32768
    ds_read_b64_tr_b16 v[40:41], v12 offset:12288
    ds_read_b64_tr_b16 v[42:43], v12 offset:12800
    v_mfma_f32_32x32x16_bf16 v[112:127], v[56:59], v[60:63], v[112:127]
    ds_read_b128 v[36:39], v10 offset:36864
    ds_read_b64_tr_b16 v[44:45], v15 offset:16384
    ds_read_b64_tr_b16 v[46:47], v15 offset:16896
    v_mfma_f32_32x32x16_bf16 v[128:143], v[64:67], v[52:55], v[128:143]
    ds_read_b64_tr_b16 v[48:49], v16 offset:16384
    ds_read_b64_tr_b16 v[50:51], v16 offset:16896
    v_mfma_f32_32x32x16_bf16 v[144:159], v[64:67], v[56:59], v[144:159]
    v_mfma_f32_32x32x16_bf16 v[160:175], v[68:71], v[52:55], v[160:175]
    s_waitcnt vmcnt(0)
    s_mov_b32 s47, 1048576
CB_NONCE:
    v_readfirstlane_b32 s74, v30
    s_nop 0
    s_cmp_lg_u32 s74, 0
    s_cbranch_scc1 CB_NONCE_OK
    s_sleep 2
    buffer_load_dword v30, v31, s[68:71], 0 offen sc1
    s_waitcnt vmcnt(0)
    s_sub_u32 s47, s47, 1
    s_cmp_lg_u32 s47, 0
    s_cbranch_scc1 CB_NONCE
CB_NONCE_OK:
    v_mov_b32 v30, s74
    v_mov_b32 v31, s74
    s_mov_b32 s49, 0
    v_mfma_f32_32x32x16_bf16 v[176:191], v[68:71], v[56:59], v[176:191]
    s_waitcnt lgkmcnt(0)
    v_mfma_f32_32x32x16_bf16 v[96:111], v[32:35], v[40:43], v[96:111]
    ds_read_b128 v[52:55], v11 offset:32768
    ds_read_b64_tr_b16 v[60:61], v12 offset:14336
    ds_read_b64_tr_b16 v[62:63], v12 offset:14848
    v_mfma_f32_32x32x16_bf16 v[112:127], v[36:39], v[40:43], v[112:127]
    ds_read_b128 v[56:59], v11 offset:36864
    ds_read_b64_tr_b16 v[64:65], v15 offset:18432
    ds_read_b64_tr_b16 v[66:67], v15 offset:18944
    v_mfma_f32_32x32x16_bf16 v[128:143], v[44:47], v[32:35], v[128:143]
    ds_read_b64_tr_b16 v[68:69], v16 offset:18432
    ds_read_b64_tr_b16 v[70:71], v16 offset:18944
    v_mfma_f32_32x32x16_bf16 v[144:159], v[44:47], v[36:39], v[144:159]
    v_mfma_f32_32x32x16_bf16 v[160:175], v[48:51], v[32:35], v[160:175]
    v_mfma_f32_32x32x16_bf16 v[176:191], v[48:51], v[36:39], v[176:191]
    s_waitcnt lgkmcnt(0)
    v_mfma_f32_32x32x16_bf16 v[96:111], v[52:55], v[60:63], v[96:111]
    s_barrier
    ds_read_b128 v[32:35], v4 offset:0
    ds_read_b64_tr_b16 v[40:41], v15 offset:24576
    ds_read_b64_tr_b16 v[42:43], v15 offset:25088
    v_mfma_f32_32x32x16_bf16 v[112:127], v[56:59], v[60:63], v[112:127]
    ds_read_b128 v[36:39], v4 offset:4096
    ds_read_b64_tr_b16 v[44:45], v16 offset:24576
    ds_read_b64_tr_b16 v[46:47], v16 offset:25088
    v_mfma_f32_32x32x16_bf16 v[128:143], v[64:67], v[52:55], v[128:143]
    v_mfma_f32_32x32x16_bf16 v[144:159], v[64:67], v[56:59], v[144:159]
    v_mfma_f32_32x32x16_bf16 v[160:175], v[68:71], v[52:55], v[160:175]
    v_mfma_f32_32x32x16_bf16 v[176:191], v[68:71], v[56:59], v[176:191]
    s_waitcnt lgkmcnt(0)
    v_mfma_f32_32x32x16_bf16 v[192:207], v[40:43], v[32:35], 0
    s_barrier
    ds_read_b128 v[48:51], v5 offset:0
    ds_read_b64_tr_b16 v[56:57], v15 offset:26624
    ds_read_b64_tr_b16 v[58:59], v15 offset:27136
    ds_read_b128 v[52:55], v5 offset:4096
    s_add_u32 s44, s39, 0
    s_lshl_b32 s44, s44, s42
    s_add_u32 s44, s44, s43
    v_cvt_pk_bf16_f32 v80, v96, v97
    v_cvt_pk_bf16_f32 v81, v98, v99
    v_cvt_pk_bf16_f32 v82, v100, v101
    v_cvt_pk_bf16_f32 v83, v102, v103
    v_cndmask_b32 v80, v80, v18, s[52:53]
    v_cndmask_b32 v81, v81, v18, s[52:53]
    v_cndmask_b32 v82, v82, v18, s[52:53]
    v_cndmask_b32 v83, v83, v18, s[52:53]
    buffer_store_dwordx4 v[80:83], v2, s[24:27], s44 offen offset:2048 sc1
    v_cvt_pk_bf16_f32 v84, v104, v105
    v_cvt_pk_bf16_f32 v85, v106, v107
    v_cvt_pk_bf16_f32 v86, v108, v109
    v_cvt_pk_bf16_f32 v87, v110, v111
    v_cndmask_b32 v84, v84, v18, s[52:53]
    v_cndmask_b32 v85, v85, v18, s[52:53]
    v_cndmask_b32 v86, v86, v18, s[52:53]
    v_cndmask_b32 v87, v87, v18, s[52:53]
    buffer_store_dwordx4 v[84:87], v2, s[24:27], s44 offen offset:3072 sc1
    s_add_u32 s44, s39, 1
    s_lshl_b32 s44, s44, s42
    s_add_u32 s44, s44, s43
    v_cvt_pk_bf16_f32 v88, v112, v113
    v_cvt_pk_bf16_f32 v89, v114, v115
    v_cvt_pk_bf16_f32 v90, v116, v117
    v_cvt_pk_bf16_f32 v91, v118, v119
    v_cndmask_b32 v88, v88, v18, s[52:53]
    v_cndmask_b32 v89, v89, v18, s[52:53]
    v_cndmask_b32 v90, v90, v18, s[52:53]
    v_cndmask_b32 v91, v91, v18, s[52:53]
    buffer_store_dwordx4 v[88:91], v2, s[24:27], s44 offen offset:2048 sc1
    v_cvt_pk_bf16_f32 v92, v120, v121
    v_cvt_pk_bf16_f32 v93, v122, v123
    v_cvt_pk_bf16_f32 v94, v124, v125
    v_cvt_pk_bf16_f32 v95, v126, v127
    v_cndmask_b32 v92, v92, v18, s[52:53]
    v_cndmask_b32 v93, v93, v18, s[52:53]
    v_cndmask_b32 v94, v94, v18, s[52:53]
    v_cndmask_b32 v95, v95, v18, s[52:53]
    buffer_store_dwordx4 v[92:95], v2, s[24:27], s44 offen offset:3072 sc1
    v_max_f32 v128, 0, v128
    v_max_f32 v129, 0, v129
    v_max_f32 v130, 0, v130
    v_max_f32 v131, 0, v131
    v_max_f32 v132, 0, v132
    v_max_f32 v133, 0, v133
    v_max_f32 v134, 0, v134
    v_max_f32 v135, 0, v135
    v_mul_f32 v128, v128, v136
    v_mul_f32 v129, v129, v137
    v_mul_f32 v130, v130, v138
    v_mul_f32 v131, v131, v139
    v_mul_f32 v132, v132, v140
    v_mul_f32 v133, v133, v141
    v_mul_f32 v134, v134, v142
    v_mul_f32 v135, v135, v143
    v_cvt_pk_bf16_f32 v80, v128, v129
    v_cvt_pk_bf16_f32 v81, v130, v131
    v_cvt_pk_bf16_f32 v82, v132, v133
    v_cvt_pk_bf16_f32 v83, v134, v135
    v_mfma_f32_32x32x16_bf16 v[208:223], v[40:43], v[36:39], 0
    ds_read_b64_tr_b16 v[60:61], v16 offset:26624
    ds_read_b64_tr_b16 v[62:63], v16 offset:27136
    ds_read_b128 v[64:67], v6 offset:0
    ds_read_b64_tr_b16 v[72:73], v15 offset:32768
    v_max_f32 v144, 0, v144
    v_mfma_f32_32x32x16_bf16 v[224:239], v[44:47], v[32:35], 0
    ds_read_b64_tr_b16 v[74:75], v15 offset:33280
    ds_read_b128 v[68:71], v6 offset:4096
    ds_read_b64_tr_b16 v[76:77], v16 offset:32768
    ds_read_b64_tr_b16 v[78:79], v16 offset:33280
    v_max_f32 v145, 0, v145
    v_mfma_f32_32x32x16_bf16 v[240:255], v[44:47], v[36:39], 0
    v_max_f32 v146, 0, v146
    v_max_f32 v147, 0, v147
    v_max_f32 v148, 0, v148
    v_max_f32 v149, 0, v149
    v_max_f32 v150, 0, v150
    s_waitcnt lgkmcnt(6)
    v_mfma_f32_32x32x16_bf16 v[192:207], v[56:59], v[48:51], v[192:207]
    ds_read_b128 v[32:35], v7 offset:0
    ds_read_b64_tr_b16 v[40:41], v15 offset:34816
    ds_read_b64_tr_b16 v[42:43], v15 offset:35328
    v_max_f32 v151, 0, v151
    v_mul_f32 v144, v144, v152
    v_mfma_f32_32x32x16_bf16 v[208:223], v[56:59], v[52:55], v[208:223]
    ds_read_b128 v[36:39], v7 offset:4096
    ds_read_b64_tr_b16 v[44:45], v16 offset:34816
    ds_read_b64_tr_b16 v[46:47], v16 offset:35328
    v_mul_f32 v145, v145, v153
    v_mul_f32 v146, v146, v154
    v_mfma_f32_32x32x16_bf16 v[224:239], v[60:63], v[48:51], v[224:239]
    v_mul_f32 v147, v147, v155
    v_mul_f32 v148, v148, v156
    v_mul_f32 v149, v149, v157
    v_mul_f32 v150, v150, v158
    v_mul_f32 v151, v151, v159
    v_mfma_f32_32x32x16_bf16 v[240:255], v[60:63], v[52:55], v[240:255]
    v_cvt_pk_bf16_f32 v84, v144, v145
    v_cvt_pk_bf16_f32 v85, v146, v147
    v_cvt_pk_bf16_f32 v86, v148, v149
    v_cvt_pk_bf16_f32 v87, v150, v151
    v_max_f32 v160, 0, v160
    s_waitcnt lgkmcnt(6)
    v_mfma_f32_32x32x16_bf16 v[192:207], v[72:75], v[64:67], v[192:207]
    s_barrier
    ds_read_b128 v[48:51], v4 offset:16384
    ds_read_b64_tr_b16 v[56:57], v15 offset:40960
    ds_read_b64_tr_b16 v[58:59], v15 offset:41472
    v_max_f32 v161, 0, v161
    v_max_f32 v162, 0, v162
    v_mfma_f32_32x32x16_bf16 v[208:223], v[72:75], v[68:71], v[208:223]
    ds_read_b128 v[52:55], v4 offset:20480
    ds_read_b64_tr_b16 v[60:61], v16 offset:40960
    ds_read_b64_tr_b16 v[62:63], v16 offset:41472
    v_max_f32 v163, 0, v163
    v_max_f32 v164, 0, v164
    s_getreg_b32 s45, hwreg(HW_REG_IB_STS, 0, 4)
    v_mfma_f32_32x32x16_bf16 v[224:239], v[76:79], v[64:67], v[224:239]
    v_max_f32 v165, 0, v165
    v_max_f32 v166, 0, v166
    v_max_f32 v167, 0, v167
    v_mul_f32 v160, v160, v168
    v_mul_f32 v161, v161, v169
    s_or_b32 s45, s45, s49
    v_mfma_f32_32x32x16_bf16 v[240:255], v[76:79], v[68:71], v[240:255]
    v_mul_f32 v162, v162, v170
    v_mul_f32 v163, v163, v171
    v_mul_f32 v164, v164, v172
    v_mul_f32 v165, v165, v173
    v_mul_f32 v166, v166, v174
    s_cbranch_scc0 CB_PUB30
CB_PUBR30:
    s_waitcnt lgkmcnt(6)
    v_mfma_f32_32x32x16_bf16 v[192:207], v[40:43], v[32:35], v[192:207]
    ds_read_b128 v[64:67], v5 offset:16384
    ds_read_b64_tr_b16 v[72:73], v15 offset:43008
    ds_read_b64_tr_b16 v[74:75], v15 offset:43520
    v_mul_f32 v167, v167, v175
    v_cvt_pk_bf16_f32 v88, v160, v161
    v_mfma_f32_32x32x16_bf16 v[208:223], v[40:43], v[36:39], v[208:223]
    ds_read_b128 v[68:71], v5 offset:20480
    ds_read_b64_tr_b16 v[76:77], v16 offset:43008
    ds_read_b64_tr_b16 v[78:79], v16 offset:43520
    v_cvt_pk_bf16_f32 v89, v162, v163
    v_cvt_pk_bf16_f32 v90, v164, v165
    s_getreg_b32 s45, hwreg(HW_REG_IB_STS, 0, 4)
    v_mfma_f32_32x32x16_bf16 v[224:239], v[44:47], v[32:35], v[224:239]
    v_cvt_pk_bf16_f32 v91, v166, v167
    v_max_f32 v176, 0, v176
    v_max_f32 v177, 0, v177
    v_max_f32 v178, 0, v178
    v_max_f32 v179, 0, v179
    s_or_b32 s45, s45, s49
    v_mfma_f32_32x32x16_bf16 v[240:255], v[44:47], v[36:39], v[240:255]
    v_max_f32 v180, 0, v180
    v_max_f32 v181, 0, v181
    v_max_f32 v182, 0, v182
    v_max_f32 v183, 0, v183
    v_mul_f32 v176, v176, v184
    s_cbranch_scc0 CB_PUB31
CB_PUBR31:
    s_waitcnt lgkmcnt(6)
    v_mfma_f32_32x32x16_bf16 v[192:207], v[56:59], v[48:51], v[192:207]
    s_barrier
    ds_read_b128 v[32:35], v6 offset:16384
    ds_read_b64_tr_b16 v[40:41], v15 offset:0
    ds_read_b64_tr_b16 v[42:43], v15 offset:512
    v_mul_f32 v177, v177, v185
    v_mul_f32 v178, v178, v186
    v_mfma_f32_32x32x16_bf16 v[208:223], v[56:59], v[52:55], v[208:223]
    ds_read_b128 v[36:39], v6 offset:20480
    ds_read_b64_tr_b16 v[44:45], v16 offset:0
    ds_read_b64_tr_b16 v[46:47], v16 offset:512
    v_mul_f32 v179, v179, v187
    v_mul_f32 v180, v180, v188
    s_getreg_b32 s45, hwreg(HW_REG_IB_STS, 0, 4)
    v_mfma_f32_32x32x16_bf16 v[224:239], v[60:63], v[48:51], v[224:239]
    v_mul_f32 v181, v181, v189
    v_mul_f32 v182, v182, v190
    v_mul_f32 v183, v183, v191
    v_cvt_pk_bf16_f32 v92, v176, v177
    v_cvt_pk_bf16_f32 v93, v178, v179
    s_or_b32 s45, s45, s49
    v_mfma_f32_32x32x16_bf16 v[240:255], v[60:63], v[52:55], v[240:255]
    v_cvt_pk_bf16_f32 v94, v180, v181
    v_cvt_pk_bf16_f32 v95, v182, v183
    s_cbranch_scc0 CB_PUB32
CB_PUBR32:
    s_waitcnt lgkmcnt(6)
    v_mfma_f32_32x32x16_bf16 v[192:207], v[72:75], v[64:67], v[192:207]
    ds_read_b128 v[48:51], v7 offset:16384
    ds_read_b64_tr_b16 v[56:57], v15 offset:2048
    ds_read_b64_tr_b16 v[58:59], v15 offset:2560
    v_mfma_f32_32x32x16_bf16 v[208:223], v[72:75], v[68:71], v[208:223]
    ds_read_b128 v[52:55], v7 offset:20480
    ds_read_b64_tr_b16 v[60:61], v16 offset:2048
    ds_read_b64_tr_b16 v[62:63], v16 offset:2560
    s_getreg_b32 s45, hwreg(HW_REG_IB_STS, 0, 4)
    v_mfma_f32_32x32x16_bf16 v[224:239], v[76:79], v[64:67], v[224:239]
    s_or_b32 s45, s45, s49
    v_mfma_f32_32x32x16_bf16 v[240:255], v[76:79], v[68:71], v[240:255]
    s_cbranch_scc0 CB_PUB33
CB_PUBR33:
    s_waitcnt lgkmcnt(6)
    v_mfma_f32_32x32x16_bf16 v[192:207], v[40:43], v[32:35], v[192:207]
    s_barrier
    ds_read_b128 v[64:67], v4 offset:32768
    ds_read_b64_tr_b16 v[72:73], v15 offset:8192
    ds_read_b64_tr_b16 v[74:75], v15 offset:8704
    v_mfma_f32_32x32x16_bf16 v[208:223], v[40:43], v[36:39], v[208:223]
    ds_read_b128 v[68:71], v4 offset:36864
    ds_read_b64_tr_b16 v[76:77], v16 offset:8192
    ds_read_b64_tr_b16 v[78:79], v16 offset:8704
    s_getreg_b32 s45, hwreg(HW_REG_IB_STS, 0, 4)
    v_mfma_f32_32x32x16_bf16 v[224:239], v[44:47], v[32:35], v[224:239]
    s_or_b32 s45, s45, s49
    v_mfma_f32_32x32x16_bf16 v[240:255], v[44:47], v[36:39], v[240:255]
    s_cbranch_scc0 CB_PUB34
CB_PUBR34:
    s_waitcnt lgkmcnt(6)
    v_mfma_f32_32x32x16_bf16 v[192:207], v[56:59], v[48:51], v[192:207]
    ds_read_b128 v[32:35], v5 offset:32768
    ds_read_b64_tr_b16 v[40:41], v15 offset:10240
    ds_read_b64_tr_b16 v[42:43], v15 offset:10752
    v_mfma_f32_32x32x16_bf16 v[208:223], v[56:59], v[52:55], v[208:223]
    ds_read_b128 v[36:39], v5 offset:36864
    ds_read_b64_tr_b16 v[44:45], v16 offset:10240
    ds_read_b64_tr_b16 v[46:47], v16 offset:10752
    s_getreg_b32 s45, hwreg(HW_REG_IB_STS, 0, 4)
    v_mfma_f32_32x32x16_bf16 v[224:239], v[60:63], v[48:51], v[224:239]
    s_or_b32 s45, s45, s49
    v_mfma_f32_32x32x16_bf16 v[240:255], v[60:63], v[52:55], v[240:255]
    s_cbranch_scc0 CB_PUB35
CB_PUBR35:
    s_waitcnt lgkmcnt(6)
    v_mfma_f32_32x32x16_bf16 v[192:207], v[72:75], v[64:67], v[192:207]
    s_barrier
    ds_read_b128 v[48:51], v6 offset:32768
    ds_read_b64_tr_b16 v[56:57], v15 offset:16384
    ds_read_b64_tr_b16 v[58:59], v15 offset:16896
    v_mfma_f32_32x32x16_bf16 v[208:223], v[72:75], v[68:71], v[208:223]
    ds_read_b128 v[52:55], v6 offset:36864
    ds_read_b64_tr_b16 v[60:61], v16 offset:16384
    ds_read_b64_tr_b16 v[62:63], v16 offset:16896
    s_getreg_b32 s45, hwreg(HW_REG_IB_STS, 0, 4)
    v_mfma_f32_32x32x16_bf16 v[224:239], v[76:79], v[64:67], v[224:239]
    s_or_b32 s45, s45, s49
    v_mfma_f32_32x32x16_bf16 v[240:255], v[76:79], v[68:71], v[240:255]
    s_cbranch_scc0 CB_PUB36
CB_PUBR36:
    s_waitcnt lgkmcnt(6)
    v_mfma_f32_32x32x16_bf16 v[192:207], v[40:43], v[32:35], v[192:207]
    ds_read_b128 v[64:67], v7 offset:32768
    ds_read_b64_tr_b16 v[72:73], v15 offset:18432
    ds_read_b64_tr_b16 v[74:75], v15 offset:18944
    v_mfma_f32_32x32x16_bf16 v[208:223], v[40:43], v[36:39], v[208:223]
    ds_read_b128 v[68:71], v7 offset:36864
    ds_read_b64_tr_b16 v[76:77], v16 offset:18432
    ds_read_b64_tr_b16 v[78:79], v16 offset:18944
    s_getreg_b32 s45, hwreg(HW_REG_IB_STS, 0, 4)
    v_mfma_f32_32x32x16_bf16 v[224:239], v[44:47], v[32:35], v[224:239]
    s_or_b32 s45, s45, s49
    v_mfma_f32_32x32x16_bf16 v[240:255], v[44:47], v[36:39], v[240:255]
    s_cbranch_scc0 CB_PUB37
CB_PUBR37:
    s_waitcnt lgkmcnt(6)
    v_mfma_f32_32x32x16_bf16 v[192:207], v[56:59], v[48:51], v[192:207]
    s_barrier
    ds_read_b128 v[32:35], v4 offset:49152
    ds_read_b64_tr_b16 v[40:41], v15 offset:24576
    ds_read_b64_tr_b16 v[42:43], v15 offset:25088
    v_mfma_f32_32x32x16_bf16 v[208:223], v[56:59], v[52:55], v[208:223]
    ds_read_b128 v[36:39], v4 offset:53248
    ds_read_b64_tr_b16 v[44:45], v16 offset:24576
    ds_read_b64_tr_b16 v[46:47], v16 offset:25088
    s_getreg_b32 s45, hwreg(HW_REG_IB_STS, 0, 4)
    v_mfma_f32_32x32x16_bf16 v[224:239], v[60:63], v[48:51], v[224:239]
    s_or_b32 s45, s45, s49
    v_mfma_f32_32x32x16_bf16 v[240:255], v[60:63], v[52:55], v[240:255]
    s_cbranch_scc0 CB_PUB38
CB_PUBR38:
    s_waitcnt lgkmcnt(6)
    v_mfma_f32_32x32x16_bf16 v[192:207], v[72:75], v[64:67], v[192:207]
    ds_read_b128 v[48:51], v5 offset:49152
    ds_read_b64_tr_b16 v[56:57], v15 offset:26624
    ds_read_b64_tr_b16 v[58:59], v15 offset:27136
    v_mfma_f32_32x32x16_bf16 v[208:223], v[72:75], v[68:71], v[208:223]
    ds_read_b128 v[52:55], v5 offset:53248
    ds_read_b64_tr_b16 v[60:61], v16 offset:26624
    ds_read_b64_tr_b16 v[62:63], v16 offset:27136
    s_getreg_b32 s45, hwreg(HW_REG_IB_STS, 0, 4)
    v_mfma_f32_32x32x16_bf16 v[224:239], v[76:79], v[64:67], v[224:239]
    s_or_b32 s45, s45, s49
    v_mfma_f32_32x32x16_bf16 v[240:255], v[76:79], v[68:71], v[240:255]
    s_cbranch_scc0 CB_PUB39
CB_PUBR39:
    s_waitcnt lgkmcnt(6)
    v_mfma_f32_32x32x16_bf16 v[192:207], v[40:43], v[32:35], v[192:207]
    s_barrier
    ds_read_b128 v[64:67], v6 offset:49152
    ds_read_b64_tr_b16 v[72:73], v15 offset:32768
    ds_read_b64_tr_b16 v[74:75], v15 offset:33280
    v_mfma_f32_32x32x16_bf16 v[208:223], v[40:43], v[36:39], v[208:223]
    ds_read_b128 v[68:71], v6 offset:53248
    ds_read_b64_tr_b16 v[76:77], v16 offset:32768
    ds_read_b64_tr_b16 v[78:79], v16 offset:33280
    s_getreg_b32 s45, hwreg(HW_REG_IB_STS, 0, 4)
    v_mfma_f32_32x32x16_bf16 v[224:239], v[44:47], v[32:35], v[224:239]
    s_or_b32 s45, s45, s49
    v_mfma_f32_32x32x16_bf16 v[240:255], v[44:47], v[36:39], v[240:255]
    s_cbranch_scc0 CB_PUB40
CB_PUBR40:
    s_waitcnt lgkmcnt(6)
    v_mfma_f32_32x32x16_bf16 v[192:207], v[56:59], v[48:51], v[192:207]
    ds_read_b128 v[32:35], v7 offset:49152
    ds_read_b64_tr_b16 v[40:41], v15 offset:34816
    ds_read_b64_tr_b16 v[42:43], v15 offset:35328
    v_mfma_f32_32x32x16_bf16 v[208:223], v[56:59], v[52:55], v[208:223]
    ds_read_b128 v[36:39], v7 offset:53248
    ds_read_b64_tr_b16 v[44:45], v16 offset:34816
    ds_read_b64_tr_b16 v[46:47], v16 offset:35328
    s_getreg_b32 s45, hwreg(HW_REG_IB_STS, 0, 4)
    v_mfma_f32_32x32x16_bf16 v[224:239], v[60:63], v[48:51], v[224:239]
    s_or_b32 s45, s45, s49
    v_mfma_f32_32x32x16_bf16 v[240:255], v[60:63], v[52:55], v[240:255]
    s_cbranch_scc0 CB_PUB41
CB_PUBR41:
    s_waitcnt lgkmcnt(6)
    v_mfma_f32_32x32x16_bf16 v[192:207], v[72:75], v[64:67], v[192:207]
    s_barrier
    ds_read_b128 v[48:51], v8 offset:0
    ds_read_b64_tr_b16 v[56:57], v15 offset:40960
    ds_read_b64_tr_b16 v[58:59], v15 offset:41472
    v_mfma_f32_32x32x16_bf16 v[208:223], v[72:75], v[68:71], v[208:223]
    ds_read_b128 v[52:55], v8 offset:4096
    ds_read_b64_tr_b16 v[60:61], v16 offset:40960
    ds_read_b64_tr_b16 v[62:63], v16 offset:41472
    s_getreg_b32 s45, hwreg(HW_REG_IB_STS, 0, 4)
    v_mfma_f32_32x32x16_bf16 v[224:239], v[76:79], v[64:67], v[224:239]
    s_or_b32 s45, s45, s49
    v_mfma_f32_32x32x16_bf16 v[240:255], v[76:79], v[68:71], v[240:255]
    s_cbranch_scc0 CB_PUB42
CB_PUBR42:
    s_waitcnt lgkmcnt(6)
    v_mfma_f32_32x32x16_bf16 v[192:207], v[40:43], v[32:35], v[192:207]
    ds_read_b128 v[64:67], v9 offset:0
    ds_read_b64_tr_b16 v[72:73], v15 offset:43008
    ds_read_b64_tr_b16 v[74:75], v15 offset:43520
    v_mfma_f32_32x32x16_bf16 v[208:223], v[40:43], v[36:39], v[208:223]
    ds_read_b128 v[68:71], v9 offset:4096
    ds_read_b64_tr_b16 v[76:77], v16 offset:43008
    ds_read_b64_tr_b16 v[78:79], v16 offset:43520
    s_getreg_b32 s45, hwreg(HW_REG_IB_STS, 0, 4)
    v_mfma_f32_32x32x16_bf16 v[224:239], v[44:47], v[32:35], v[224:239]
    s_or_b32 s45, s45, s49
    v_mfma_f32_32x32x16_bf16 v[240:255], v[44:47], v[36:39], v[240:255]
    s_cbranch_scc0 CB_PUB43
CB_PUBR43:
    s_waitcnt lgkmcnt(6)
    v_mfma_f32_32x32x16_bf16 v[192:207], v[56:59], v[48:51], v[192:207]
    s_barrier
    ds_read_b128 v[32:35], v10 offset:0
    ds_read_b64_tr_b16 v[40:41], v15 offset:0
    ds_read_b64_tr_b16 v[42:43], v15 offset:512
    v_mfma_f32_32x32x16_bf16 v[208:223], v[56:59], v[52:55], v[208:223]
    ds_read_b128 v[36:39], v10 offset:4096
    ds_read_b64_tr_b16 v[44:45], v16 offset:0
    ds_read_b64_tr_b16 v[46:47], v16 offset:512
    s_getreg_b32 s45, hwreg(HW_REG_IB_STS, 0, 4)
    v_mfma_f32_32x32x16_bf16 v[224:239], v[60:63], v[48:51], v[224:239]
    s_or_b32 s45, s45, s49
    v_mfma_f32_32x32x16_bf16 v[240:255], v[60:63], v[52:55], v[240:255]
    s_cbranch_scc0 CB_PUB44
CB_PUBR44:
    s_waitcnt lgkmcnt(6)
    v_mfma_f32_32x32x16_bf16 v[192:207], v[72:75], v[64:67], v[192:207]
    ds_read_b128 v[48:51], v11 offset:0
    ds_read_b64_tr_b16 v[56:57], v15 offset:2048
    ds_read_b64_tr_b16 v[58:59], v15 offset:2560
    v_mfma_f32_32x32x16_bf16 v[208:223], v[72:75], v[68:71], v[208:223]
    ds_read_b128 v[52:55], v11 offset:4096
    ds_read_b64_tr_b16 v[60:61], v16 offset:2048
    ds_read_b64_tr_b16 v[62:63], v16 offset:2560
    s_getreg_b32 s45, hwreg(HW_REG_IB_STS, 0, 4)
    v_mfma_f32_32x32x16_bf16 v[224:239], v[76:79], v[64:67], v[224:239]
    s_or_b32 s45, s45, s49
    v_mfma_f32_32x32x16_bf16 v[240:255], v[76:79], v[68:71], v[240:255]
    s_cbranch_scc0 CB_PUB45
CB_PUBR45:
    s_waitcnt lgkmcnt(6)
    v_mfma_f32_32x32x16_bf16 v[192:207], v[40:43], v[32:35], v[192:207]
    s_barrier
    ds_read_b128 v[64:67], v8 offset:16384
    ds_read_b64_tr_b16 v[72:73], v15 offset:8192
    ds_read_b64_tr_b16 v[74:75], v15 offset:8704
    v_mfma_f32_32x32x16_bf16 v[208:223], v[40:43], v[36:39], v[208:223]
    ds_read_b128 v[68:71], v8 offset:20480
    ds_read_b64_tr_b16 v[76:77], v16 offset:8192
    ds_read_b64_tr_b16 v[78:79], v16 offset:8704
    s_getreg_b32 s45, hwreg(HW_REG_IB_STS, 0, 4)
    v_mfma_f32_32x32x16_bf16 v[224:239], v[44:47], v[32:35], v[224:239]
    s_or_b32 s45, s45, s49
    v_mfma_f32_32x32x16_bf16 v[240:255], v[44:47], v[36:39], v[240:255]
    s_cbranch_scc0 CB_PUB46
CB_PUBR46:
    s_waitcnt lgkmcnt(6)
    v_mfma_f32_32x32x16_bf16 v[192:207], v[56:59], v[48:51], v[192:207]
    ds_read_b128 v[32:35], v9 offset:16384
    ds_read_b64_tr_b16 v[40:41], v15 offset:10240
    ds_read_b64_tr_b16 v[42:43], v15 offset:10752
    v_mfma_f32_32x32x16_bf16 v[208:223], v[56:59], v[52:55], v[208:223]
    ds_read_b128 v[36:39], v9 offset:20480
    ds_read_b64_tr_b16 v[44:45], v16 offset:10240
    ds_read_b64_tr_b16 v[46:47], v16 offset:10752
    s_getreg_b32 s45, hwreg(HW_REG_IB_STS, 0, 4)
    v_mfma_f32_32x32x16_bf16 v[224:239], v[60:63], v[48:51], v[224:239]
    s_or_b32 s45, s45, s49
    v_mfma_f32_32x32x16_bf16 v[240:255], v[60:63], v[52:55], v[240:255]
    s_cbranch_scc0 CB_PUB47
CB_PUBR47:
    s_waitcnt lgkmcnt(6)
    v_mfma_f32_32x32x16_bf16 v[192:207], v[72:75], v[64:67], v[192:207]
    s_barrier
    ds_read_b128 v[48:51], v10 offset:16384
    ds_read_b64_tr_b16 v[56:57], v15 offset:16384
    ds_read_b64_tr_b16 v[58:59], v15 offset:16896
    v_mfma_f32_32x32x16_bf16 v[208:223], v[72:75], v[68:71], v[208:223]
    ds_read_b128 v[52:55], v10 offset:20480
    ds_read_b64_tr_b16 v[60:61], v16 offset:16384
    ds_read_b64_tr_b16 v[62:63], v16 offset:16896
    s_getreg_b32 s45, hwreg(HW_REG_IB_STS, 0, 4)
    v_mfma_f32_32x32x16_bf16 v[224:239], v[76:79], v[64:67], v[224:239]
    s_or_b32 s45, s45, s49
    v_mfma_f32_32x32x16_bf16 v[240:255], v[76:79], v[68:71], v[240:255]
    s_cbranch_scc0 CB_PUB48
CB_PUBR48:
    s_waitcnt lgkmcnt(6)
    v_mfma_f32_32x32x16_bf16 v[192:207], v[40:43], v[32:35], v[192:207]
    ds_read_b128 v[64:67], v11 offset:16384
    ds_read_b64_tr_b16 v[72:73], v15 offset:18432
    ds_read_b64_tr_b16 v[74:75], v15 offset:18944
    v_mfma_f32_32x32x16_bf16 v[208:223], v[40:43], v[36:39], v[208:223]
    ds_read_b128 v[68:71], v11 offset:20480
    ds_read_b64_tr_b16 v[76:77], v16 offset:18432
    ds_read_b64_tr_b16 v[78:79], v16 offset:18944
    s_getreg_b32 s45, hwreg(HW_REG_IB_STS, 0, 4)
    v_mfma_f32_32x32x16_bf16 v[224:239], v[44:47], v[32:35], v[224:239]
    s_or_b32 s45, s45, s49
    v_mfma_f32_32x32x16_bf16 v[240:255], v[44:47], v[36:39], v[240:255]
    s_cbranch_scc0 CB_PUB49
CB_PUBR49:
    s_waitcnt lgkmcnt(6)
    v_mfma_f32_32x32x16_bf16 v[192:207], v[56:59], v[48:51], v[192:207]
    s_barrier
    ds_read_b128 v[32:35], v8 offset:32768
    ds_read_b64_tr_b16 v[40:41], v15 offset:24576
    ds_read_b64_tr_b16 v[42:43], v15 offset:25088
    v_mfma_f32_32x32x16_bf16 v[208:223], v[56:59], v[52:55], v[208:223]
    ds_read_b128 v[36:39], v8 offset:36864
    ds_read_b64_tr_b16 v[44:45], v16 offset:24576
    ds_read_b64_tr_b16 v[46:47], v16 offset:25088
    s_getreg_b32 s45, hwreg(HW_REG_IB_STS, 0, 4)
    v_mfma_f32_32x32x16_bf16 v[224:239], v[60:63], v[48:51], v[224:239]
    s_or_b32 s45, s45, s49
    v_mfma_f32_32x32x16_bf16 v[240:255], v[60:63], v[52:55], v[240:255]
    s_cbranch_scc0 CB_PUB50
CB_PUBR50:
    s_waitcnt lgkmcnt(6)
    v_mfma_f32_32x32x16_bf16 v[192:207], v[72:75], v[64:67], v[192:207]
    ds_read_b128 v[48:51], v9 offset:32768
    ds_read_b64_tr_b16 v[56:57], v15 offset:26624
    ds_read_b64_tr_b16 v[58:59], v15 offset:27136
    v_mfma_f32_32x32x16_bf16 v[208:223], v[72:75], v[68:71], v[208:223]
    ds_read_b128 v[52:55], v9 offset:36864
    ds_read_b64_tr_b16 v[60:61], v16 offset:26624
    ds_read_b64_tr_b16 v[62:63], v16 offset:27136
    s_getreg_b32 s45, hwreg(HW_REG_IB_STS, 0, 4)
    v_mfma_f32_32x32x16_bf16 v[224:239], v[76:79], v[64:67], v[224:239]
    s_or_b32 s45, s45, s49
    v_mfma_f32_32x32x16_bf16 v[240:255], v[76:79], v[68:71], v[240:255]
    s_cbranch_scc0 CB_PUB51
CB_PUBR51:
    s_waitcnt lgkmcnt(6)
    v_mfma_f32_32x32x16_bf16 v[192:207], v[40:43], v[32:35], v[192:207]
    s_barrier
    ds_read_b128 v[64:67], v10 offset:32768
    ds_read_b64_tr_b16 v[72:73], v15 offset:32768
    ds_read_b64_tr_b16 v[74:75], v15 offset:33280
    v_mfma_f32_32x32x16_bf16 v[208:223], v[40:43], v[36:39], v[208:223]
    ds_read_b128 v[68:71], v10 offset:36864
    ds_read_b64_tr_b16 v[76:77], v16 offset:32768
    ds_read_b64_tr_b16 v[78:79], v16 offset:33280
    s_getreg_b32 s45, hwreg(HW_REG_IB_STS, 0, 4)
    v_mfma_f32_32x32x16_bf16 v[224:239], v[44:47], v[32:35], v[224:239]
    s_or_b32 s45, s45, s49
    v_mfma_f32_32x32x16_bf16 v[240:255], v[44:47], v[36:39], v[240:255]
    s_cbranch_scc0 CB_PUB52
CB_PUBR52:
    s_waitcnt lgkmcnt(6)
    v_mfma_f32_32x32x16_bf16 v[192:207], v[56:59], v[48:51], v[192:207]
    ds_read_b128 v[32:35], v11 offset:32768
    ds_read_b64_tr_b16 v[40:41], v15 offset:34816
    ds_read_b64_tr_b16 v[42:43], v15 offset:35328
    v_mfma_f32_32x32x16_bf16 v[208:223], v[56:59], v[52:55], v[208:223]
    ds_read_b128 v[36:39], v11 offset:36864
    ds_read_b64_tr_b16 v[44:45], v16 offset:34816
    ds_read_b64_tr_b16 v[46:47], v16 offset:35328
    s_getreg_b32 s45, hwreg(HW_REG_IB_STS, 0, 4)
    v_mfma_f32_32x32x16_bf16 v[224:239], v[60:63], v[48:51], v[224:239]
    s_or_b32 s45, s45, s49
    v_mfma_f32_32x32x16_bf16 v[240:255], v[60:63], v[52:55], v[240:255]
    s_cbranch_scc0 CB_PUB53
CB_PUBR53:
    s_waitcnt lgkmcnt(6)
    v_mfma_f32_32x32x16_bf16 v[192:207], v[72:75], v[64:67], v[192:207]
    v_mfma_f32_32x32x16_bf16 v[208:223], v[72:75], v[68:71], v[208:223]
    s_cmp_lg_u32 s49, 0
    s_cbranch_scc1 CB_W54
    s_waitcnt vmcnt(0)
CB_W54:
    s_getreg_b32 s45, hwreg(HW_REG_IB_STS, 0, 4)
    v_mfma_f32_32x32x16_bf16 v[224:239], v[76:79], v[64:67], v[224:239]
    s_or_b32 s45, s45, s49
    v_mfma_f32_32x32x16_bf16 v[240:255], v[76:79], v[68:71], v[240:255]
    s_cbranch_scc0 CB_PUB54
CB_PUBR54:
    s_waitcnt lgkmcnt(0)
    v_mfma_f32_32x32x16_bf16 v[192:207], v[40:43], v[32:35], v[192:207]
    v_mfma_f32_32x32x16_bf16 v[208:223], v[40:43], v[36:39], v[208:223]
    v_mfma_f32_32x32x16_bf16 v[224:239], v[44:47], v[32:35], v[224:239]
    v_mfma_f32_32x32x16_bf16 v[240:255], v[44:47], v[36:39], v[240:255]
    s_branch ROLE_A
CB_PUB30:
    s_mov_b64 exec, 0xffff
    buffer_store_dwordx2 v[30:31], v17, s[24:27], s48 offen sc1
    s_mov_b64 exec, -1
    s_mov_b32 s49, 1
    s_branch CB_PUBR30
CB_PUB31:
    s_mov_b64 exec, 0xffff
    buffer_store_dwordx2 v[30:31], v17, s[24:27], s48 offen sc1
    s_mov_b64 exec, -1
    s_mov_b32 s49, 1
    s_branch CB_PUBR31
CB_PUB32:
    s_mov_b64 exec, 0xffff
    buffer_store_dwordx2 v[30:31], v17, s[24:27], s48 offen sc1
    s_mov_b64 exec, -1
    s_mov_b32 s49, 1
    s_branch CB_PUBR32
CB_PUB33:
    s_mov_b64 exec, 0xffff
    buffer_store_dwordx2 v[30:31], v17, s[24:27], s48 offen sc1
    s_mov_b64 exec, -1
    s_mov_b32 s49, 1
    s_branch CB_PUBR33
CB_PUB34:
    s_mov_b64 exec, 0xffff
    buffer_store_dwordx2 v[30:31], v17, s[24:27], s48 offen sc1
    s_mov_b64 exec, -1
    s_mov_b32 s49, 1
    s_branch CB_PUBR34
CB_PUB35:
    s_mov_b64 exec, 0xffff
    buffer_store_dwordx2 v[30:31], v17, s[24:27], s48 offen sc1
    s_mov_b64 exec, -1
    s_mov_b32 s49, 1
    s_branch CB_PUBR35
CB_PUB36:
    s_mov_b64 exec, 0xffff
    buffer_store_dwordx2 v[30:31], v17, s[24:27], s48 offen sc1
    s_mov_b64 exec, -1
    s_mov_b32 s49, 1
    s_branch CB_PUBR36
CB_PUB37:
    s_mov_b64 exec, 0xffff
    buffer_store_dwordx2 v[30:31], v17, s[24:27], s48 offen sc1
    s_mov_b64 exec, -1
    s_mov_b32 s49, 1
    s_branch CB_PUBR37
CB_PUB38:
    s_mov_b64 exec, 0xffff
    buffer_store_dwordx2 v[30:31], v17, s[24:27], s48 offen sc1
    s_mov_b64 exec, -1
    s_mov_b32 s49, 1
    s_branch CB_PUBR38
CB_PUB39:
    s_mov_b64 exec, 0xffff
    buffer_store_dwordx2 v[30:31], v17, s[24:27], s48 offen sc1
    s_mov_b64 exec, -1
    s_mov_b32 s49, 1
    s_branch CB_PUBR39
CB_PUB40:
    s_mov_b64 exec, 0xffff
    buffer_store_dwordx2 v[30:31], v17, s[24:27], s48 offen sc1
    s_mov_b64 exec, -1
    s_mov_b32 s49, 1
    s_branch CB_PUBR40
CB_PUB41:
    s_mov_b64 exec, 0xffff
    buffer_store_dwordx2 v[30:31], v17, s[24:27], s48 offen sc1
    s_mov_b64 exec, -1
    s_mov_b32 s49, 1
    s_branch CB_PUBR41
CB_PUB42:
    s_mov_b64 exec, 0xffff
    buffer_store_dwordx2 v[30:31], v17, s[24:27], s48 offen sc1
    s_mov_b64 exec, -1
    s_mov_b32 s49, 1
    s_branch CB_PUBR42
CB_PUB43:
    s_mov_b64 exec, 0xffff
    buffer_store_dwordx2 v[30:31], v17, s[24:27], s48 offen sc1
    s_mov_b64 exec, -1
    s_mov_b32 s49, 1
    s_branch CB_PUBR43
CB_PUB44:
    s_mov_b64 exec, 0xffff
    buffer_store_dwordx2 v[30:31], v17, s[24:27], s48 offen sc1
    s_mov_b64 exec, -1
    s_mov_b32 s49, 1
    s_branch CB_PUBR44
CB_PUB45:
    s_mov_b64 exec, 0xffff
    buffer_store_dwordx2 v[30:31], v17, s[24:27], s48 offen sc1
    s_mov_b64 exec, -1
    s_mov_b32 s49, 1
    s_branch CB_PUBR45
CB_PUB46:
    s_mov_b64 exec, 0xffff
    buffer_store_dwordx2 v[30:31], v17, s[24:27], s48 offen sc1
    s_mov_b64 exec, -1
    s_mov_b32 s49, 1
    s_branch CB_PUBR46
CB_PUB47:
    s_mov_b64 exec, 0xffff
    buffer_store_dwordx2 v[30:31], v17, s[24:27], s48 offen sc1
    s_mov_b64 exec, -1
    s_mov_b32 s49, 1
    s_branch CB_PUBR47
CB_PUB48:
    s_mov_b64 exec, 0xffff
    buffer_store_dwordx2 v[30:31], v17, s[24:27], s48 offen sc1
    s_mov_b64 exec, -1
    s_mov_b32 s49, 1
    s_branch CB_PUBR48
CB_PUB49:
    s_mov_b64 exec, 0xffff
    buffer_store_dwordx2 v[30:31], v17, s[24:27], s48 offen sc1
    s_mov_b64 exec, -1
    s_mov_b32 s49, 1
    s_branch CB_PUBR49
CB_PUB50:
    s_mov_b64 exec, 0xffff
    buffer_store_dwordx2 v[30:31], v17, s[24:27], s48 offen sc1
    s_mov_b64 exec, -1
    s_mov_b32 s49, 1
    s_branch CB_PUBR50
CB_PUB51:
    s_mov_b64 exec, 0xffff
    buffer_store_dwordx2 v[30:31], v17, s[24:27], s48 offen sc1
    s_mov_b64 exec, -1
    s_mov_b32 s49, 1
    s_branch CB_PUBR51
CB_PUB52:
    s_mov_b64 exec, 0xffff
    buffer_store_dwordx2 v[30:31], v17, s[24:27], s48 offen sc1
    s_mov_b64 exec, -1
    s_mov_b32 s49, 1
    s_branch CB_PUBR52
CB_PUB53:
    s_mov_b64 exec, 0xffff
    buffer_store_dwordx2 v[30:31], v17, s[24:27], s48 offen sc1
    s_mov_b64 exec, -1
    s_mov_b32 s49, 1
    s_branch CB_PUBR53
CB_PUB54:
    s_mov_b64 exec, 0xffff
    buffer_store_dwordx2 v[30:31], v17, s[24:27], s48 offen sc1
    s_mov_b64 exec, -1
    s_mov_b32 s49, 1
    s_branch CB_PUBR54
K_CC:
    s_waitcnt vmcnt(4)
    s_barrier
    ds_read_b128 v[32:35], v4 offset:0
    ds_read_b64_tr_b16 v[40:41], v12 offset:0
    ds_read_b64_tr_b16 v[42:43], v12 offset:1536
    ds_read_b128 v[36:39], v4 offset:4096
    ds_read_b64_tr_b16 v[44:45], v13 offset:0
    ds_read_b64_tr_b16 v[46:47], v13 offset:1536
    ds_read_b64_tr_b16 v[48:49], v14 offset:0
    ds_read_b64_tr_b16 v[50:51], v14 offset:1536
    s_waitcnt lgkmcnt(0)
    v_mfma_f32_32x32x16_bf16 v[96:111], v[40:43], v[32:35], 0
    ds_read_b128 v[52:55], v5 offset:0
    ds_read_b64_tr_b16 v[60:61], v12 offset:6144
    ds_read_b64_tr_b16 v[62:63], v12 offset:7680
    v_mfma_f32_32x32x16_bf16 v[112:127], v[40:43], v[36:39], 0
    ds_read_b128 v[56:59], v5 offset:4096
    ds_read_b64_tr_b16 v[64:65], v13 offset:6144
    ds_read_b64_tr_b16 v[66:67], v13 offset:7680
    v_mfma_f32_32x32x16_bf16 v[128:143], v[44:47], v[32:35], 0
    ds_read_b64_tr_b16 v[68:69], v14 offset:6144
    ds_read_b64_tr_b16 v[70:71], v14 offset:7680
    v_mfma_f32_32x32x16_bf16 v[144:159], v[44:47], v[36:39], 0
    v_mfma_f32_32x32x16_bf16 v[160:175], v[48:51], v[32:35], 0
    v_mfma_f32_32x32x16_bf16 v[176:191], v[48:51], v[36:39], 0
    s_waitcnt lgkmcnt(0)
    v_mfma_f32_32x32x16_bf16 v[96:111], v[60:63], v[52:55], v[96:111]
    s_waitcnt vmcnt(1)
    s_barrier
    ds_read_b128 v[32:35], v6 offset:0
    ds_read_b64_tr_b16 v[40:41], v12 offset:12288
    ds_read_b64_tr_b16 v[42:43], v12 offset:13824
    v_lshlrev_b32 v29, 2, v29
    v_lshl_add_u32 v29, v24, 1, v29
    v_lshrrev_b32 v30, 1, v26
    v_mfma_f32_32x32x16_bf16 v[112:127], v[60:63], v[56:59], v[112:127]
    ds_read_b128 v[36:39], v6 offset:4096
    ds_read_b64_tr_b16 v[44:45], v13 offset:12288
    ds_read_b64_tr_b16 v[46:47], v13 offset:13824
    s_lshl_b32 s37, s36, 2
    v_add_u32 v30, s37, v30
    v_and_b32 v31, 1, v26
    v_mfma_f32_32x32x16_bf16 v[128:143], v[64:67], v[52:55], v[128:143]
    ds_read_b64_tr_b16 v[48:49], v14 offset:12288
    ds_read_b64_tr_b16 v[50:51], v14 offset:13824
    v_lshlrev_b32 v31, 3, v31
    v_lshl_add_u32 v31, v27, 7, v31
    v_lshl_add_u32 v31, v24, 12, v31
    v_mfma_f32_32x32x16_bf16 v[144:159], v[64:67], v[56:59], v[144:159]
    v_add_u32 v31, 114688, v31
    v_add_u32 v28, 0, v30
    v_xor_b32 v28, v28, v29
    v_mfma_f32_32x32x16_bf16 v[160:175], v[68:71], v[52:55], v[160:175]
    v_lshl_add_u32 v15, v28, 4, v31
    v_add_u32 v28, 2, v30
    v_xor_b32 v28, v28, v29
    v_mfma_f32_32x32x16_bf16 v[176:191], v[68:71], v[56:59], v[176:191]
    v_lshl_add_u32 v16, v28, 4, v31
    v_add_u32 v8, 0x10000, v4
    v_add_u32 v9, 0x10000, v5
    s_waitcnt lgkmcnt(0)
    v_mfma_f32_32x32x16_bf16 v[96:111], v[40:43], v[32:35], v[96:111]
    ds_read_b128 v[52:55], v7 offset:0
    ds_read_b64_tr_b16 v[60:61], v12 offset:18432
    ds_read_b64_tr_b16 v[62:63], v12 offset:19968
    v_add_u32 v10, 0x10000, v6
    v_add_u32 v11, 0x10000, v7
    s_mov_b32 s30, 896
    v_mfma_f32_32x32x16_bf16 v[112:127], v[40:43], v[36:39], v[112:127]
    ds_read_b128 v[56:59], v7 offset:4096
    ds_read_b64_tr_b16 v[64:65], v13 offset:18432
    ds_read_b64_tr_b16 v[66:67], v13 offset:19968
    s_mov_b32 s31, 0x00020000
    s_mov_b32 s26, 17498112
    s_mov_b32 s27, 0x00020000
    v_mfma_f32_32x32x16_bf16 v[128:143], v[44:47], v[32:35], v[128:143]
    ds_read_b64_tr_b16 v[68:69], v14 offset:18432
    ds_read_b64_tr_b16 v[70:71], v14 offset:19968
    s_mov_b32 s58, 1605632
    s_mov_b32 s59, 0x00020000
    s_mov_b32 s62, 401408
    v_mfma_f32_32x32x16_bf16 v[144:159], v[44:47], v[36:39], v[144:159]
    s_mov_b32 s63, 0x00020000
    s_mov_b32 s66, 1835008
    s_mov_b32 s67, 0x00020000
    v_mfma_f32_32x32x16_bf16 v[160:175], v[48:51], v[32:35], v[160:175]
    s_mov_b32 s70, 256
    s_mov_b32 s71, 0x00020000
    s_and_b32 s4, s2, 7
    v_mfma_f32_32x32x16_bf16 v[176:191], v[48:51], v[36:39], v[176:191]
    s_lshl_b32 s4, s4, 1
    s_lshr_b32 s5, s2, 7
    s_add_u32 s37, s4, s5
    s_waitcnt lgkmcnt(0)
    v_mfma_f32_32x32x16_bf16 v[96:111], v[60:63], v[52:55], v[96:111]
    s_barrier
    ds_read_b128 v[32:35], v4 offset:16384
    ds_read_b64_tr_b16 v[40:41], v12 offset:24576
    ds_read_b64_tr_b16 v[42:43], v12 offset:26112
    s_bfe_u32 s38, s2, 0x40003
    s_lshl_b32 s6, s37, 18
    v_mfma_f32_32x32x16_bf16 v[112:127], v[60:63], v[56:59], v[112:127]
    ds_read_b128 v[36:39], v4 offset:20480
    ds_read_b64_tr_b16 v[44:45], v13 offset:24576
    ds_read_b64_tr_b16 v[46:47], v13 offset:26112
    s_add_u32 s6, s6, 2097152
    s_lshl_b32 s5, s3, 16
    v_mfma_f32_32x32x16_bf16 v[128:143], v[64:67], v[52:55], v[128:143]
    ds_read_b64_tr_b16 v[48:49], v14 offset:24576
    ds_read_b64_tr_b16 v[50:51], v14 offset:26112
    s_add_u32 s39, s6, s5
    s_mov_b32 s99, s39
    v_mfma_f32_32x32x16_bf16 v[144:159], v[64:67], v[56:59], v[144:159]
    v_mov_b32 v28, 0
    v_mov_b32 v27, 1
    v_mfma_f32_32x32x16_bf16 v[160:175], v[68:71], v[52:55], v[160:175]
    v_lshlrev_b32 v24, 2, v1
    s_lshl_b32 s4, s3, 12
    v_mfma_f32_32x32x16_bf16 v[176:191], v[68:71], v[56:59], v[176:191]
    v_add_u32 v3, s4, v2
    s_lshl_b32 s4, s3, 8
    s_waitcnt lgkmcnt(0)
    v_mfma_f32_32x32x16_bf16 v[96:111], v[40:43], v[32:35], v[96:111]
    ds_read_b128 v[52:55], v5 offset:16384
    ds_read_b64_tr_b16 v[60:61], v12 offset:30720
    ds_read_b64_tr_b16 v[62:63], v12 offset:32256
    v_add_u32 v25, s4, v24
    s_add_u32 s4, s38, 0
    v_mfma_f32_32x32x16_bf16 v[112:127], v[40:43], v[36:39], v[112:127]
    ds_read_b128 v[56:59], v5 offset:20480
    ds_read_b64_tr_b16 v[64:65], v13 offset:30720
    ds_read_b64_tr_b16 v[66:67], v13 offset:32256
    s_and_b32 s4, s4, 15
    s_lshl_b32 s4, s4, 12
    v_mfma_f32_32x32x16_bf16 v[128:143], v[44:47], v[32:35], v[128:143]
    ds_read_b64_tr_b16 v[68:69], v14 offset:30720
    ds_read_b64_tr_b16 v[70:71], v14 offset:32256
    s_add_u32 s8, s4, s39
    s_add_u32 s4, s38, 1
    v_mfma_f32_32x32x16_bf16 v[144:159], v[44:47], v[36:39], v[144:159]
    s_and_b32 s4, s4, 15
    s_lshl_b32 s4, s4, 12
    v_mfma_f32_32x32x16_bf16 v[160:175], v[48:51], v[32:35], v[160:175]
    s_add_u32 s9, s4, s39
    s_add_u32 s4, s38, 2
    v_mfma_f32_32x32x16_bf16 v[176:191], v[48:51], v[36:39], v[176:191]
    s_and_b32 s4, s4, 15
    s_lshl_b32 s4, s4, 12
    s_waitcnt lgkmcnt(0)
    v_mfma_f32_32x32x16_bf16 v[96:111], v[60:63], v[52:55], v[96:111]
    s_barrier
    ds_read_b128 v[32:35], v6 offset:16384
    ds_read_b64_tr_b16 v[40:41], v12 offset:36864
    ds_read_b64_tr_b16 v[42:43], v12 offset:38400
    s_add_u32 s10, s4, s39
    s_add_u32 s4, s38, 3
    v_mfma_f32_32x32x16_bf16 v[112:127], v[60:63], v[56:59], v[112:127]
    ds_read_b128 v[36:39], v6 offset:20480
    ds_read_b64_tr_b16 v[44:45], v13 offset:36864
    ds_read_b64_tr_b16 v[46:47], v13 offset:38400
    s_and_b32 s4, s4, 15
    s_lshl_b32 s4, s4, 12
    v_mfma_f32_32x32x16_bf16 v[128:143], v[64:67], v[52:55], v[128:143]
    ds_read_b64_tr_b16 v[48:49], v14 offset:36864
    ds_read_b64_tr_b16 v[50:51], v14 offset:38400
    s_add_u32 s11, s4, s39
    s_add_u32 s4, s38, 4
    v_mfma_f32_32x32x16_bf16 v[144:159], v[64:67], v[56:59], v[144:159]
    s_and_b32 s4, s4, 15
    s_lshl_b32 s4, s4, 12
    v_mfma_f32_32x32x16_bf16 v[160:175], v[68:71], v[52:55], v[160:175]
    s_add_u32 s12, s4, s39
    s_add_u32 s4, s38, 5
    v_mfma_f32_32x32x16_bf16 v[176:191], v[68:71], v[56:59], v[176:191]
    s_and_b32 s4, s4, 15
    s_lshl_b32 s4, s4, 12
    s_waitcnt lgkmcnt(0)
    v_mfma_f32_32x32x16_bf16 v[96:111], v[40:43], v[32:35], v[96:111]
    ds_read_b128 v[52:55], v7 offset:16384
    ds_read_b64_tr_b16 v[60:61], v12 offset:43008
    ds_read_b64_tr_b16 v[62:63], v12 offset:44544
    s_add_u32 s13, s4, s39
    s_add_u32 s4, s38, 6
    v_mfma_f32_32x32x16_bf16 v[112:127], v[40:43], v[36:39], v[112:127]
    ds_read_b128 v[56:59], v7 offset:20480
    ds_read_b64_tr_b16 v[64:65], v13 offset:43008
    ds_read_b64_tr_b16 v[66:67], v13 offset:44544
    s_and_b32 s4, s4, 15
    s_lshl_b32 s4, s4, 12
    v_mfma_f32_32x32x16_bf16 v[128:143], v[44:47], v[32:35], v[128:143]
    ds_read_b64_tr_b16 v[68:69], v14 offset:43008
    ds_read_b64_tr_b16 v[70:71], v14 offset:44544
    s_add_u32 s14, s4, s39
    s_add_u32 s4, s38, 7
    v_mfma_f32_32x32x16_bf16 v[144:159], v[44:47], v[36:39], v[144:159]
    s_and_b32 s4, s4, 15
    s_lshl_b32 s4, s4, 12
    v_mfma_f32_32x32x16_bf16 v[160:175], v[48:51], v[32:35], v[160:175]
    s_add_u32 s15, s4, s39
    s_add_u32 s4, s38, 8
    v_mfma_f32_32x32x16_bf16 v[176:191], v[48:51], v[36:39], v[176:191]
    s_and_b32 s4, s4, 15
    s_lshl_b32 s4, s4, 12
    s_waitcnt lgkmcnt(0)
    v_mfma_f32_32x32x16_bf16 v[96:111], v[60:63], v[52:55], v[96:111]
    s_barrier
    ds_read_b128 v[32:35], v4 offset:32768
    ds_read_b64_tr_b16 v[40:41], v12 offset:0
    ds_read_b64_tr_b16 v[42:43], v12 offset:1536
    s_add_u32 s28, s4, s39
    s_add_u32 s4, s38, 9
    v_mfma_f32_32x32x16_bf16 v[112:127], v[60:63], v[56:59], v[112:127]
    ds_read_b128 v[36:39], v4 offset:36864
    ds_read_b64_tr_b16 v[44:45], v13 offset:0
    ds_read_b64_tr_b16 v[46:47], v13 offset:1536
    s_and_b32 s4, s4, 15
    s_lshl_b32 s4, s4, 12
    v_mfma_f32_32x32x16_bf16 v[128:143], v[64:67], v[52:55], v[128:143]
    ds_read_b64_tr_b16 v[48:49], v14 offset:0
    ds_read_b64_tr_b16 v[50:51], v14 offset:1536
    s_add_u32 s29, s4, s39
    s_add_u32 s4, s38, 10
    v_mfma_f32_32x32x16_bf16 v[144:159], v[64:67], v[56:59], v[144:159]
    s_and_b32 s4, s4, 15
    s_lshl_b32 s4, s4, 12
    v_mfma_f32_32x32x16_bf16 v[160:175], v[68:71], v[52:55], v[160:175]
    s_add_u32 s30, s4, s39
    s_add_u32 s4, s38, 11
    v_mfma_f32_32x32x16_bf16 v[176:191], v[68:71], v[56:59], v[176:191]
    s_and_b32 s4, s4, 15
    s_lshl_b32 s4, s4, 12
    s_waitcnt lgkmcnt(0)
    v_mfma_f32_32x32x16_bf16 v[96:111], v[40:43], v[32:35], v[96:111]
    ds_read_b128 v[52:55], v5 offset:32768
    ds_read_b64_tr_b16 v[60:61], v12 offset:6144
    ds_read_b64_tr_b16 v[62:63], v12 offset:7680
    s_add_u32 s31, s4, s39
    s_add_u32 s4, s38, 12
    v_mfma_f32_32x32x16_bf16 v[112:127], v[40:43], v[36:39], v[112:127]
    ds_read_b128 v[56:59], v5 offset:36864
    ds_read_b64_tr_b16 v[64:65], v13 offset:6144
    ds_read_b64_tr_b16 v[66:67], v13 offset:7680
    s_and_b32 s4, s4, 15
    s_lshl_b32 s4, s4, 12
    v_mfma_f32_32x32x16_bf16 v[128:143], v[44:47], v[32:35], v[128:143]
    ds_read_b64_tr_b16 v[68:69], v14 offset:6144
    ds_read_b64_tr_b16 v[70:71], v14 offset:7680
    s_add_u32 s64, s4, s39
    s_add_u32 s4, s38, 13
    v_mfma_f32_32x32x16_bf16 v[144:159], v[44:47], v[36:39], v[144:159]
    s_and_b32 s4, s4, 15
    s_lshl_b32 s4, s4, 12
    v_mfma_f32_32x32x16_bf16 v[160:175], v[48:51], v[32:35], v[160:175]
    s_add_u32 s65, s4, s39
    s_add_u32 s4, s38, 14
    v_mfma_f32_32x32x16_bf16 v[176:191], v[48:51], v[36:39], v[176:191]
    s_and_b32 s4, s4, 15
    s_lshl_b32 s4, s4, 12
    s_waitcnt lgkmcnt(0)
    v_mfma_f32_32x32x16_bf16 v[96:111], v[60:63], v[52:55], v[96:111]
    s_barrier
    ds_read_b128 v[32:35], v6 offset:32768
    ds_read_b64_tr_b16 v[40:41], v12 offset:12288
    ds_read_b64_tr_b16 v[42:43], v12 offset:13824
    s_add_u32 s66, s4, s39
    s_add_u32 s4, s38, 15
    v_mfma_f32_32x32x16_bf16 v[112:127], v[60:63], v[56:59], v[112:127]
    ds_read_b128 v[36:39], v6 offset:36864
    ds_read_b64_tr_b16 v[44:45], v13 offset:12288
    ds_read_b64_tr_b16 v[46:47], v13 offset:13824
    s_and_b32 s4, s4, 15
    s_lshl_b32 s4, s4, 12
    v_mfma_f32_32x32x16_bf16 v[128:143], v[64:67], v[52:55], v[128:143]
    v_mov_b32 v31, 0
    buffer_load_dword v30, v31, s[68:71], 0 offen sc1
    ds_read_b64_tr_b16 v[48:49], v14 offset:12288
    ds_read_b64_tr_b16 v[50:51], v14 offset:13824
    s_add_u32 s67, s4, s39
    s_add_u32 s4, s3, 1
    v_mfma_f32_32x32x16_bf16 v[144:159], v[64:67], v[56:59], v[144:159]
    s_and_b32 s4, s4, 3
    s_lshl_b32 s4, s4, 11
    v_mfma_f32_32x32x16_bf16 v[160:175], v[68:71], v[52:55], v[160:175]
    v_add_u32 v20, s4, v2
    s_add_u32 s4, s3, 2
    v_mfma_f32_32x32x16_bf16 v[176:191], v[68:71], v[56:59], v[176:191]
    s_and_b32 s4, s4, 3
    s_lshl_b32 s4, s4, 11
    s_waitcnt lgkmcnt(0)
    v_mfma_f32_32x32x16_bf16 v[96:111], v[40:43], v[32:35], v[96:111]
    ds_read_b128 v[52:55], v7 offset:32768
    ds_read_b64_tr_b16 v[60:61], v12 offset:18432
    ds_read_b64_tr_b16 v[62:63], v12 offset:19968
    v_add_u32 v21, s4, v2
    s_add_u32 s4, s3, 3
    v_mfma_f32_32x32x16_bf16 v[112:127], v[40:43], v[36:39], v[112:127]
    ds_read_b128 v[56:59], v7 offset:36864
    ds_read_b64_tr_b16 v[64:65], v13 offset:18432
    ds_read_b64_tr_b16 v[66:67], v13 offset:19968
    s_and_b32 s4, s4, 3
    s_lshl_b32 s4, s4, 11
    v_mfma_f32_32x32x16_bf16 v[128:143], v[44:47], v[32:35], v[128:143]
    s_lshl_b32 s44, s2, 2
    s_add_u32 s44, s44, s3
    s_mul_i32 s45, s44, 1600
    v_min_u32 v29, 24, v1
    v_lshlrev_b32 v29, 6, v29
    buffer_load_dword v95, v29, s[56:59], s45 offen
    s_mul_i32 s45, s44, 448
    v_min_u32 v29, 384, v29
    buffer_load_dword v95, v29, s[60:63], s45 offen
    ds_read_b64_tr_b16 v[68:69], v14 offset:18432
    ds_read_b64_tr_b16 v[70:71], v14 offset:19968
    v_add_u32 v22, s4, v2
    s_add_u32 s4, s3, 4
    v_mfma_f32_32x32x16_bf16 v[144:159], v[44:47], v[36:39], v[144:159]
    s_and_b32 s4, s4, 3
    s_lshl_b32 s4, s4, 11
    v_mfma_f32_32x32x16_bf16 v[160:175], v[48:51], v[32:35], v[160:175]
    v_add_u32 v23, s4, v2
    s_lshl_b32 s5, s38, 2
    v_mfma_f32_32x32x16_bf16 v[176:191], v[48:51], v[36:39], v[176:191]
    s_add_u32 s5, s5, s3
    s_lshl_b32 s5, s5, 4
    s_waitcnt lgkmcnt(0)
    v_mfma_f32_32x32x16_bf16 v[96:111], v[60:63], v[52:55], v[96:111]
    s_barrier
    ds_read_b128 v[32:35], v4 offset:49152
    ds_read_b64_tr_b16 v[40:41], v12 offset:24576
    ds_read_b64_tr_b16 v[42:43], v12 offset:26112
    s_add_u32 s5, s5, s37
    s_lshl_b32 s96, s5, 11
    v_mfma_f32_32x32x16_bf16 v[112:127], v[60:63], v[56:59], v[112:127]
    ds_read_b128 v[36:39], v4 offset:53248
    ds_read_b64_tr_b16 v[44:45], v13 offset:24576
    ds_read_b64_tr_b16 v[46:47], v13 offset:26112
    s_add_u32 s96, s96, 14680064
    s_mov_b32 s100, s96
    v_mfma_f32_32x32x16_bf16 v[128:143], v[64:67], v[52:55], v[128:143]
    ds_read_b64_tr_b16 v[48:49], v14 offset:24576
    ds_read_b64_tr_b16 v[50:51], v14 offset:26112
    s_lshl_b32 s97, s5, 7
    s_add_u32 s97, s97, 17367040
    v_mfma_f32_32x32x16_bf16 v[144:159], v[64:67], v[56:59], v[144:159]
    s_lshl_b32 s4, s32, 6
    s_lshl_b32 s5, s33, 2
    v_mfma_f32_32x32x16_bf16 v[160:175], v[68:71], v[52:55], v[160:175]
    s_add_u32 s4, s4, s5
    s_add_u32 s4, s4, s3
    v_mfma_f32_32x32x16_bf16 v[176:191], v[68:71], v[56:59], v[176:191]
    s_lshl_b32 s4, s4, 7
    s_add_u32 s98, s4, 17235968
    s_waitcnt lgkmcnt(0)
    v_mfma_f32_32x32x16_bf16 v[96:111], v[40:43], v[32:35], v[96:111]
    ds_read_b128 v[52:55], v5 offset:49152
    ds_read_b64_tr_b16 v[60:61], v12 offset:30720
    ds_read_b64_tr_b16 v[62:63], v12 offset:32256
    s_lshl_b32 s37, s32, 2
    s_lshl_b32 s38, s35, 1
    v_mfma_f32_32x32x16_bf16 v[112:127], v[40:43], v[36:39], v[112:127]
    ds_read_b128 v[56:59], v5 offset:53248
    ds_read_b64_tr_b16 v[64:65], v13 offset:30720
    ds_read_b64_tr_b16 v[66:67], v13 offset:32256
    s_add_u32 s37, s37, s38
    s_mul_i32 s39, s36, 3
    v_mfma_f32_32x32x16_bf16 v[128:143], v[44:47], v[32:35], v[128:143]
    ds_read_b64_tr_b16 v[68:69], v14 offset:30720
    ds_read_b64_tr_b16 v[70:71], v14 offset:32256
    s_add_u32 s39, s39, s34
    v_lshrrev_b32 v17, 4, v1
    v_mfma_f32_32x32x16_bf16 v[144:159], v[44:47], v[36:39], v[144:159]
    v_add_u32 v17, s39, v17
    v_and_b32 v18, 15, v17
    v_mfma_f32_32x32x16_bf16 v[160:175], v[48:51], v[32:35], v[160:175]
    v_lshrrev_b32 v17, 4, v17
    v_mul_u32_u24 v18, 3, v18
    v_mfma_f32_32x32x16_bf16 v[176:191], v[48:51], v[36:39], v[176:191]
    v_add_u32 v17, v17, v18
    v_lshlrev_b32 v17, 12, v17
    s_waitcnt lgkmcnt(0)
    v_mfma_f32_32x32x16_bf16 v[96:111], v[60:63], v[52:55], v[96:111]
    s_barrier
    ds_read_b128 v[32:35], v6 offset:49152
    ds_read_b64_tr_b16 v[40:41], v12 offset:36864
    ds_read_b64_tr_b16 v[42:43], v12 offset:38400
    v_and_b32 v18, 15, v1
    v_lshl_add_u32 v17, v18, 3, v17
    v_mfma_f32_32x32x16_bf16 v[112:127], v[60:63], v[56:59], v[112:127]
    ds_read_b128 v[36:39], v6 offset:53248
    ds_read_b64_tr_b16 v[44:45], v13 offset:36864
    ds_read_b64_tr_b16 v[46:47], v13 offset:38400
    s_lshl_b32 s48, s37, 6
    s_add_u32 s48, s48, 17039360
    v_mfma_f32_32x32x16_bf16 v[128:143], v[64:67], v[52:55], v[128:143]
    ds_read_b64_tr_b16 v[48:49], v14 offset:36864
    ds_read_b64_tr_b16 v[50:51], v14 offset:38400
    s_and_b32 s39, s39, 15
    s_lshl_b32 s39, s39, 6
    v_mfma_f32_32x32x16_bf16 v[144:159], v[64:67], v[56:59], v[144:159]
    s_add_u32 s39, s39, s37
    s_mov_b32 s50, 0
    v_mfma_f32_32x32x16_bf16 v[160:175], v[68:71], v[52:55], v[160:175]
    s_mov_b32 s51, -1
    s_cmp_lt_u32 s34, 16
    s_cselect_b32 s92, 0x3e8b97f6, 1.0
    s_mov_b32 s93, s92
    s_cselect_b32 s40, 0, 0x3f803f80
    s_cselect_b32 s41, 0, 0x3f80
    s_cselect_b32 s42, 11, 12
    s_cselect_b32 s43, 0, 2097152
    v_mfma_f32_32x32x16_bf16 v[176:191], v[68:71], v[56:59], v[176:191]
    v_mov_b32 v18, s40
    v_mov_b32 v19, s41
    s_waitcnt lgkmcnt(0)
    v_mfma_f32_32x32x16_bf16 v[96:111], v[40:43], v[32:35], v[96:111]
    ds_read_b128 v[52:55], v7 offset:49152
    ds_read_b64_tr_b16 v[60:61], v12 offset:43008
    ds_read_b64_tr_b16 v[62:63], v12 offset:44544
    s_mul_i32 s40, s37, 112
    s_lshl_b32 s41, s36, 1
    v_mfma_f32_32x32x16_bf16 v[112:127], v[40:43], v[36:39], v[112:127]
    ds_read_b128 v[56:59], v7 offset:53248
    ds_read_b64_tr_b16 v[64:65], v13 offset:43008
    ds_read_b64_tr_b16 v[66:67], v13 offset:44544
    s_add_u32 s40, s40, s41
    s_lshl_b32 s41, s73, 2
    v_mfma_f32_32x32x16_bf16 v[128:143], v[44:47], v[32:35], v[128:143]
    ds_read_b64_tr_b16 v[68:69], v14 offset:43008
    ds_read_b64_tr_b16 v[70:71], v14 offset:44544
    s_add_u32 s54, s40, s41
    s_lshl_b32 s54, s54, 10
    v_mfma_f32_32x32x16_bf16 v[144:159], v[44:47], v[36:39], v[144:159]
    s_add_u32 s54, s54, 6291456
    s_add_u32 s55, s54, 114688
    v_mfma_f32_32x32x16_bf16 v[160:175], v[48:51], v[32:35], v[160:175]
    s_lshl_b32 s41, s72, 2
    s_add_u32 s40, s40, s41
    v_mfma_f32_32x32x16_bf16 v[176:191], v[48:51], v[36:39], v[176:191]
    s_lshl_b32 s40, s40, 10
    s_add_u32 s40, s40, 6291456
    s_waitcnt lgkmcnt(0)
    v_mfma_f32_32x32x16_bf16 v[96:111], v[60:63], v[52:55], v[96:111]
    s_barrier
    ds_read_b128 v[32:35], v8 offset:0
    ds_read_b64_tr_b16 v[40:41], v12 offset:0
    ds_read_b64_tr_b16 v[42:43], v12 offset:1536
    s_add_u32 s41, s40, 114688
    v_mfma_f32_32x32x16_bf16 v[112:127], v[60:63], v[56:59], v[112:127]
    ds_read_b128 v[36:39], v8 offset:4096
    ds_read_b64_tr_b16 v[44:45], v13 offset:0
    ds_read_b64_tr_b16 v[46:47], v13 offset:1536
    v_mfma_f32_32x32x16_bf16 v[128:143], v[64:67], v[52:55], v[128:143]
    ds_read_b64_tr_b16 v[48:49], v14 offset:0
    ds_read_b64_tr_b16 v[50:51], v14 offset:1536
    v_mfma_f32_32x32x16_bf16 v[144:159], v[64:67], v[56:59], v[144:159]
    v_mfma_f32_32x32x16_bf16 v[160:175], v[68:71], v[52:55], v[160:175]
    v_mfma_f32_32x32x16_bf16 v[176:191], v[68:71], v[56:59], v[176:191]
    s_waitcnt lgkmcnt(0)
    v_mfma_f32_32x32x16_bf16 v[96:111], v[40:43], v[32:35], v[96:111]
    ds_read_b128 v[52:55], v9 offset:0
    ds_read_b64_tr_b16 v[60:61], v12 offset:6144
    ds_read_b64_tr_b16 v[62:63], v12 offset:7680
    v_mfma_f32_32x32x16_bf16 v[112:127], v[40:43], v[36:39], v[112:127]
    ds_read_b128 v[56:59], v9 offset:4096
    ds_read_b64_tr_b16 v[64:65], v13 offset:6144
    ds_read_b64_tr_b16 v[66:67], v13 offset:7680
    v_mfma_f32_32x32x16_bf16 v[128:143], v[44:47], v[32:35], v[128:143]
    ds_read_b64_tr_b16 v[68:69], v14 offset:6144
    ds_read_b64_tr_b16 v[70:71], v14 offset:7680
    v_mfma_f32_32x32x16_bf16 v[144:159], v[44:47], v[36:39], v[144:159]
    v_mfma_f32_32x32x16_bf16 v[160:175], v[48:51], v[32:35], v[160:175]
    v_mfma_f32_32x32x16_bf16 v[176:191], v[48:51], v[36:39], v[176:191]
    s_waitcnt lgkmcnt(0)
    v_mfma_f32_32x32x16_bf16 v[96:111], v[60:63], v[52:55], v[96:111]
    s_barrier
    ds_read_b128 v[32:35], v10 offset:0
    ds_read_b64_tr_b16 v[40:41], v12 offset:12288
    ds_read_b64_tr_b16 v[42:43], v12 offset:13824
    v_mfma_f32_32x32x16_bf16 v[112:127], v[60:63], v[56:59], v[112:127]
    ds_read_b128 v[36:39], v10 offset:4096
    ds_read_b64_tr_b16 v[44:45], v13 offset:12288
    ds_read_b64_tr_b16 v[46:47], v13 offset:13824
    v_mfma_f32_32x32x16_bf16 v[128:143], v[64:67], v[52:55], v[128:143]
    ds_read_b64_tr_b16 v[48:49], v14 offset:12288
    ds_read_b64_tr_b16 v[50:51], v14 offset:13824
    v_mfma_f32_32x32x16_bf16 v[144:159], v[64:67], v[56:59], v[144:159]
    v_mfma_f32_32x32x16_bf16 v[160:175], v[68:71], v[52:55], v[160:175]
    v_mfma_f32_32x32x16_bf16 v[176:191], v[68:71], v[56:59], v[176:191]
    s_waitcnt lgkmcnt(0)
    v_mfma_f32_32x32x16_bf16 v[96:111], v[40:43], v[32:35], v[96:111]
    ds_read_b128 v[52:55], v11 offset:0
    ds_read_b64_tr_b16 v[60:61], v12 offset:18432
    ds_read_b64_tr_b16 v[62:63], v12 offset:19968
    v_mfma_f32_32x32x16_bf16 v[112:127], v[40:43], v[36:39], v[112:127]
    ds_read_b128 v[56:59], v11 offset:4096
    ds_read_b64_tr_b16 v[64:65], v13 offset:18432
    ds_read_b64_tr_b16 v[66:67], v13 offset:19968
    v_mfma_f32_32x32x16_bf16 v[128:143], v[44:47], v[32:35], v[128:143]
    s_bfe_u32 s44, s2, 0x30003
    s_lshl_b32 s44, s44, 1
    s_add_u32 s44, s44, s35
    s_mul_i32 s44, s44, 100352
    s_lshl_b32 s45, s73, 7
    s_add_u32 s44, s44, s45
    v_lshrrev_b32 v29, 1, v1
    v_min_u32 v29, 27, v29
    v_mul_u32_u24 v29, 3584, v29
    v_and_b32 v26, 1, v1
    v_lshl_add_u32 v29, v26, 6, v29
    s_cmp_eq_u32 s36, 0
    s_cbranch_scc1 CC_TG
    buffer_load_dword v29, v29, s[20:23], s44 offen
    s_branch CC_TD
CC_TG:
    buffer_load_dword v29, v29, s[16:19], s44 offen
CC_TD:
    ds_read_b64_tr_b16 v[68:69], v14 offset:18432
    ds_read_b64_tr_b16 v[70:71], v14 offset:19968
    v_mfma_f32_32x32x16_bf16 v[144:159], v[44:47], v[36:39], v[144:159]
    v_mfma_f32_32x32x16_bf16 v[160:175], v[48:51], v[32:35], v[160:175]
    v_mfma_f32_32x32x16_bf16 v[176:191], v[48:51], v[36:39], v[176:191]
    s_waitcnt lgkmcnt(0)
    v_mfma_f32_32x32x16_bf16 v[96:111], v[60:63], v[52:55], v[96:111]
    s_barrier
    ds_read_b128 v[32:35], v8 offset:16384
    ds_read_b64_tr_b16 v[40:41], v12 offset:24576
    ds_read_b64_tr_b16 v[42:43], v12 offset:26112
    v_mfma_f32_32x32x16_bf16 v[112:127], v[60:63], v[56:59], v[112:127]
    ds_read_b128 v[36:39], v8 offset:20480
    ds_read_b64_tr_b16 v[44:45], v13 offset:24576
    ds_read_b64_tr_b16 v[46:47], v13 offset:26112
    v_mfma_f32_32x32x16_bf16 v[128:143], v[64:67], v[52:55], v[128:143]
    ds_read_b64_tr_b16 v[48:49], v14 offset:24576
    ds_read_b64_tr_b16 v[50:51], v14 offset:26112
    v_mfma_f32_32x32x16_bf16 v[144:159], v[64:67], v[56:59], v[144:159]
    v_mfma_f32_32x32x16_bf16 v[160:175], v[68:71], v[52:55], v[160:175]
    v_mfma_f32_32x32x16_bf16 v[176:191], v[68:71], v[56:59], v[176:191]
    s_waitcnt lgkmcnt(0)
    v_mfma_f32_32x32x16_bf16 v[96:111], v[40:43], v[32:35], v[96:111]
    ds_read_b128 v[52:55], v9 offset:16384
    ds_read_b64_tr_b16 v[60:61], v12 offset:30720
    ds_read_b64_tr_b16 v[62:63], v12 offset:32256
    v_mfma_f32_32x32x16_bf16 v[112:127], v[40:43], v[36:39], v[112:127]
    ds_read_b128 v[56:59], v9 offset:20480
    ds_read_b64_tr_b16 v[64:65], v13 offset:30720
    ds_read_b64_tr_b16 v[66:67], v13 offset:32256
    v_mfma_f32_32x32x16_bf16 v[128:143], v[44:47], v[32:35], v[128:143]
    ds_read_b64_tr_b16 v[68:69], v14 offset:30720
    ds_read_b64_tr_b16 v[70:71], v14 offset:32256
    v_mfma_f32_32x32x16_bf16 v[144:159], v[44:47], v[36:39], v[144:159]
    v_mfma_f32_32x32x16_bf16 v[160:175], v[48:51], v[32:35], v[160:175]
    v_mfma_f32_32x32x16_bf16 v[176:191], v[48:51], v[36:39], v[176:191]
    s_waitcnt lgkmcnt(0)
    v_mfma_f32_32x32x16_bf16 v[96:111], v[60:63], v[52:55], v[96:111]
    s_barrier
    ds_read_b128 v[32:35], v10 offset:16384
    ds_read_b64_tr_b16 v[40:41], v12 offset:36864
    ds_read_b64_tr_b16 v[42:43], v12 offset:38400
    v_mfma_f32_32x32x16_bf16 v[112:127], v[60:63], v[56:59], v[112:127]
    ds_read_b128 v[36:39], v10 offset:20480
    ds_read_b64_tr_b16 v[44:45], v13 offset:36864
    ds_read_b64_tr_b16 v[46:47], v13 offset:38400
    v_mfma_f32_32x32x16_bf16 v[128:143], v[64:67], v[52:55], v[128:143]
    ds_read_b64_tr_b16 v[48:49], v14 offset:36864
    ds_read_b64_tr_b16 v[50:51], v14 offset:38400
    v_mfma_f32_32x32x16_bf16 v[144:159], v[64:67], v[56:59], v[144:159]
    v_mfma_f32_32x32x16_bf16 v[160:175], v[68:71], v[52:55], v[160:175]
    v_mfma_f32_32x32x16_bf16 v[176:191], v[68:71], v[56:59], v[176:191]
    s_waitcnt lgkmcnt(0)
    v_mfma_f32_32x32x16_bf16 v[96:111], v[40:43], v[32:35], v[96:111]
    ds_read_b128 v[52:55], v11 offset:16384
    ds_read_b64_tr_b16 v[60:61], v12 offset:43008
    ds_read_b64_tr_b16 v[62:63], v12 offset:44544
    v_mfma_f32_32x32x16_bf16 v[112:127], v[40:43], v[36:39], v[112:127]
    ds_read_b128 v[56:59], v11 offset:20480
    ds_read_b64_tr_b16 v[64:65], v13 offset:43008
    ds_read_b64_tr_b16 v[66:67], v13 offset:44544
    v_mfma_f32_32x32x16_bf16 v[128:143], v[44:47], v[32:35], v[128:143]
    ds_read_b64_tr_b16 v[68:69], v14 offset:43008
    ds_read_b64_tr_b16 v[70:71], v14 offset:44544
    v_mfma_f32_32x32x16_bf16 v[144:159], v[44:47], v[36:39], v[144:159]
    v_mfma_f32_32x32x16_bf16 v[160:175], v[48:51], v[32:35], v[160:175]
    v_mfma_f32_32x32x16_bf16 v[176:191], v[48:51], v[36:39], v[176:191]
    s_waitcnt lgkmcnt(0)
    v_mfma_f32_32x32x16_bf16 v[96:111], v[60:63], v[52:55], v[96:111]
    s_barrier
    ds_read_b128 v[32:35], v8 offset:32768
    ds_read_b64_tr_b16 v[40:41], v12 offset:0
    ds_read_b64_tr_b16 v[42:43], v12 offset:1536
    v_mfma_f32_32x32x16_bf16 v[112:127], v[60:63], v[56:59], v[112:127]
    ds_read_b128 v[36:39], v8 offset:36864
    ds_read_b64_tr_b16 v[44:45], v13 offset:0
    ds_read_b64_tr_b16 v[46:47], v13 offset:1536
    v_mfma_f32_32x32x16_bf16 v[128:143], v[64:67], v[52:55], v[128:143]
    ds_read_b64_tr_b16 v[48:49], v14 offset:0
    ds_read_b64_tr_b16 v[50:51], v14 offset:1536
    v_mfma_f32_32x32x16_bf16 v[144:159], v[64:67], v[56:59], v[144:159]
    v_mfma_f32_32x32x16_bf16 v[160:175], v[68:71], v[52:55], v[160:175]
    v_mfma_f32_32x32x16_bf16 v[176:191], v[68:71], v[56:59], v[176:191]
    s_waitcnt lgkmcnt(0)
    v_mfma_f32_32x32x16_bf16 v[96:111], v[40:43], v[32:35], v[96:111]
    ds_read_b128 v[52:55], v9 offset:32768
    ds_read_b64_tr_b16 v[60:61], v12 offset:6144
    ds_read_b64_tr_b16 v[62:63], v12 offset:7680
    v_mfma_f32_32x32x16_bf16 v[112:127], v[40:43], v[36:39], v[112:127]
    ds_read_b128 v[56:59], v9 offset:36864
    ds_read_b64_tr_b16 v[64:65], v13 offset:6144
    ds_read_b64_tr_b16 v[66:67], v13 offset:7680
    v_mfma_f32_32x32x16_bf16 v[128:143], v[44:47], v[32:35], v[128:143]
    ds_read_b64_tr_b16 v[68:69], v14 offset:6144
    ds_read_b64_tr_b16 v[70:71], v14 offset:7680
    v_mfma_f32_32x32x16_bf16 v[144:159], v[44:47], v[36:39], v[144:159]
    v_mfma_f32_32x32x16_bf16 v[160:175], v[48:51], v[32:35], v[160:175]
    v_mfma_f32_32x32x16_bf16 v[176:191], v[48:51], v[36:39], v[176:191]
    s_waitcnt lgkmcnt(0)
    v_mfma_f32_32x32x16_bf16 v[96:111], v[60:63], v[52:55], v[96:111]
    s_barrier
    ds_read_b128 v[32:35], v10 offset:32768
    ds_read_b64_tr_b16 v[40:41], v12 offset:12288
    ds_read_b64_tr_b16 v[42:43], v12 offset:13824
    v_mfma_f32_32x32x16_bf16 v[112:127], v[60:63], v[56:59], v[112:127]
    ds_read_b128 v[36:39], v10 offset:36864
    ds_read_b64_tr_b16 v[44:45], v13 offset:12288
    ds_read_b64_tr_b16 v[46:47], v13 offset:13824
    v_mfma_f32_32x32x16_bf16 v[128:143], v[64:67], v[52:55], v[128:143]
    ds_read_b64_tr_b16 v[48:49], v14 offset:12288
    ds_read_b64_tr_b16 v[50:51], v14 offset:13824
    v_mfma_f32_32x32x16_bf16 v[144:159], v[64:67], v[56:59], v[144:159]
    v_mfma_f32_32x32x16_bf16 v[160:175], v[68:71], v[52:55], v[160:175]
    s_waitcnt vmcnt(0)
    s_mov_b32 s47, 1048576
CC_NONCE:
    v_readfirstlane_b32 s74, v30
    s_nop 0
    s_cmp_lg_u32 s74, 0
    s_cbranch_scc1 CC_NONCE_OK
    s_sleep 2
    buffer_load_dword v30, v31, s[68:71], 0 offen sc1
    s_waitcnt vmcnt(0)
    s_sub_u32 s47, s47, 1
    s_cmp_lg_u32 s47, 0
    s_cbranch_scc1 CC_NONCE
CC_NONCE_OK:
    v_mov_b32 v30, s74
    v_mov_b32 v31, s74
    s_mov_b32 s49, 0
    v_mfma_f32_32x32x16_bf16 v[176:191], v[68:71], v[56:59], v[176:191]
    s_waitcnt lgkmcnt(0)
    v_mfma_f32_32x32x16_bf16 v[96:111], v[40:43], v[32:35], v[96:111]
    ds_read_b128 v[52:55], v11 offset:32768
    ds_read_b64_tr_b16 v[60:61], v12 offset:18432
    ds_read_b64_tr_b16 v[62:63], v12 offset:19968
    v_mfma_f32_32x32x16_bf16 v[112:127], v[40:43], v[36:39], v[112:127]
    ds_read_b128 v[56:59], v11 offset:36864
    ds_read_b64_tr_b16 v[64:65], v13 offset:18432
    ds_read_b64_tr_b16 v[66:67], v13 offset:19968
    v_mfma_f32_32x32x16_bf16 v[128:143], v[44:47], v[32:35], v[128:143]
    ds_read_b64_tr_b16 v[68:69], v14 offset:18432
    ds_read_b64_tr_b16 v[70:71], v14 offset:19968
    v_mfma_f32_32x32x16_bf16 v[144:159], v[44:47], v[36:39], v[144:159]
    v_mfma_f32_32x32x16_bf16 v[160:175], v[48:51], v[32:35], v[160:175]
    v_mfma_f32_32x32x16_bf16 v[176:191], v[48:51], v[36:39], v[176:191]
    s_waitcnt lgkmcnt(0)
    v_mfma_f32_32x32x16_bf16 v[96:111], v[60:63], v[52:55], v[96:111]
    s_barrier
    ds_read_b128 v[32:35], v4 offset:0
    ds_read_b64_tr_b16 v[40:41], v15 offset:24576
    ds_read_b64_tr_b16 v[42:43], v15 offset:25088
    v_mfma_f32_32x32x16_bf16 v[112:127], v[60:63], v[56:59], v[112:127]
    ds_read_b128 v[36:39], v4 offset:4096
    ds_read_b64_tr_b16 v[44:45], v16 offset:24576
    ds_read_b64_tr_b16 v[46:47], v16 offset:25088
    v_mfma_f32_32x32x16_bf16 v[128:143], v[64:67], v[52:55], v[128:143]
    v_mfma_f32_32x32x16_bf16 v[144:159], v[64:67], v[56:59], v[144:159]
    v_mfma_f32_32x32x16_bf16 v[160:175], v[68:71], v[52:55], v[160:175]
    v_mfma_f32_32x32x16_bf16 v[176:191], v[68:71], v[56:59], v[176:191]
    s_waitcnt lgkmcnt(0)
    v_mfma_f32_32x32x16_bf16 v[192:207], v[40:43], v[32:35], 0
    s_barrier
    ds_read_b128 v[48:51], v5 offset:0
    ds_read_b64_tr_b16 v[56:57], v15 offset:26624
    ds_read_b64_tr_b16 v[58:59], v15 offset:27136
    ds_read_b128 v[52:55], v5 offset:4096
    s_add_u32 s44, s39, 0
    s_lshl_b32 s44, s44, s42
    s_add_u32 s44, s44, s43
    v_pk_mul_f32 v[96:97], v[96:97], s[92:93]
    v_pk_mul_f32 v[98:99], v[98:99], s[92:93]
    v_pk_mul_f32 v[100:101], v[100:101], s[92:93]
    v_pk_mul_f32 v[102:103], v[102:103], s[92:93]
    v_cvt_pk_bf16_f32 v80, v96, v97
    v_cvt_pk_bf16_f32 v81, v98, v99
    v_cvt_pk_bf16_f32 v82, v100, v101
    v_cvt_pk_bf16_f32 v83, v102, v103
    buffer_store_dwordx4 v[80:83], v2, s[24:27], s44 offen offset:0 sc1
    v_pk_mul_f32 v[104:105], v[104:105], s[92:93]
    v_pk_mul_f32 v[106:107], v[106:107], s[92:93]
    v_pk_mul_f32 v[108:109], v[108:109], s[92:93]
    v_pk_mul_f32 v[110:111], v[110:111], s[92:93]
    v_cvt_pk_bf16_f32 v84, v104, v105
    v_cvt_pk_bf16_f32 v85, v106, v107
    v_cvt_pk_bf16_f32 v86, v108, v109
    v_cvt_pk_bf16_f32 v87, v110, v111
    v_cndmask_b32 v86, v86, v18, s[50:51]
    v_cndmask_b32 v87, v87, v19, s[50:51]
    buffer_store_dwordx4 v[84:87], v2, s[24:27], s44 offen offset:1024 sc1
    s_add_u32 s44, s39, 1
    s_lshl_b32 s44, s44, s42
    s_add_u32 s44, s44, s43
    v_pk_mul_f32 v[112:113], v[112:113], s[92:93]
    v_pk_mul_f32 v[114:115], v[114:115], s[92:93]
    v_pk_mul_f32 v[116:117], v[116:117], s[92:93]
    v_pk_mul_f32 v[118:119], v[118:119], s[92:93]
    v_cvt_pk_bf16_f32 v88, v112, v113
    v_cvt_pk_bf16_f32 v89, v114, v115
    v_cvt_pk_bf16_f32 v90, v116, v117
    v_cvt_pk_bf16_f32 v91, v118, v119
    buffer_store_dwordx4 v[88:91], v2, s[24:27], s44 offen offset:0 sc1
    v_pk_mul_f32 v[120:121], v[120:121], s[92:93]
    v_pk_mul_f32 v[122:123], v[122:123], s[92:93]
    v_pk_mul_f32 v[124:125], v[124:125], s[92:93]
    v_pk_mul_f32 v[126:127], v[126:127], s[92:93]
    v_cvt_pk_bf16_f32 v92, v120, v121
    v_cvt_pk_bf16_f32 v93, v122, v123
    v_cvt_pk_bf16_f32 v94, v124, v125
    v_cvt_pk_bf16_f32 v95, v126, v127
    v_cndmask_b32 v94, v94, v18, s[50:51]
    v_cndmask_b32 v95, v95, v19, s[50:51]
    buffer_store_dwordx4 v[92:95], v2, s[24:27], s44 offen offset:1024 sc1
    s_add_u32 s44, s39, 64
    s_lshl_b32 s44, s44, s42
    s_add_u32 s44, s44, s43
    v_pk_mul_f32 v[128:129], v[128:129], s[92:93]
    v_pk_mul_f32 v[130:131], v[130:131], s[92:93]
    v_pk_mul_f32 v[132:133], v[132:133], s[92:93]
    v_pk_mul_f32 v[134:135], v[134:135], s[92:93]
    v_cvt_pk_bf16_f32 v80, v128, v129
    v_cvt_pk_bf16_f32 v81, v130, v131
    v_cvt_pk_bf16_f32 v82, v132, v133
    v_cvt_pk_bf16_f32 v83, v134, v135
    buffer_store_dwordx4 v[80:83], v2, s[24:27], s44 offen offset:0 sc1
    v_pk_mul_f32 v[136:137], v[136:137], s[92:93]
    v_pk_mul_f32 v[138:139], v[138:139], s[92:93]
    v_pk_mul_f32 v[140:141], v[140:141], s[92:93]
    v_pk_mul_f32 v[142:143], v[142:143], s[92:93]
    v_cvt_pk_bf16_f32 v84, v136, v137
    v_cvt_pk_bf16_f32 v85, v138, v139
    v_cvt_pk_bf16_f32 v86, v140, v141
    v_mfma_f32_32x32x16_bf16 v[208:223], v[40:43], v[36:39], 0
    ds_read_b64_tr_b16 v[60:61], v16 offset:26624
    ds_read_b64_tr_b16 v[62:63], v16 offset:27136
    ds_read_b128 v[64:67], v6 offset:0
    ds_read_b64_tr_b16 v[72:73], v15 offset:32768
    v_cvt_pk_bf16_f32 v87, v142, v143
    v_cndmask_b32 v86, v86, v18, s[50:51]
    v_cndmask_b32 v87, v87, v19, s[50:51]
    buffer_store_dwordx4 v[84:87], v2, s[24:27], s44 offen offset:1024 sc1
    s_add_u32 s44, s39, 65
    s_lshl_b32 s44, s44, s42
    s_add_u32 s44, s44, s43
    v_pk_mul_f32 v[144:145], v[144:145], s[92:93]
    v_pk_mul_f32 v[146:147], v[146:147], s[92:93]
    v_pk_mul_f32 v[148:149], v[148:149], s[92:93]
    v_pk_mul_f32 v[150:151], v[150:151], s[92:93]
    v_cvt_pk_bf16_f32 v88, v144, v145
    v_cvt_pk_bf16_f32 v89, v146, v147
    v_cvt_pk_bf16_f32 v90, v148, v149
    v_cvt_pk_bf16_f32 v91, v150, v151
    buffer_store_dwordx4 v[88:91], v2, s[24:27], s44 offen offset:0 sc1
    v_pk_mul_f32 v[152:153], v[152:153], s[92:93]
    v_pk_mul_f32 v[154:155], v[154:155], s[92:93]
    v_pk_mul_f32 v[156:157], v[156:157], s[92:93]
    v_pk_mul_f32 v[158:159], v[158:159], s[92:93]
    v_cvt_pk_bf16_f32 v92, v152, v153
    v_cvt_pk_bf16_f32 v93, v154, v155
    v_cvt_pk_bf16_f32 v94, v156, v157
    v_cvt_pk_bf16_f32 v95, v158, v159
    v_cndmask_b32 v94, v94, v18, s[50:51]
    v_cndmask_b32 v95, v95, v19, s[50:51]
    buffer_store_dwordx4 v[92:95], v2, s[24:27], s44 offen offset:1024 sc1
    s_add_u32 s44, s39, 128
    s_lshl_b32 s44, s44, s42
    s_add_u32 s44, s44, s43
    v_pk_mul_f32 v[160:161], v[160:161], s[92:93]
    v_pk_mul_f32 v[162:163], v[162:163], s[92:93]
    v_pk_mul_f32 v[164:165], v[164:165], s[92:93]
    v_pk_mul_f32 v[166:167], v[166:167], s[92:93]
    v_cvt_pk_bf16_f32 v80, v160, v161
    v_cvt_pk_bf16_f32 v81, v162, v163
    v_cvt_pk_bf16_f32 v82, v164, v165
    v_cvt_pk_bf16_f32 v83, v166, v167
    buffer_store_dwordx4 v[80:83], v2, s[24:27], s44 offen offset:0 sc1
    v_pk_mul_f32 v[168:169], v[168:169], s[92:93]
    v_pk_mul_f32 v[170:171], v[170:171], s[92:93]
    v_pk_mul_f32 v[172:173], v[172:173], s[92:93]
    v_pk_mul_f32 v[174:175], v[174:175], s[92:93]
    v_cvt_pk_bf16_f32 v84, v168, v169
    v_cvt_pk_bf16_f32 v85, v170, v171
    v_cvt_pk_bf16_f32 v86, v172, v173
    v_cvt_pk_bf16_f32 v87, v174, v175
    v_cndmask_b32 v86, v86, v18, s[50:51]
    v_cndmask_b32 v87, v87, v19, s[50:51]
    buffer_store_dwordx4 v[84:87], v2, s[24:27], s44 offen offset:1024 sc1
    s_add_u32 s44, s39, 129
    s_lshl_b32 s44, s44, s42
    s_add_u32 s44, s44, s43
    v_pk_mul_f32 v[176:177], v[176:177], s[92:93]
    v_pk_mul_f32 v[178:179], v[178:179], s[92:93]
    v_pk_mul_f32 v[180:181], v[180:181], s[92:93]
    v_pk_mul_f32 v[182:183], v[182:183], s[92:93]
    v_cvt_pk_bf16_f32 v88, v176, v177
    v_cvt_pk_bf16_f32 v89, v178, v179
    v_cvt_pk_bf16_f32 v90, v180, v181
    v_cvt_pk_bf16_f32 v91, v182, v183
    buffer_store_dwordx4 v[88:91], v2, s[24:27], s44 offen offset:0 sc1
    v_pk_mul_f32 v[184:185], v[184:185], s[92:93]
    v_pk_mul_f32 v[186:187], v[186:187], s[92:93]
    v_pk_mul_f32 v[188:189], v[188:189], s[92:93]
    v_mfma_f32_32x32x16_bf16 v[224:239], v[44:47], v[32:35], 0
    ds_read_b64_tr_b16 v[74:75], v15 offset:33280
    ds_read_b128 v[68:71], v6 offset:4096
    ds_read_b64_tr_b16 v[76:77], v16 offset:32768
    ds_read_b64_tr_b16 v[78:79], v16 offset:33280
    v_pk_mul_f32 v[190:191], v[190:191], s[92:93]
    v_cvt_pk_bf16_f32 v92, v184, v185
    v_cvt_pk_bf16_f32 v93, v186, v187
    v_cvt_pk_bf16_f32 v94, v188, v189
    v_cvt_pk_bf16_f32 v95, v190, v191
    v_cndmask_b32 v94, v94, v18, s[50:51]
    v_cndmask_b32 v95, v95, v19, s[50:51]
    buffer_store_dwordx4 v[92:95], v2, s[24:27], s44 offen offset:1024 sc1
    v_mfma_f32_32x32x16_bf16 v[240:255], v[44:47], v[36:39], 0
    s_waitcnt lgkmcnt(6)
    v_mfma_f32_32x32x16_bf16 v[192:207], v[56:59], v[48:51], v[192:207]
    ds_read_b128 v[32:35], v7 offset:0
    ds_read_b64_tr_b16 v[40:41], v15 offset:34816
    ds_read_b64_tr_b16 v[42:43], v15 offset:35328
    v_mfma_f32_32x32x16_bf16 v[208:223], v[56:59], v[52:55], v[208:223]
    ds_read_b128 v[36:39], v7 offset:4096
    ds_read_b64_tr_b16 v[44:45], v16 offset:34816
    ds_read_b64_tr_b16 v[46:47], v16 offset:35328
    v_mfma_f32_32x32x16_bf16 v[224:239], v[60:63], v[48:51], v[224:239]
    v_mfma_f32_32x32x16_bf16 v[240:255], v[60:63], v[52:55], v[240:255]
    s_waitcnt lgkmcnt(6)
    v_mfma_f32_32x32x16_bf16 v[192:207], v[72:75], v[64:67], v[192:207]
    s_barrier
    ds_read_b128 v[48:51], v4 offset:16384
    ds_read_b64_tr_b16 v[56:57], v15 offset:40960
    ds_read_b64_tr_b16 v[58:59], v15 offset:41472
    v_mfma_f32_32x32x16_bf16 v[208:223], v[72:75], v[68:71], v[208:223]
    ds_read_b128 v[52:55], v4 offset:20480
    ds_read_b64_tr_b16 v[60:61], v16 offset:40960
    ds_read_b64_tr_b16 v[62:63], v16 offset:41472
    s_getreg_b32 s45, hwreg(HW_REG_IB_STS, 0, 4)
    v_mfma_f32_32x32x16_bf16 v[224:239], v[76:79], v[64:67], v[224:239]
    s_or_b32 s45, s45, s49
    v_mfma_f32_32x32x16_bf16 v[240:255], v[76:79], v[68:71], v[240:255]
    s_cbranch_scc0 CC_PUB30
CC_PUBR30:
    s_waitcnt lgkmcnt(6)
    v_mfma_f32_32x32x16_bf16 v[192:207], v[40:43], v[32:35], v[192:207]
    ds_read_b128 v[64:67], v5 offset:16384
    ds_read_b64_tr_b16 v[72:73], v15 offset:43008
    ds_read_b64_tr_b16 v[74:75], v15 offset:43520
    v_mfma_f32_32x32x16_bf16 v[208:223], v[40:43], v[36:39], v[208:223]
    ds_read_b128 v[68:71], v5 offset:20480
    ds_read_b64_tr_b16 v[76:77], v16 offset:43008
    ds_read_b64_tr_b16 v[78:79], v16 offset:43520
    s_getreg_b32 s45, hwreg(HW_REG_IB_STS, 0, 4)
    v_mfma_f32_32x32x16_bf16 v[224:239], v[44:47], v[32:35], v[224:239]
    s_or_b32 s45, s45, s49
    v_mfma_f32_32x32x16_bf16 v[240:255], v[44:47], v[36:39], v[240:255]
    s_cbranch_scc0 CC_PUB31
CC_PUBR31:
    s_waitcnt lgkmcnt(6)
    v_mfma_f32_32x32x16_bf16 v[192:207], v[56:59], v[48:51], v[192:207]
    s_barrier
    ds_read_b128 v[32:35], v6 offset:16384
    ds_read_b64_tr_b16 v[40:41], v15 offset:0
    ds_read_b64_tr_b16 v[42:43], v15 offset:512
    v_mfma_f32_32x32x16_bf16 v[208:223], v[56:59], v[52:55], v[208:223]
    ds_read_b128 v[36:39], v6 offset:20480
    ds_read_b64_tr_b16 v[44:45], v16 offset:0
    ds_read_b64_tr_b16 v[46:47], v16 offset:512
    s_getreg_b32 s45, hwreg(HW_REG_IB_STS, 0, 4)
    v_mfma_f32_32x32x16_bf16 v[224:239], v[60:63], v[48:51], v[224:239]
    s_or_b32 s45, s45, s49
    v_mfma_f32_32x32x16_bf16 v[240:255], v[60:63], v[52:55], v[240:255]
    s_cbranch_scc0 CC_PUB32
CC_PUBR32:
    s_waitcnt lgkmcnt(6)
    v_mfma_f32_32x32x16_bf16 v[192:207], v[72:75], v[64:67], v[192:207]
    ds_read_b128 v[48:51], v7 offset:16384
    ds_read_b64_tr_b16 v[56:57], v15 offset:2048
    ds_read_b64_tr_b16 v[58:59], v15 offset:2560
    v_mfma_f32_32x32x16_bf16 v[208:223], v[72:75], v[68:71], v[208:223]
    ds_read_b128 v[52:55], v7 offset:20480
    ds_read_b64_tr_b16 v[60:61], v16 offset:2048
    ds_read_b64_tr_b16 v[62:63], v16 offset:2560
    s_getreg_b32 s45, hwreg(HW_REG_IB_STS, 0, 4)
    v_mfma_f32_32x32x16_bf16 v[224:239], v[76:79], v[64:67], v[224:239]
    s_or_b32 s45, s45, s49
    v_mfma_f32_32x32x16_bf16 v[240:255], v[76:79], v[68:71], v[240:255]
    s_cbranch_scc0 CC_PUB33
CC_PUBR33:
    s_waitcnt lgkmcnt(6)
    v_mfma_f32_32x32x16_bf16 v[192:207], v[40:43], v[32:35], v[192:207]
    s_barrier
    ds_read_b128 v[64:67], v4 offset:32768
    ds_read_b64_tr_b16 v[72:73], v15 offset:8192
    ds_read_b64_tr_b16 v[74:75], v15 offset:8704
    v_mfma_f32_32x32x16_bf16 v[208:223], v[40:43], v[36:39], v[208:223]
    ds_read_b128 v[68:71], v4 offset:36864
    ds_read_b64_tr_b16 v[76:77], v16 offset:8192
    ds_read_b64_tr_b16 v[78:79], v16 offset:8704
    s_getreg_b32 s45, hwreg(HW_REG_IB_STS, 0, 4)
    v_mfma_f32_32x32x16_bf16 v[224:239], v[44:47], v[32:35], v[224:239]
    s_or_b32 s45, s45, s49
    v_mfma_f32_32x32x16_bf16 v[240:255], v[44:47], v[36:39], v[240:255]
    s_cbranch_scc0 CC_PUB34
CC_PUBR34:
    s_waitcnt lgkmcnt(6)
    v_mfma_f32_32x32x16_bf16 v[192:207], v[56:59], v[48:51], v[192:207]
    ds_read_b128 v[32:35], v5 offset:32768
    ds_read_b64_tr_b16 v[40:41], v15 offset:10240
    ds_read_b64_tr_b16 v[42:43], v15 offset:10752
    v_mfma_f32_32x32x16_bf16 v[208:223], v[56:59], v[52:55], v[208:223]
    ds_read_b128 v[36:39], v5 offset:36864
    ds_read_b64_tr_b16 v[44:45], v16 offset:10240
    ds_read_b64_tr_b16 v[46:47], v16 offset:10752
    s_getreg_b32 s45, hwreg(HW_REG_IB_STS, 0, 4)
    v_mfma_f32_32x32x16_bf16 v[224:239], v[60:63], v[48:51], v[224:239]
    s_or_b32 s45, s45, s49
    v_mfma_f32_32x32x16_bf16 v[240:255], v[60:63], v[52:55], v[240:255]
    s_cbranch_scc0 CC_PUB35
CC_PUBR35:
    s_waitcnt lgkmcnt(6)
    v_mfma_f32_32x32x16_bf16 v[192:207], v[72:75], v[64:67], v[192:207]
    s_barrier
    ds_read_b128 v[48:51], v6 offset:32768
    ds_read_b64_tr_b16 v[56:57], v15 offset:16384
    ds_read_b64_tr_b16 v[58:59], v15 offset:16896
    v_mfma_f32_32x32x16_bf16 v[208:223], v[72:75], v[68:71], v[208:223]
    ds_read_b128 v[52:55], v6 offset:36864
    ds_read_b64_tr_b16 v[60:61], v16 offset:16384
    ds_read_b64_tr_b16 v[62:63], v16 offset:16896
    s_getreg_b32 s45, hwreg(HW_REG_IB_STS, 0, 4)
    v_mfma_f32_32x32x16_bf16 v[224:239], v[76:79], v[64:67], v[224:239]
    s_or_b32 s45, s45, s49
    v_mfma_f32_32x32x16_bf16 v[240:255], v[76:79], v[68:71], v[240:255]
    s_cbranch_scc0 CC_PUB36
CC_PUBR36:
    s_waitcnt lgkmcnt(6)
    v_mfma_f32_32x32x16_bf16 v[192:207], v[40:43], v[32:35], v[192:207]
    ds_read_b128 v[64:67], v7 offset:32768
    ds_read_b64_tr_b16 v[72:73], v15 offset:18432
    ds_read_b64_tr_b16 v[74:75], v15 offset:18944
    v_mfma_f32_32x32x16_bf16 v[208:223], v[40:43], v[36:39], v[208:223]
    ds_read_b128 v[68:71], v7 offset:36864
    ds_read_b64_tr_b16 v[76:77], v16 offset:18432
    ds_read_b64_tr_b16 v[78:79], v16 offset:18944
    s_getreg_b32 s45, hwreg(HW_REG_IB_STS, 0, 4)
    v_mfma_f32_32x32x16_bf16 v[224:239], v[44:47], v[32:35], v[224:239]
    s_or_b32 s45, s45, s49
    v_mfma_f32_32x32x16_bf16 v[240:255], v[44:47], v[36:39], v[240:255]
    s_cbranch_scc0 CC_PUB37
CC_PUBR37:
    s_waitcnt lgkmcnt(6)
    v_mfma_f32_32x32x16_bf16 v[192:207], v[56:59], v[48:51], v[192:207]
    s_barrier
    ds_read_b128 v[32:35], v4 offset:49152
    ds_read_b64_tr_b16 v[40:41], v15 offset:24576
    ds_read_b64_tr_b16 v[42:43], v15 offset:25088
    v_mfma_f32_32x32x16_bf16 v[208:223], v[56:59], v[52:55], v[208:223]
    ds_read_b128 v[36:39], v4 offset:53248
    ds_read_b64_tr_b16 v[44:45], v16 offset:24576
    ds_read_b64_tr_b16 v[46:47], v16 offset:25088
    s_getreg_b32 s45, hwreg(HW_REG_IB_STS, 0, 4)
    v_mfma_f32_32x32x16_bf16 v[224:239], v[60:63], v[48:51], v[224:239]
    s_or_b32 s45, s45, s49
    v_mfma_f32_32x32x16_bf16 v[240:255], v[60:63], v[52:55], v[240:255]
    s_cbranch_scc0 CC_PUB38
CC_PUBR38:
    s_waitcnt lgkmcnt(6)
    v_mfma_f32_32x32x16_bf16 v[192:207], v[72:75], v[64:67], v[192:207]
    ds_read_b128 v[48:51], v5 offset:49152
    ds_read_b64_tr_b16 v[56:57], v15 offset:26624
    ds_read_b64_tr_b16 v[58:59], v15 offset:27136
    v_mfma_f32_32x32x16_bf16 v[208:223], v[72:75], v[68:71], v[208:223]
    ds_read_b128 v[52:55], v5 offset:53248
    ds_read_b64_tr_b16 v[60:61], v16 offset:26624
    ds_read_b64_tr_b16 v[62:63], v16 offset:27136
    s_getreg_b32 s45, hwreg(HW_REG_IB_STS, 0, 4)
    v_mfma_f32_32x32x16_bf16 v[224:239], v[76:79], v[64:67], v[224:239]
    s_or_b32 s45, s45, s49
    v_mfma_f32_32x32x16_bf16 v[240:255], v[76:79], v[68:71], v[240:255]
    s_cbranch_scc0 CC_PUB39
CC_PUBR39:
    s_waitcnt lgkmcnt(6)
    v_mfma_f32_32x32x16_bf16 v[192:207], v[40:43], v[32:35], v[192:207]
    s_barrier
    ds_read_b128 v[64:67], v6 offset:49152
    ds_read_b64_tr_b16 v[72:73], v15 offset:32768
    ds_read_b64_tr_b16 v[74:75], v15 offset:33280
    v_mfma_f32_32x32x16_bf16 v[208:223], v[40:43], v[36:39], v[208:223]
    ds_read_b128 v[68:71], v6 offset:53248
    ds_read_b64_tr_b16 v[76:77], v16 offset:32768
    ds_read_b64_tr_b16 v[78:79], v16 offset:33280
    s_getreg_b32 s45, hwreg(HW_REG_IB_STS, 0, 4)
    v_mfma_f32_32x32x16_bf16 v[224:239], v[44:47], v[32:35], v[224:239]
    s_or_b32 s45, s45, s49
    v_mfma_f32_32x32x16_bf16 v[240:255], v[44:47], v[36:39], v[240:255]
    s_cbranch_scc0 CC_PUB40
CC_PUBR40:
    s_waitcnt lgkmcnt(6)
    v_mfma_f32_32x32x16_bf16 v[192:207], v[56:59], v[48:51], v[192:207]
    ds_read_b128 v[32:35], v7 offset:49152
    ds_read_b64_tr_b16 v[40:41], v15 offset:34816
    ds_read_b64_tr_b16 v[42:43], v15 offset:35328
    v_mfma_f32_32x32x16_bf16 v[208:223], v[56:59], v[52:55], v[208:223]
    ds_read_b128 v[36:39], v7 offset:53248
    ds_read_b64_tr_b16 v[44:45], v16 offset:34816
    ds_read_b64_tr_b16 v[46:47], v16 offset:35328
    s_getreg_b32 s45, hwreg(HW_REG_IB_STS, 0, 4)
    v_mfma_f32_32x32x16_bf16 v[224:239], v[60:63], v[48:51], v[224:239]
    s_or_b32 s45, s45, s49
    v_mfma_f32_32x32x16_bf16 v[240:255], v[60:63], v[52:55], v[240:255]
    s_cbranch_scc0 CC_PUB41
CC_PUBR41:
    s_waitcnt lgkmcnt(6)
    v_mfma_f32_32x32x16_bf16 v[192:207], v[72:75], v[64:67], v[192:207]
    s_barrier
    ds_read_b128 v[48:51], v8 offset:0
    ds_read_b64_tr_b16 v[56:57], v15 offset:40960
    ds_read_b64_tr_b16 v[58:59], v15 offset:41472
    v_mfma_f32_32x32x16_bf16 v[208:223], v[72:75], v[68:71], v[208:223]
    ds_read_b128 v[52:55], v8 offset:4096
    ds_read_b64_tr_b16 v[60:61], v16 offset:40960
    ds_read_b64_tr_b16 v[62:63], v16 offset:41472
    s_getreg_b32 s45, hwreg(HW_REG_IB_STS, 0, 4)
    v_mfma_f32_32x32x16_bf16 v[224:239], v[76:79], v[64:67], v[224:239]
    s_or_b32 s45, s45, s49
    v_mfma_f32_32x32x16_bf16 v[240:255], v[76:79], v[68:71], v[240:255]
    s_cbranch_scc0 CC_PUB42
CC_PUBR42:
    s_waitcnt lgkmcnt(6)
    v_mfma_f32_32x32x16_bf16 v[192:207], v[40:43], v[32:35], v[192:207]
    ds_read_b128 v[64:67], v9 offset:0
    ds_read_b64_tr_b16 v[72:73], v15 offset:43008
    ds_read_b64_tr_b16 v[74:75], v15 offset:43520
    v_mfma_f32_32x32x16_bf16 v[208:223], v[40:43], v[36:39], v[208:223]
    ds_read_b128 v[68:71], v9 offset:4096
    ds_read_b64_tr_b16 v[76:77], v16 offset:43008
    ds_read_b64_tr_b16 v[78:79], v16 offset:43520
    s_getreg_b32 s45, hwreg(HW_REG_IB_STS, 0, 4)
    v_mfma_f32_32x32x16_bf16 v[224:239], v[44:47], v[32:35], v[224:239]
    s_or_b32 s45, s45, s49
    v_mfma_f32_32x32x16_bf16 v[240:255], v[44:47], v[36:39], v[240:255]
    s_cbranch_scc0 CC_PUB43
CC_PUBR43:
    s_waitcnt lgkmcnt(6)
    v_mfma_f32_32x32x16_bf16 v[192:207], v[56:59], v[48:51], v[192:207]
    s_barrier
    ds_read_b128 v[32:35], v10 offset:0
    ds_read_b64_tr_b16 v[40:41], v15 offset:0
    ds_read_b64_tr_b16 v[42:43], v15 offset:512
    v_mfma_f32_32x32x16_bf16 v[208:223], v[56:59], v[52:55], v[208:223]
    ds_read_b128 v[36:39], v10 offset:4096
    ds_read_b64_tr_b16 v[44:45], v16 offset:0
    ds_read_b64_tr_b16 v[46:47], v16 offset:512
    s_getreg_b32 s45, hwreg(HW_REG_IB_STS, 0, 4)
    v_mfma_f32_32x32x16_bf16 v[224:239], v[60:63], v[48:51], v[224:239]
    s_or_b32 s45, s45, s49
    v_mfma_f32_32x32x16_bf16 v[240:255], v[60:63], v[52:55], v[240:255]
    s_cbranch_scc0 CC_PUB44
CC_PUBR44:
    s_waitcnt lgkmcnt(6)
    v_mfma_f32_32x32x16_bf16 v[192:207], v[72:75], v[64:67], v[192:207]
    ds_read_b128 v[48:51], v11 offset:0
    ds_read_b64_tr_b16 v[56:57], v15 offset:2048
    ds_read_b64_tr_b16 v[58:59], v15 offset:2560
    v_mfma_f32_32x32x16_bf16 v[208:223], v[72:75], v[68:71], v[208:223]
    ds_read_b128 v[52:55], v11 offset:4096
    ds_read_b64_tr_b16 v[60:61], v16 offset:2048
    ds_read_b64_tr_b16 v[62:63], v16 offset:2560
    s_getreg_b32 s45, hwreg(HW_REG_IB_STS, 0, 4)
    v_mfma_f32_32x32x16_bf16 v[224:239], v[76:79], v[64:67], v[224:239]
    s_or_b32 s45, s45, s49
    v_mfma_f32_32x32x16_bf16 v[240:255], v[76:79], v[68:71], v[240:255]
    s_cbranch_scc0 CC_PUB45
CC_PUBR45:
    s_waitcnt lgkmcnt(6)
    v_mfma_f32_32x32x16_bf16 v[192:207], v[40:43], v[32:35], v[192:207]
    s_barrier
    ds_read_b128 v[64:67], v8 offset:16384
    ds_read_b64_tr_b16 v[72:73], v15 offset:8192
    ds_read_b64_tr_b16 v[74:75], v15 offset:8704
    v_mfma_f32_32x32x16_bf16 v[208:223], v[40:43], v[36:39], v[208:223]
    ds_read_b128 v[68:71], v8 offset:20480
    ds_read_b64_tr_b16 v[76:77], v16 offset:8192
    ds_read_b64_tr_b16 v[78:79], v16 offset:8704
    s_getreg_b32 s45, hwreg(HW_REG_IB_STS, 0, 4)
    v_mfma_f32_32x32x16_bf16 v[224:239], v[44:47], v[32:35], v[224:239]
    s_or_b32 s45, s45, s49
    v_mfma_f32_32x32x16_bf16 v[240:255], v[44:47], v[36:39], v[240:255]
    s_cbranch_scc0 CC_PUB46
CC_PUBR46:
    s_waitcnt lgkmcnt(6)
    v_mfma_f32_32x32x16_bf16 v[192:207], v[56:59], v[48:51], v[192:207]
    ds_read_b128 v[32:35], v9 offset:16384
    ds_read_b64_tr_b16 v[40:41], v15 offset:10240
    ds_read_b64_tr_b16 v[42:43], v15 offset:10752
    v_mfma_f32_32x32x16_bf16 v[208:223], v[56:59], v[52:55], v[208:223]
    ds_read_b128 v[36:39], v9 offset:20480
    ds_read_b64_tr_b16 v[44:45], v16 offset:10240
    ds_read_b64_tr_b16 v[46:47], v16 offset:10752
    s_getreg_b32 s45, hwreg(HW_REG_IB_STS, 0, 4)
    v_mfma_f32_32x32x16_bf16 v[224:239], v[60:63], v[48:51], v[224:239]
    s_or_b32 s45, s45, s49
    v_mfma_f32_32x32x16_bf16 v[240:255], v[60:63], v[52:55], v[240:255]
    s_cbranch_scc0 CC_PUB47
CC_PUBR47:
    s_waitcnt lgkmcnt(6)
    v_mfma_f32_32x32x16_bf16 v[192:207], v[72:75], v[64:67], v[192:207]
    s_barrier
    ds_read_b128 v[48:51], v10 offset:16384
    ds_read_b64_tr_b16 v[56:57], v15 offset:16384
    ds_read_b64_tr_b16 v[58:59], v15 offset:16896
    v_mfma_f32_32x32x16_bf16 v[208:223], v[72:75], v[68:71], v[208:223]
    ds_read_b128 v[52:55], v10 offset:20480
    ds_read_b64_tr_b16 v[60:61], v16 offset:16384
    ds_read_b64_tr_b16 v[62:63], v16 offset:16896
    s_getreg_b32 s45, hwreg(HW_REG_IB_STS, 0, 4)
    v_mfma_f32_32x32x16_bf16 v[224:239], v[76:79], v[64:67], v[224:239]
    s_or_b32 s45, s45, s49
    v_mfma_f32_32x32x16_bf16 v[240:255], v[76:79], v[68:71], v[240:255]
    s_cbranch_scc0 CC_PUB48
CC_PUBR48:
    s_waitcnt lgkmcnt(6)
    v_mfma_f32_32x32x16_bf16 v[192:207], v[40:43], v[32:35], v[192:207]
    ds_read_b128 v[64:67], v11 offset:16384
    ds_read_b64_tr_b16 v[72:73], v15 offset:18432
    ds_read_b64_tr_b16 v[74:75], v15 offset:18944
    v_mfma_f32_32x32x16_bf16 v[208:223], v[40:43], v[36:39], v[208:223]
    ds_read_b128 v[68:71], v11 offset:20480
    ds_read_b64_tr_b16 v[76:77], v16 offset:18432
    ds_read_b64_tr_b16 v[78:79], v16 offset:18944
    s_getreg_b32 s45, hwreg(HW_REG_IB_STS, 0, 4)
    v_mfma_f32_32x32x16_bf16 v[224:239], v[44:47], v[32:35], v[224:239]
    s_or_b32 s45, s45, s49
    v_mfma_f32_32x32x16_bf16 v[240:255], v[44:47], v[36:39], v[240:255]
    s_cbranch_scc0 CC_PUB49
CC_PUBR49:
    s_waitcnt lgkmcnt(6)
    v_mfma_f32_32x32x16_bf16 v[192:207], v[56:59], v[48:51], v[192:207]
    s_barrier
    ds_read_b128 v[32:35], v8 offset:32768
    ds_read_b64_tr_b16 v[40:41], v15 offset:24576
    ds_read_b64_tr_b16 v[42:43], v15 offset:25088
    v_mfma_f32_32x32x16_bf16 v[208:223], v[56:59], v[52:55], v[208:223]
    ds_read_b128 v[36:39], v8 offset:36864
    ds_read_b64_tr_b16 v[44:45], v16 offset:24576
    ds_read_b64_tr_b16 v[46:47], v16 offset:25088
    s_getreg_b32 s45, hwreg(HW_REG_IB_STS, 0, 4)
    v_mfma_f32_32x32x16_bf16 v[224:239], v[60:63], v[48:51], v[224:239]
    s_or_b32 s45, s45, s49
    v_mfma_f32_32x32x16_bf16 v[240:255], v[60:63], v[52:55], v[240:255]
    s_cbranch_scc0 CC_PUB50
CC_PUBR50:
    s_waitcnt lgkmcnt(6)
    v_mfma_f32_32x32x16_bf16 v[192:207], v[72:75], v[64:67], v[192:207]
    ds_read_b128 v[48:51], v9 offset:32768
    ds_read_b64_tr_b16 v[56:57], v15 offset:26624
    ds_read_b64_tr_b16 v[58:59], v15 offset:27136
    v_mfma_f32_32x32x16_bf16 v[208:223], v[72:75], v[68:71], v[208:223]
    ds_read_b128 v[52:55], v9 offset:36864
    ds_read_b64_tr_b16 v[60:61], v16 offset:26624
    ds_read_b64_tr_b16 v[62:63], v16 offset:27136
    s_getreg_b32 s45, hwreg(HW_REG_IB_STS, 0, 4)
    v_mfma_f32_32x32x16_bf16 v[224:239], v[76:79], v[64:67], v[224:239]
    s_or_b32 s45, s45, s49
    v_mfma_f32_32x32x16_bf16 v[240:255], v[76:79], v[68:71], v[240:255]
    s_cbranch_scc0 CC_PUB51
CC_PUBR51:
    s_waitcnt lgkmcnt(6)
    v_mfma_f32_32x32x16_bf16 v[192:207], v[40:43], v[32:35], v[192:207]
    s_barrier
    ds_read_b128 v[64:67], v10 offset:32768
    ds_read_b64_tr_b16 v[72:73], v15 offset:32768
    ds_read_b64_tr_b16 v[74:75], v15 offset:33280
    v_mfma_f32_32x32x16_bf16 v[208:223], v[40:43], v[36:39], v[208:223]
    ds_read_b128 v[68:71], v10 offset:36864
    ds_read_b64_tr_b16 v[76:77], v16 offset:32768
    ds_read_b64_tr_b16 v[78:79], v16 offset:33280
    s_getreg_b32 s45, hwreg(HW_REG_IB_STS, 0, 4)
    v_mfma_f32_32x32x16_bf16 v[224:239], v[44:47], v[32:35], v[224:239]
    s_or_b32 s45, s45, s49
    v_mfma_f32_32x32x16_bf16 v[240:255], v[44:47], v[36:39], v[240:255]
    s_cbranch_scc0 CC_PUB52
CC_PUBR52:
    s_waitcnt lgkmcnt(6)
    v_mfma_f32_32x32x16_bf16 v[192:207], v[56:59], v[48:51], v[192:207]
    ds_read_b128 v[32:35], v11 offset:32768
    ds_read_b64_tr_b16 v[40:41], v15 offset:34816
    ds_read_b64_tr_b16 v[42:43], v15 offset:35328
    v_mfma_f32_32x32x16_bf16 v[208:223], v[56:59], v[52:55], v[208:223]
    ds_read_b128 v[36:39], v11 offset:36864
    ds_read_b64_tr_b16 v[44:45], v16 offset:34816
    ds_read_b64_tr_b16 v[46:47], v16 offset:35328
    s_getreg_b32 s45, hwreg(HW_REG_IB_STS, 0, 4)
    v_mfma_f32_32x32x16_bf16 v[224:239], v[60:63], v[48:51], v[224:239]
    s_or_b32 s45, s45, s49
    v_mfma_f32_32x32x16_bf16 v[240:255], v[60:63], v[52:55], v[240:255]
    s_cbranch_scc0 CC_PUB53
CC_PUBR53:
    s_waitcnt lgkmcnt(6)
    v_mfma_f32_32x32x16_bf16 v[192:207], v[72:75], v[64:67], v[192:207]
    v_mfma_f32_32x32x16_bf16 v[208:223], v[72:75], v[68:71], v[208:223]
    s_cmp_lg_u32 s49, 0
    s_cbranch_scc1 CC_W54
    s_waitcnt vmcnt(0)
CC_W54:
    s_getreg_b32 s45, hwreg(HW_REG_IB_STS, 0, 4)
    v_mfma_f32_32x32x16_bf16 v[224:239], v[76:79], v[64:67], v[224:239]
    s_or_b32 s45, s45, s49
    v_mfma_f32_32x32x16_bf16 v[240:255], v[76:79], v[68:71], v[240:255]
    s_cbranch_scc0 CC_PUB54
CC_PUBR54:
    s_waitcnt lgkmcnt(0)
    v_mfma_f32_32x32x16_bf16 v[192:207], v[40:43], v[32:35], v[192:207]
    v_mfma_f32_32x32x16_bf16 v[208:223], v[40:43], v[36:39], v[208:223]
    v_mfma_f32_32x32x16_bf16 v[224:239], v[44:47], v[32:35], v[224:239]
    v_mfma_f32_32x32x16_bf16 v[240:255], v[44:47], v[36:39], v[240:255]
    s_mov_b32 s40, 2147479552
    s_mov_b32 s41, 2147479552
    s_branch ROLE_A
CC_PUB30:
    s_mov_b32 exec_hi, 0xffff
    buffer_store_dwordx2 v[30:31], v17, s[24:27], s48 offen sc1
    s_mov_b64 exec, -1
    s_mov_b32 s49, 1
    s_branch CC_PUBR30
CC_PUB31:
    s_mov_b32 exec_hi, 0xffff
    buffer_store_dwordx2 v[30:31], v17, s[24:27], s48 offen sc1
    s_mov_b64 exec, -1
    s_mov_b32 s49, 1
    s_branch CC_PUBR31
CC_PUB32:
    s_mov_b32 exec_hi, 0xffff
    buffer_store_dwordx2 v[30:31], v17, s[24:27], s48 offen sc1
    s_mov_b64 exec, -1
    s_mov_b32 s49, 1
    s_branch CC_PUBR32
CC_PUB33:
    s_mov_b32 exec_hi, 0xffff
    buffer_store_dwordx2 v[30:31], v17, s[24:27], s48 offen sc1
    s_mov_b64 exec, -1
    s_mov_b32 s49, 1
    s_branch CC_PUBR33
CC_PUB34:
    s_mov_b32 exec_hi, 0xffff
    buffer_store_dwordx2 v[30:31], v17, s[24:27], s48 offen sc1
    s_mov_b64 exec, -1
    s_mov_b32 s49, 1
    s_branch CC_PUBR34
CC_PUB35:
    s_mov_b32 exec_hi, 0xffff
    buffer_store_dwordx2 v[30:31], v17, s[24:27], s48 offen sc1
    s_mov_b64 exec, -1
    s_mov_b32 s49, 1
    s_branch CC_PUBR35
CC_PUB36:
    s_mov_b32 exec_hi, 0xffff
    buffer_store_dwordx2 v[30:31], v17, s[24:27], s48 offen sc1
    s_mov_b64 exec, -1
    s_mov_b32 s49, 1
    s_branch CC_PUBR36
CC_PUB37:
    s_mov_b32 exec_hi, 0xffff
    buffer_store_dwordx2 v[30:31], v17, s[24:27], s48 offen sc1
    s_mov_b64 exec, -1
    s_mov_b32 s49, 1
    s_branch CC_PUBR37
CC_PUB38:
    s_mov_b32 exec_hi, 0xffff
    buffer_store_dwordx2 v[30:31], v17, s[24:27], s48 offen sc1
    s_mov_b64 exec, -1
    s_mov_b32 s49, 1
    s_branch CC_PUBR38
CC_PUB39:
    s_mov_b32 exec_hi, 0xffff
    buffer_store_dwordx2 v[30:31], v17, s[24:27], s48 offen sc1
    s_mov_b64 exec, -1
    s_mov_b32 s49, 1
    s_branch CC_PUBR39
CC_PUB40:
    s_mov_b32 exec_hi, 0xffff
    buffer_store_dwordx2 v[30:31], v17, s[24:27], s48 offen sc1
    s_mov_b64 exec, -1
    s_mov_b32 s49, 1
    s_branch CC_PUBR40
CC_PUB41:
    s_mov_b32 exec_hi, 0xffff
    buffer_store_dwordx2 v[30:31], v17, s[24:27], s48 offen sc1
    s_mov_b64 exec, -1
    s_mov_b32 s49, 1
    s_branch CC_PUBR41
CC_PUB42:
    s_mov_b32 exec_hi, 0xffff
    buffer_store_dwordx2 v[30:31], v17, s[24:27], s48 offen sc1
    s_mov_b64 exec, -1
    s_mov_b32 s49, 1
    s_branch CC_PUBR42
CC_PUB43:
    s_mov_b32 exec_hi, 0xffff
    buffer_store_dwordx2 v[30:31], v17, s[24:27], s48 offen sc1
    s_mov_b64 exec, -1
    s_mov_b32 s49, 1
    s_branch CC_PUBR43
CC_PUB44:
    s_mov_b32 exec_hi, 0xffff
    buffer_store_dwordx2 v[30:31], v17, s[24:27], s48 offen sc1
    s_mov_b64 exec, -1
    s_mov_b32 s49, 1
    s_branch CC_PUBR44
CC_PUB45:
    s_mov_b32 exec_hi, 0xffff
    buffer_store_dwordx2 v[30:31], v17, s[24:27], s48 offen sc1
    s_mov_b64 exec, -1
    s_mov_b32 s49, 1
    s_branch CC_PUBR45
CC_PUB46:
    s_mov_b32 exec_hi, 0xffff
    buffer_store_dwordx2 v[30:31], v17, s[24:27], s48 offen sc1
    s_mov_b64 exec, -1
    s_mov_b32 s49, 1
    s_branch CC_PUBR46
CC_PUB47:
    s_mov_b32 exec_hi, 0xffff
    buffer_store_dwordx2 v[30:31], v17, s[24:27], s48 offen sc1
    s_mov_b64 exec, -1
    s_mov_b32 s49, 1
    s_branch CC_PUBR47
CC_PUB48:
    s_mov_b32 exec_hi, 0xffff
    buffer_store_dwordx2 v[30:31], v17, s[24:27], s48 offen sc1
    s_mov_b64 exec, -1
    s_mov_b32 s49, 1
    s_branch CC_PUBR48
CC_PUB49:
    s_mov_b32 exec_hi, 0xffff
    buffer_store_dwordx2 v[30:31], v17, s[24:27], s48 offen sc1
    s_mov_b64 exec, -1
    s_mov_b32 s49, 1
    s_branch CC_PUBR49
CC_PUB50:
    s_mov_b32 exec_hi, 0xffff
    buffer_store_dwordx2 v[30:31], v17, s[24:27], s48 offen sc1
    s_mov_b64 exec, -1
    s_mov_b32 s49, 1
    s_branch CC_PUBR50
CC_PUB51:
    s_mov_b32 exec_hi, 0xffff
    buffer_store_dwordx2 v[30:31], v17, s[24:27], s48 offen sc1
    s_mov_b64 exec, -1
    s_mov_b32 s49, 1
    s_branch CC_PUBR51
CC_PUB52:
    s_mov_b32 exec_hi, 0xffff
    buffer_store_dwordx2 v[30:31], v17, s[24:27], s48 offen sc1
    s_mov_b64 exec, -1
    s_mov_b32 s49, 1
    s_branch CC_PUBR52
CC_PUB53:
    s_mov_b32 exec_hi, 0xffff
    buffer_store_dwordx2 v[30:31], v17, s[24:27], s48 offen sc1
    s_mov_b64 exec, -1
    s_mov_b32 s49, 1
    s_branch CC_PUBR53
CC_PUB54:
    s_mov_b32 exec_hi, 0xffff
    buffer_store_dwordx2 v[30:31], v17, s[24:27], s48 offen sc1
    s_mov_b64 exec, -1
    s_mov_b32 s49, 1
    s_branch CC_PUBR54
K_CD:
    s_waitcnt vmcnt(4)
    s_barrier
    ds_read_b128 v[32:35], v4 offset:0
    ds_read_b64_tr_b16 v[40:41], v12 offset:0
    ds_read_b64_tr_b16 v[42:43], v12 offset:1536
    ds_read_b128 v[36:39], v4 offset:4096
    ds_read_b64_tr_b16 v[44:45], v13 offset:0
    ds_read_b64_tr_b16 v[46:47], v13 offset:1536
    ds_read_b64_tr_b16 v[48:49], v14 offset:0
    ds_read_b64_tr_b16 v[50:51], v14 offset:1536
    s_waitcnt lgkmcnt(0)
    v_mfma_f32_32x32x16_bf16 v[96:111], v[32:35], v[40:43], 0
    ds_read_b128 v[52:55], v5 offset:0
    ds_read_b64_tr_b16 v[60:61], v12 offset:6144
    ds_read_b64_tr_b16 v[62:63], v12 offset:7680
    v_mfma_f32_32x32x16_bf16 v[112:127], v[36:39], v[40:43], 0
    ds_read_b128 v[56:59], v5 offset:4096
    ds_read_b64_tr_b16 v[64:65], v13 offset:6144
    ds_read_b64_tr_b16 v[66:67], v13 offset:7680
    v_mfma_f32_32x32x16_bf16 v[128:143], v[32:35], v[44:47], 0
    ds_read_b64_tr_b16 v[68:69], v14 offset:6144
    ds_read_b64_tr_b16 v[70:71], v14 offset:7680
    v_mfma_f32_32x32x16_bf16 v[144:159], v[36:39], v[44:47], 0
    v_mfma_f32_32x32x16_bf16 v[160:175], v[32:35], v[48:51], 0
    v_mfma_f32_32x32x16_bf16 v[176:191], v[36:39], v[48:51], 0
    s_waitcnt lgkmcnt(0)
    v_mfma_f32_32x32x16_bf16 v[96:111], v[52:55], v[60:63], v[96:111]
    s_waitcnt vmcnt(1)
    s_barrier
    ds_read_b128 v[32:35], v6 offset:0
    ds_read_b64_tr_b16 v[40:41], v12 offset:12288
    ds_read_b64_tr_b16 v[42:43], v12 offset:13824
    v_lshlrev_b32 v29, 2, v29
    v_lshl_add_u32 v29, v24, 1, v29
    v_lshrrev_b32 v30, 1, v26
    v_mfma_f32_32x32x16_bf16 v[112:127], v[56:59], v[60:63], v[112:127]
    ds_read_b128 v[36:39], v6 offset:4096
    ds_read_b64_tr_b16 v[44:45], v13 offset:12288
    ds_read_b64_tr_b16 v[46:47], v13 offset:13824
    s_lshl_b32 s37, s36, 2
    v_add_u32 v30, s37, v30
    v_and_b32 v31, 1, v26
    v_mfma_f32_32x32x16_bf16 v[128:143], v[52:55], v[64:67], v[128:143]
    ds_read_b64_tr_b16 v[48:49], v14 offset:12288
    ds_read_b64_tr_b16 v[50:51], v14 offset:13824
    v_lshlrev_b32 v31, 3, v31
    v_lshl_add_u32 v31, v27, 7, v31
    v_lshl_add_u32 v31, v24, 12, v31
    v_mfma_f32_32x32x16_bf16 v[144:159], v[56:59], v[64:67], v[144:159]
    v_add_u32 v31, 114688, v31
    v_add_u32 v28, 0, v30
    v_xor_b32 v28, v28, v29
    v_mfma_f32_32x32x16_bf16 v[160:175], v[52:55], v[68:71], v[160:175]
    v_lshl_add_u32 v15, v28, 4, v31
    v_add_u32 v28, 2, v30
    v_xor_b32 v28, v28, v29
    v_mfma_f32_32x32x16_bf16 v[176:191], v[56:59], v[68:71], v[176:191]
    v_lshl_add_u32 v16, v28, 4, v31
    v_add_u32 v8, 0x10000, v4
    v_add_u32 v9, 0x10000, v5
    s_waitcnt lgkmcnt(0)
    v_mfma_f32_32x32x16_bf16 v[96:111], v[32:35], v[40:43], v[96:111]
    ds_read_b128 v[52:55], v7 offset:0
    ds_read_b64_tr_b16 v[60:61], v12 offset:18432
    ds_read_b64_tr_b16 v[62:63], v12 offset:19968
    v_add_u32 v10, 0x10000, v6
    v_add_u32 v11, 0x10000, v7
    s_mov_b32 s30, 896
    v_mfma_f32_32x32x16_bf16 v[112:127], v[36:39], v[40:43], v[112:127]
    ds_read_b128 v[56:59], v7 offset:4096
    ds_read_b64_tr_b16 v[64:65], v13 offset:18432
    ds_read_b64_tr_b16 v[66:67], v13 offset:19968
    s_mov_b32 s31, 0x00020000
    s_mov_b32 s26, 17498112
    s_mov_b32 s27, 0x00020000
    v_mfma_f32_32x32x16_bf16 v[128:143], v[32:35], v[44:47], v[128:143]
    ds_read_b64_tr_b16 v[68:69], v14 offset:18432
    ds_read_b64_tr_b16 v[70:71], v14 offset:19968
    s_mov_b32 s58, 1605632
    s_mov_b32 s59, 0x00020000
    s_mov_b32 s62, 401408
    v_mfma_f32_32x32x16_bf16 v[144:159], v[36:39], v[44:47], v[144:159]
    s_mov_b32 s63, 0x00020000
    s_mov_b32 s66, 1835008
    s_mov_b32 s67, 0x00020000
    v_mfma_f32_32x32x16_bf16 v[160:175], v[32:35], v[48:51], v[160:175]
    s_mov_b32 s70, 256
    s_mov_b32 s71, 0x00020000
    s_and_b32 s4, s2, 7
    v_mfma_f32_32x32x16_bf16 v[176:191], v[36:39], v[48:51], v[176:191]
    s_lshl_b32 s4, s4, 1
    s_lshr_b32 s5, s2, 7
    s_add_u32 s37, s4, s5
    s_waitcnt lgkmcnt(0)
    v_mfma_f32_32x32x16_bf16 v[96:111], v[52:55], v[60:63], v[96:111]
    s_barrier
    ds_read_b128 v[32:35], v4 offset:16384
    ds_read_b64_tr_b16 v[40:41], v12 offset:24576
    ds_read_b64_tr_b16 v[42:43], v12 offset:26112
    s_bfe_u32 s38, s2, 0x40003
    s_lshl_b32 s6, s37, 18
    v_mfma_f32_32x32x16_bf16 v[112:127], v[56:59], v[60:63], v[112:127]
    ds_read_b128 v[36:39], v4 offset:20480
    ds_read_b64_tr_b16 v[44:45], v13 offset:24576
    ds_read_b64_tr_b16 v[46:47], v13 offset:26112
    s_add_u32 s6, s6, 2097152
    s_lshl_b32 s5, s3, 16
    v_mfma_f32_32x32x16_bf16 v[128:143], v[52:55], v[64:67], v[128:143]
    ds_read_b64_tr_b16 v[48:49], v14 offset:24576
    ds_read_b64_tr_b16 v[50:51], v14 offset:26112
    s_add_u32 s39, s6, s5
    s_mov_b32 s99, s39
    v_mfma_f32_32x32x16_bf16 v[144:159], v[56:59], v[64:67], v[144:159]
    v_mov_b32 v28, 0
    v_mov_b32 v27, 1
    v_mfma_f32_32x32x16_bf16 v[160:175], v[52:55], v[68:71], v[160:175]
    v_lshlrev_b32 v24, 2, v1
    s_lshl_b32 s4, s3, 12
    v_mfma_f32_32x32x16_bf16 v[176:191], v[56:59], v[68:71], v[176:191]
    v_add_u32 v3, s4, v2
    s_lshl_b32 s4, s3, 8
    s_waitcnt lgkmcnt(0)
    v_mfma_f32_32x32x16_bf16 v[96:111], v[32:35], v[40:43], v[96:111]
    ds_read_b128 v[52:55], v5 offset:16384
    ds_read_b64_tr_b16 v[60:61], v12 offset:30720
    ds_read_b64_tr_b16 v[62:63], v12 offset:32256
    v_add_u32 v25, s4, v24
    s_add_u32 s4, s38, 0
    v_mfma_f32_32x32x16_bf16 v[112:127], v[36:39], v[40:43], v[112:127]
    ds_read_b128 v[56:59], v5 offset:20480
    ds_read_b64_tr_b16 v[64:65], v13 offset:30720
    ds_read_b64_tr_b16 v[66:67], v13 offset:32256
    s_and_b32 s4, s4, 15
    s_lshl_b32 s4, s4, 12
    v_mfma_f32_32x32x16_bf16 v[128:143], v[32:35], v[44:47], v[128:143]
    ds_read_b64_tr_b16 v[68:69], v14 offset:30720
    ds_read_b64_tr_b16 v[70:71], v14 offset:32256
    s_add_u32 s8, s4, s39
    s_add_u32 s4, s38, 1
    v_mfma_f32_32x32x16_bf16 v[144:159], v[36:39], v[44:47], v[144:159]
    s_and_b32 s4, s4, 15
    s_lshl_b32 s4, s4, 12
    v_mfma_f32_32x32x16_bf16 v[160:175], v[32:35], v[48:51], v[160:175]
    s_add_u32 s9, s4, s39
    s_add_u32 s4, s38, 2
    v_mfma_f32_32x32x16_bf16 v[176:191], v[36:39], v[48:51], v[176:191]
    s_and_b32 s4, s4, 15
    s_lshl_b32 s4, s4, 12
    s_waitcnt lgkmcnt(0)
    v_mfma_f32_32x32x16_bf16 v[96:111], v[52:55], v[60:63], v[96:111]
    s_barrier
    ds_read_b128 v[32:35], v6 offset:16384
    ds_read_b64_tr_b16 v[40:41], v12 offset:36864
    ds_read_b64_tr_b16 v[42:43], v12 offset:38400
    s_add_u32 s10, s4, s39
    s_add_u32 s4, s38, 3
    v_mfma_f32_32x32x16_bf16 v[112:127], v[56:59], v[60:63], v[112:127]
    ds_read_b128 v[36:39], v6 offset:20480
    ds_read_b64_tr_b16 v[44:45], v13 offset:36864
    ds_read_b64_tr_b16 v[46:47], v13 offset:38400
    s_and_b32 s4, s4, 15
    s_lshl_b32 s4, s4, 12
    v_mfma_f32_32x32x16_bf16 v[128:143], v[52:55], v[64:67], v[128:143]
    ds_read_b64_tr_b16 v[48:49], v14 offset:36864
    ds_read_b64_tr_b16 v[50:51], v14 offset:38400
    s_add_u32 s11, s4, s39
    s_add_u32 s4, s38, 4
    v_mfma_f32_32x32x16_bf16 v[144:159], v[56:59], v[64:67], v[144:159]
    s_and_b32 s4, s4, 15
    s_lshl_b32 s4, s4, 12
    v_mfma_f32_32x32x16_bf16 v[160:175], v[52:55], v[68:71], v[160:175]
    s_add_u32 s12, s4, s39
    s_add_u32 s4, s38, 5
    v_mfma_f32_32x32x16_bf16 v[176:191], v[56:59], v[68:71], v[176:191]
    s_and_b32 s4, s4, 15
    s_lshl_b32 s4, s4, 12
    s_waitcnt lgkmcnt(0)
    v_mfma_f32_32x32x16_bf16 v[96:111], v[32:35], v[40:43], v[96:111]
    ds_read_b128 v[52:55], v7 offset:16384
    ds_read_b64_tr_b16 v[60:61], v12 offset:43008
    ds_read_b64_tr_b16 v[62:63], v12 offset:44544
    s_add_u32 s13, s4, s39
    s_add_u32 s4, s38, 6
    v_mfma_f32_32x32x16_bf16 v[112:127], v[36:39], v[40:43], v[112:127]
    ds_read_b128 v[56:59], v7 offset:20480
    ds_read_b64_tr_b16 v[64:65], v13 offset:43008
    ds_read_b64_tr_b16 v[66:67], v13 offset:44544
    s_and_b32 s4, s4, 15
    s_lshl_b32 s4, s4, 12
    v_mfma_f32_32x32x16_bf16 v[128:143], v[32:35], v[44:47], v[128:143]
    ds_read_b64_tr_b16 v[68:69], v14 offset:43008
    ds_read_b64_tr_b16 v[70:71], v14 offset:44544
    s_add_u32 s14, s4, s39
    s_add_u32 s4, s38, 7
    v_mfma_f32_32x32x16_bf16 v[144:159], v[36:39], v[44:47], v[144:159]
    s_and_b32 s4, s4, 15
    s_lshl_b32 s4, s4, 12
    v_mfma_f32_32x32x16_bf16 v[160:175], v[32:35], v[48:51], v[160:175]
    s_add_u32 s15, s4, s39
    s_add_u32 s4, s38, 8
    v_mfma_f32_32x32x16_bf16 v[176:191], v[36:39], v[48:51], v[176:191]
    s_and_b32 s4, s4, 15
    s_lshl_b32 s4, s4, 12
    s_waitcnt lgkmcnt(0)
    v_mfma_f32_32x32x16_bf16 v[96:111], v[52:55], v[60:63], v[96:111]
    s_barrier
    ds_read_b128 v[32:35], v4 offset:32768
    ds_read_b64_tr_b16 v[40:41], v12 offset:0
    ds_read_b64_tr_b16 v[42:43], v12 offset:1536
    s_add_u32 s28, s4, s39
    s_add_u32 s4, s38, 9
    v_mfma_f32_32x32x16_bf16 v[112:127], v[56:59], v[60:63], v[112:127]
    ds_read_b128 v[36:39], v4 offset:36864
    ds_read_b64_tr_b16 v[44:45], v13 offset:0
    ds_read_b64_tr_b16 v[46:47], v13 offset:1536
    s_and_b32 s4, s4, 15
    s_lshl_b32 s4, s4, 12
    v_mfma_f32_32x32x16_bf16 v[128:143], v[52:55], v[64:67], v[128:143]
    ds_read_b64_tr_b16 v[48:49], v14 offset:0
    ds_read_b64_tr_b16 v[50:51], v14 offset:1536
    s_add_u32 s29, s4, s39
    s_add_u32 s4, s38, 10
    v_mfma_f32_32x32x16_bf16 v[144:159], v[56:59], v[64:67], v[144:159]
    s_and_b32 s4, s4, 15
    s_lshl_b32 s4, s4, 12
    v_mfma_f32_32x32x16_bf16 v[160:175], v[52:55], v[68:71], v[160:175]
    s_add_u32 s30, s4, s39
    s_add_u32 s4, s38, 11
    v_mfma_f32_32x32x16_bf16 v[176:191], v[56:59], v[68:71], v[176:191]
    s_and_b32 s4, s4, 15
    s_lshl_b32 s4, s4, 12
    s_waitcnt lgkmcnt(0)
    v_mfma_f32_32x32x16_bf16 v[96:111], v[32:35], v[40:43], v[96:111]
    ds_read_b128 v[52:55], v5 offset:32768
    ds_read_b64_tr_b16 v[60:61], v12 offset:6144
    ds_read_b64_tr_b16 v[62:63], v12 offset:7680
    s_add_u32 s31, s4, s39
    s_add_u32 s4, s38, 12
    v_mfma_f32_32x32x16_bf16 v[112:127], v[36:39], v[40:43], v[112:127]
    ds_read_b128 v[56:59], v5 offset:36864
    ds_read_b64_tr_b16 v[64:65], v13 offset:6144
    ds_read_b64_tr_b16 v[66:67], v13 offset:7680
    s_and_b32 s4, s4, 15
    s_lshl_b32 s4, s4, 12
    v_mfma_f32_32x32x16_bf16 v[128:143], v[32:35], v[44:47], v[128:143]
    ds_read_b64_tr_b16 v[68:69], v14 offset:6144
    ds_read_b64_tr_b16 v[70:71], v14 offset:7680
    s_add_u32 s64, s4, s39
    s_add_u32 s4, s38, 13
    v_mfma_f32_32x32x16_bf16 v[144:159], v[36:39], v[44:47], v[144:159]
    s_and_b32 s4, s4, 15
    s_lshl_b32 s4, s4, 12
    v_mfma_f32_32x32x16_bf16 v[160:175], v[32:35], v[48:51], v[160:175]
    s_add_u32 s65, s4, s39
    s_add_u32 s4, s38, 14
    v_mfma_f32_32x32x16_bf16 v[176:191], v[36:39], v[48:51], v[176:191]
    s_and_b32 s4, s4, 15
    s_lshl_b32 s4, s4, 12
    s_waitcnt lgkmcnt(0)
    v_mfma_f32_32x32x16_bf16 v[96:111], v[52:55], v[60:63], v[96:111]
    s_barrier
    ds_read_b128 v[32:35], v6 offset:32768
    ds_read_b64_tr_b16 v[40:41], v12 offset:12288
    ds_read_b64_tr_b16 v[42:43], v12 offset:13824
    s_add_u32 s66, s4, s39
    s_add_u32 s4, s38, 15
    v_mfma_f32_32x32x16_bf16 v[112:127], v[56:59], v[60:63], v[112:127]
    ds_read_b128 v[36:39], v6 offset:36864
    ds_read_b64_tr_b16 v[44:45], v13 offset:12288
    ds_read_b64_tr_b16 v[46:47], v13 offset:13824
    s_and_b32 s4, s4, 15
    s_lshl_b32 s4, s4, 12
    v_mfma_f32_32x32x16_bf16 v[128:143], v[52:55], v[64:67], v[128:143]
    v_mov_b32 v31, 0
    buffer_load_dword v30, v31, s[68:71], 0 offen sc1
    ds_read_b64_tr_b16 v[48:49], v14 offset:12288
    ds_read_b64_tr_b16 v[50:51], v14 offset:13824
    s_add_u32 s67, s4, s39
    s_add_u32 s4, s3, 1
    v_mfma_f32_32x32x16_bf16 v[144:159], v[56:59], v[64:67], v[144:159]
    s_and_b32 s4, s4, 3
    s_lshl_b32 s4, s4, 11
    v_mfma_f32_32x32x16_bf16 v[160:175], v[52:55], v[68:71], v[160:175]
    v_add_u32 v20, s4, v2
    s_add_u32 s4, s3, 2
    v_mfma_f32_32x32x16_bf16 v[176:191], v[56:59], v[68:71], v[176:191]
    s_and_b32 s4, s4, 3
    s_lshl_b32 s4, s4, 11
    s_waitcnt lgkmcnt(0)
    v_mfma_f32_32x32x16_bf16 v[96:111], v[32:35], v[40:43], v[96:111]
    ds_read_b128 v[52:55], v7 offset:32768
    ds_read_b64_tr_b16 v[60:61], v12 offset:18432
    ds_read_b64_tr_b16 v[62:63], v12 offset:19968
    v_add_u32 v21, s4, v2
    s_add_u32 s4, s3, 3
    v_mfma_f32_32x32x16_bf16 v[112:127], v[36:39], v[40:43], v[112:127]
    ds_read_b128 v[56:59], v7 offset:36864
    ds_read_b64_tr_b16 v[64:65], v13 offset:18432
    ds_read_b64_tr_b16 v[66:67], v13 offset:19968
    s_and_b32 s4, s4, 3
    s_lshl_b32 s4, s4, 11
    v_mfma_f32_32x32x16_bf16 v[128:143], v[32:35], v[44:47], v[128:143]
    s_lshl_b32 s44, s2, 2
    s_add_u32 s44, s44, s3
    s_mul_i32 s45, s44, 1600
    v_min_u32 v29, 24, v1
    v_lshlrev_b32 v29, 6, v29
    buffer_load_dword v95, v29, s[56:59], s45 offen
    s_mul_i32 s45, s44, 448
    v_min_u32 v29, 384, v29
    buffer_load_dword v95, v29, s[60:63], s45 offen
    ds_read_b64_tr_b16 v[68:69], v14 offset:18432
    ds_read_b64_tr_b16 v[70:71], v14 offset:19968
    v_add_u32 v22, s4, v2
    s_add_u32 s4, s3, 4
    v_mfma_f32_32x32x16_bf16 v[144:159], v[36:39], v[44:47], v[144:159]
    s_and_b32 s4, s4, 3
    s_lshl_b32 s4, s4, 11
    v_mfma_f32_32x32x16_bf16 v[160:175], v[32:35], v[48:51], v[160:175]
    v_add_u32 v23, s4, v2
    s_lshl_b32 s5, s38, 2
    v_mfma_f32_32x32x16_bf16 v[176:191], v[36:39], v[48:51], v[176:191]
    s_add_u32 s5, s5, s3
    s_lshl_b32 s5, s5, 4
    s_waitcnt lgkmcnt(0)
    v_mfma_f32_32x32x16_bf16 v[96:111], v[52:55], v[60:63], v[96:111]
    s_barrier
    ds_read_b128 v[32:35], v4 offset:49152
    ds_read_b64_tr_b16 v[40:41], v12 offset:24576
    ds_read_b64_tr_b16 v[42:43], v12 offset:26112
    s_add_u32 s5, s5, s37
    s_lshl_b32 s96, s5, 11
    v_mfma_f32_32x32x16_bf16 v[112:127], v[56:59], v[60:63], v[112:127]
    ds_read_b128 v[36:39], v4 offset:53248
    ds_read_b64_tr_b16 v[44:45], v13 offset:24576
    ds_read_b64_tr_b16 v[46:47], v13 offset:26112
    s_add_u32 s96, s96, 14680064
    s_mov_b32 s100, s96
    v_mfma_f32_32x32x16_bf16 v[128:143], v[52:55], v[64:67], v[128:143]
    ds_read_b64_tr_b16 v[48:49], v14 offset:24576
    ds_read_b64_tr_b16 v[50:51], v14 offset:26112
    s_lshl_b32 s97, s5, 7
    s_add_u32 s97, s97, 17367040
    v_mfma_f32_32x32x16_bf16 v[144:159], v[56:59], v[64:67], v[144:159]
    s_lshl_b32 s4, s32, 6
    s_lshl_b32 s5, s33, 2
    v_mfma_f32_32x32x16_bf16 v[160:175], v[52:55], v[68:71], v[160:175]
    s_add_u32 s4, s4, s5
    s_add_u32 s4, s4, s3
    v_mfma_f32_32x32x16_bf16 v[176:191], v[56:59], v[68:71], v[176:191]
    s_lshl_b32 s4, s4, 7
    s_add_u32 s98, s4, 17235968
    s_waitcnt lgkmcnt(0)
    v_mfma_f32_32x32x16_bf16 v[96:111], v[32:35], v[40:43], v[96:111]
    ds_read_b128 v[52:55], v5 offset:49152
    ds_read_b64_tr_b16 v[60:61], v12 offset:30720
    ds_read_b64_tr_b16 v[62:63], v12 offset:32256
    s_lshl_b32 s37, s32, 2
    s_lshl_b32 s38, s35, 1
    v_mfma_f32_32x32x16_bf16 v[112:127], v[36:39], v[40:43], v[112:127]
    ds_read_b128 v[56:59], v5 offset:53248
    ds_read_b64_tr_b16 v[64:65], v13 offset:30720
    ds_read_b64_tr_b16 v[66:67], v13 offset:32256
    s_add_u32 s37, s37, s38
    s_mul_i32 s39, s36, 3
    v_mfma_f32_32x32x16_bf16 v[128:143], v[32:35], v[44:47], v[128:143]
    ds_read_b64_tr_b16 v[68:69], v14 offset:30720
    ds_read_b64_tr_b16 v[70:71], v14 offset:32256
    s_add_u32 s39, s39, s34
    v_lshrrev_b32 v17, 4, v1
    v_mfma_f32_32x32x16_bf16 v[144:159], v[36:39], v[44:47], v[144:159]
    v_add_u32 v17, s39, v17
    v_and_b32 v18, 15, v17
    v_mfma_f32_32x32x16_bf16 v[160:175], v[32:35], v[48:51], v[160:175]
    v_lshrrev_b32 v17, 4, v17
    v_mul_u32_u24 v18, 3, v18
    v_mfma_f32_32x32x16_bf16 v[176:191], v[36:39], v[48:51], v[176:191]
    v_add_u32 v17, v17, v18
    v_lshlrev_b32 v17, 12, v17
    s_waitcnt lgkmcnt(0)
    v_mfma_f32_32x32x16_bf16 v[96:111], v[52:55], v[60:63], v[96:111]
    s_barrier
    ds_read_b128 v[32:35], v6 offset:49152
    ds_read_b64_tr_b16 v[40:41], v12 offset:36864
    ds_read_b64_tr_b16 v[42:43], v12 offset:38400
    v_and_b32 v18, 15, v1
    v_lshl_add_u32 v17, v18, 3, v17
    v_mfma_f32_32x32x16_bf16 v[112:127], v[56:59], v[60:63], v[112:127]
    ds_read_b128 v[36:39], v6 offset:53248
    ds_read_b64_tr_b16 v[44:45], v13 offset:36864
    ds_read_b64_tr_b16 v[46:47], v13 offset:38400
    s_lshl_b32 s48, s37, 6
    s_add_u32 s48, s48, 17039360
    v_mfma_f32_32x32x16_bf16 v[128:143], v[52:55], v[64:67], v[128:143]
    ds_read_b64_tr_b16 v[48:49], v14 offset:36864
    ds_read_b64_tr_b16 v[50:51], v14 offset:38400
    s_and_b32 s39, s39, 15
    s_lshl_b32 s39, s39, 6
    v_mfma_f32_32x32x16_bf16 v[144:159], v[56:59], v[64:67], v[144:159]
    s_add_u32 s39, s39, s37
    s_mov_b32 s50, 0
    v_mfma_f32_32x32x16_bf16 v[160:175], v[52:55], v[68:71], v[160:175]
    s_mov_b32 s51, -1
    s_mov_b32 s42, 12
    v_mfma_f32_32x32x16_bf16 v[176:191], v[56:59], v[68:71], v[176:191]
    s_mov_b32 s43, 2097152
    v_and_b32 v19, 31, v1
    s_waitcnt lgkmcnt(0)
    v_mfma_f32_32x32x16_bf16 v[96:111], v[32:35], v[40:43], v[96:111]
    ds_read_b128 v[52:55], v7 offset:49152
    ds_read_b64_tr_b16 v[60:61], v12 offset:43008
    ds_read_b64_tr_b16 v[62:63], v12 offset:44544
    v_mov_b32 v18, 0x3f803f80
    v_cmp_eq_u32 vcc, 28, v19
    v_mfma_f32_32x32x16_bf16 v[112:127], v[36:39], v[40:43], v[112:127]
    ds_read_b128 v[56:59], v7 offset:53248
    ds_read_b64_tr_b16 v[64:65], v13 offset:43008
    ds_read_b64_tr_b16 v[66:67], v13 offset:44544
    v_cmp_lt_u32 s[52:53], 27, v19
    s_nop 1
    v_mfma_f32_32x32x16_bf16 v[128:143], v[32:35], v[44:47], v[128:143]
    ds_read_b64_tr_b16 v[68:69], v14 offset:43008
    ds_read_b64_tr_b16 v[70:71], v14 offset:44544
    v_cndmask_b32 v18, 0, v18, vcc
    s_mul_i32 s40, s37, 112
    v_mfma_f32_32x32x16_bf16 v[144:159], v[36:39], v[44:47], v[144:159]
    s_lshl_b32 s41, s36, 1
    s_add_u32 s40, s40, s41
    v_mfma_f32_32x32x16_bf16 v[160:175], v[32:35], v[48:51], v[160:175]
    s_lshl_b32 s41, s73, 2
    s_add_u32 s54, s40, s41
    v_mfma_f32_32x32x16_bf16 v[176:191], v[36:39], v[48:51], v[176:191]
    s_lshl_b32 s54, s54, 10
    s_add_u32 s54, s54, 6291456
    s_waitcnt lgkmcnt(0)
    v_mfma_f32_32x32x16_bf16 v[96:111], v[52:55], v[60:63], v[96:111]
    s_barrier
    ds_read_b128 v[32:35], v8 offset:0
    ds_read_b64_tr_b16 v[40:41], v12 offset:0
    ds_read_b64_tr_b16 v[42:43], v12 offset:1536
    s_add_u32 s55, s54, 114688
    s_lshl_b32 s41, s72, 2
    v_mfma_f32_32x32x16_bf16 v[112:127], v[56:59], v[60:63], v[112:127]
    ds_read_b128 v[36:39], v8 offset:4096
    ds_read_b64_tr_b16 v[44:45], v13 offset:0
    ds_read_b64_tr_b16 v[46:47], v13 offset:1536
    s_add_u32 s40, s40, s41
    s_lshl_b32 s40, s40, 10
    v_mfma_f32_32x32x16_bf16 v[128:143], v[52:55], v[64:67], v[128:143]
    ds_read_b64_tr_b16 v[48:49], v14 offset:0
    ds_read_b64_tr_b16 v[50:51], v14 offset:1536
    s_add_u32 s40, s40, 6291456
    s_add_u32 s41, s40, 114688
    v_mfma_f32_32x32x16_bf16 v[144:159], v[56:59], v[64:67], v[144:159]
    v_mfma_f32_32x32x16_bf16 v[160:175], v[52:55], v[68:71], v[160:175]
    v_mfma_f32_32x32x16_bf16 v[176:191], v[56:59], v[68:71], v[176:191]
    s_waitcnt lgkmcnt(0)
    v_mfma_f32_32x32x16_bf16 v[96:111], v[32:35], v[40:43], v[96:111]
    ds_read_b128 v[52:55], v9 offset:0
    ds_read_b64_tr_b16 v[60:61], v12 offset:6144
    ds_read_b64_tr_b16 v[62:63], v12 offset:7680
    v_mfma_f32_32x32x16_bf16 v[112:127], v[36:39], v[40:43], v[112:127]
    ds_read_b128 v[56:59], v9 offset:4096
    ds_read_b64_tr_b16 v[64:65], v13 offset:6144
    ds_read_b64_tr_b16 v[66:67], v13 offset:7680
    v_mfma_f32_32x32x16_bf16 v[128:143], v[32:35], v[44:47], v[128:143]
    ds_read_b64_tr_b16 v[68:69], v14 offset:6144
    ds_read_b64_tr_b16 v[70:71], v14 offset:7680
    v_mfma_f32_32x32x16_bf16 v[144:159], v[36:39], v[44:47], v[144:159]
    v_mfma_f32_32x32x16_bf16 v[160:175], v[32:35], v[48:51], v[160:175]
    v_mfma_f32_32x32x16_bf16 v[176:191], v[36:39], v[48:51], v[176:191]
    s_waitcnt lgkmcnt(0)
    v_mfma_f32_32x32x16_bf16 v[96:111], v[52:55], v[60:63], v[96:111]
    s_barrier
    ds_read_b128 v[32:35], v10 offset:0
    ds_read_b64_tr_b16 v[40:41], v12 offset:12288
    ds_read_b64_tr_b16 v[42:43], v12 offset:13824
    v_mfma_f32_32x32x16_bf16 v[112:127], v[56:59], v[60:63], v[112:127]
    ds_read_b128 v[36:39], v10 offset:4096
    ds_read_b64_tr_b16 v[44:45], v13 offset:12288
    ds_read_b64_tr_b16 v[46:47], v13 offset:13824
    v_mfma_f32_32x32x16_bf16 v[128:143], v[52:55], v[64:67], v[128:143]
    ds_read_b64_tr_b16 v[48:49], v14 offset:12288
    ds_read_b64_tr_b16 v[50:51], v14 offset:13824
    v_mfma_f32_32x32x16_bf16 v[144:159], v[56:59], v[64:67], v[144:159]
    v_mfma_f32_32x32x16_bf16 v[160:175], v[52:55], v[68:71], v[160:175]
    v_mfma_f32_32x32x16_bf16 v[176:191], v[56:59], v[68:71], v[176:191]
    s_waitcnt lgkmcnt(0)
    v_mfma_f32_32x32x16_bf16 v[96:111], v[32:35], v[40:43], v[96:111]
    ds_read_b128 v[52:55], v11 offset:0
    ds_read_b64_tr_b16 v[60:61], v12 offset:18432
    ds_read_b64_tr_b16 v[62:63], v12 offset:19968
    v_mfma_f32_32x32x16_bf16 v[112:127], v[36:39], v[40:43], v[112:127]
    ds_read_b128 v[56:59], v11 offset:4096
    ds_read_b64_tr_b16 v[64:65], v13 offset:18432
    ds_read_b64_tr_b16 v[66:67], v13 offset:19968
    v_mfma_f32_32x32x16_bf16 v[128:143], v[32:35], v[44:47], v[128:143]
    s_bfe_u32 s44, s2, 0x30003
    s_lshl_b32 s44, s44, 1
    s_add_u32 s44, s44, s35
    s_mul_i32 s44, s44, 100352
    s_lshl_b32 s45, s73, 7
    s_add_u32 s44, s44, s45
    v_lshrrev_b32 v29, 1, v1
    v_min_u32 v29, 27, v29
    v_mul_u32_u24 v29, 3584, v29
    v_and_b32 v26, 1, v1
    v_lshl_add_u32 v29, v26, 6, v29
    s_cmp_eq_u32 s36, 0
    s_cbranch_scc1 CD_TG
    buffer_load_dword v29, v29, s[20:23], s44 offen
    s_branch CD_TD
CD_TG:
    buffer_load_dword v29, v29, s[16:19], s44 offen
CD_TD:
    ds_read_b64_tr_b16 v[68:69], v14 offset:18432
    ds_read_b64_tr_b16 v[70:71], v14 offset:19968
    v_mfma_f32_32x32x16_bf16 v[144:159], v[36:39], v[44:47], v[144:159]
    v_mfma_f32_32x32x16_bf16 v[160:175], v[32:35], v[48:51], v[160:175]
    v_mfma_f32_32x32x16_bf16 v[176:191], v[36:39], v[48:51], v[176:191]
    s_waitcnt lgkmcnt(0)
    v_mfma_f32_32x32x16_bf16 v[96:111], v[52:55], v[60:63], v[96:111]
    s_barrier
    ds_read_b128 v[32:35], v8 offset:16384
    ds_read_b64_tr_b16 v[40:41], v12 offset:24576
    ds_read_b64_tr_b16 v[42:43], v12 offset:26112
    v_mfma_f32_32x32x16_bf16 v[112:127], v[56:59], v[60:63], v[112:127]
    ds_read_b128 v[36:39], v8 offset:20480
    ds_read_b64_tr_b16 v[44:45], v13 offset:24576
    ds_read_b64_tr_b16 v[46:47], v13 offset:26112
    v_mfma_f32_32x32x16_bf16 v[128:143], v[52:55], v[64:67], v[128:143]
    ds_read_b64_tr_b16 v[48:49], v14 offset:24576
    ds_read_b64_tr_b16 v[50:51], v14 offset:26112
    v_mfma_f32_32x32x16_bf16 v[144:159], v[56:59], v[64:67], v[144:159]
    v_mfma_f32_32x32x16_bf16 v[160:175], v[52:55], v[68:71], v[160:175]
    v_mfma_f32_32x32x16_bf16 v[176:191], v[56:59], v[68:71], v[176:191]
    s_waitcnt lgkmcnt(0)
    v_mfma_f32_32x32x16_bf16 v[96:111], v[32:35], v[40:43], v[96:111]
    ds_read_b128 v[52:55], v9 offset:16384
    ds_read_b64_tr_b16 v[60:61], v12 offset:30720
    ds_read_b64_tr_b16 v[62:63], v12 offset:32256
    v_mfma_f32_32x32x16_bf16 v[112:127], v[36:39], v[40:43], v[112:127]
    ds_read_b128 v[56:59], v9 offset:20480
    ds_read_b64_tr_b16 v[64:65], v13 offset:30720
    ds_read_b64_tr_b16 v[66:67], v13 offset:32256
    v_mfma_f32_32x32x16_bf16 v[128:143], v[32:35], v[44:47], v[128:143]
    ds_read_b64_tr_b16 v[68:69], v14 offset:30720
    ds_read_b64_tr_b16 v[70:71], v14 offset:32256
    v_mfma_f32_32x32x16_bf16 v[144:159], v[36:39], v[44:47], v[144:159]
    v_mfma_f32_32x32x16_bf16 v[160:175], v[32:35], v[48:51], v[160:175]
    v_mfma_f32_32x32x16_bf16 v[176:191], v[36:39], v[48:51], v[176:191]
    s_waitcnt lgkmcnt(0)
    v_mfma_f32_32x32x16_bf16 v[96:111], v[52:55], v[60:63], v[96:111]
    s_barrier
    ds_read_b128 v[32:35], v10 offset:16384
    ds_read_b64_tr_b16 v[40:41], v12 offset:36864
    ds_read_b64_tr_b16 v[42:43], v12 offset:38400
    v_mfma_f32_32x32x16_bf16 v[112:127], v[56:59], v[60:63], v[112:127]
    ds_read_b128 v[36:39], v10 offset:20480
    ds_read_b64_tr_b16 v[44:45], v13 offset:36864
    ds_read_b64_tr_b16 v[46:47], v13 offset:38400
    v_mfma_f32_32x32x16_bf16 v[128:143], v[52:55], v[64:67], v[128:143]
    ds_read_b64_tr_b16 v[48:49], v14 offset:36864
    ds_read_b64_tr_b16 v[50:51], v14 offset:38400
    v_mfma_f32_32x32x16_bf16 v[144:159], v[56:59], v[64:67], v[144:159]
    v_mfma_f32_32x32x16_bf16 v[160:175], v[52:55], v[68:71], v[160:175]
    v_mfma_f32_32x32x16_bf16 v[176:191], v[56:59], v[68:71], v[176:191]
    s_waitcnt lgkmcnt(0)
    v_mfma_f32_32x32x16_bf16 v[96:111], v[32:35], v[40:43], v[96:111]
    ds_read_b128 v[52:55], v11 offset:16384
    ds_read_b64_tr_b16 v[60:61], v12 offset:43008
    ds_read_b64_tr_b16 v[62:63], v12 offset:44544
    v_mfma_f32_32x32x16_bf16 v[112:127], v[36:39], v[40:43], v[112:127]
    ds_read_b128 v[56:59], v11 offset:20480
    ds_read_b64_tr_b16 v[64:65], v13 offset:43008
    ds_read_b64_tr_b16 v[66:67], v13 offset:44544
    v_mfma_f32_32x32x16_bf16 v[128:143], v[32:35], v[44:47], v[128:143]
    ds_read_b64_tr_b16 v[68:69], v14 offset:43008
    ds_read_b64_tr_b16 v[70:71], v14 offset:44544
    v_mfma_f32_32x32x16_bf16 v[144:159], v[36:39], v[44:47], v[144:159]
    v_mfma_f32_32x32x16_bf16 v[160:175], v[32:35], v[48:51], v[160:175]
    v_mfma_f32_32x32x16_bf16 v[176:191], v[36:39], v[48:51], v[176:191]
    s_waitcnt lgkmcnt(0)
    v_mfma_f32_32x32x16_bf16 v[96:111], v[52:55], v[60:63], v[96:111]
    s_barrier
    ds_read_b128 v[32:35], v8 offset:32768
    ds_read_b64_tr_b16 v[40:41], v12 offset:0
    ds_read_b64_tr_b16 v[42:43], v12 offset:1536
    v_mfma_f32_32x32x16_bf16 v[112:127], v[56:59], v[60:63], v[112:127]
    ds_read_b128 v[36:39], v8 offset:36864
    ds_read_b64_tr_b16 v[44:45], v13 offset:0
    ds_read_b64_tr_b16 v[46:47], v13 offset:1536
    v_mfma_f32_32x32x16_bf16 v[128:143], v[52:55], v[64:67], v[128:143]
    ds_read_b64_tr_b16 v[48:49], v14 offset:0
    ds_read_b64_tr_b16 v[50:51], v14 offset:1536
    v_mfma_f32_32x32x16_bf16 v[144:159], v[56:59], v[64:67], v[144:159]
    v_mfma_f32_32x32x16_bf16 v[160:175], v[52:55], v[68:71], v[160:175]
    v_mfma_f32_32x32x16_bf16 v[176:191], v[56:59], v[68:71], v[176:191]
    s_waitcnt lgkmcnt(0)
    v_mfma_f32_32x32x16_bf16 v[96:111], v[32:35], v[40:43], v[96:111]
    ds_read_b128 v[52:55], v9 offset:32768
    ds_read_b64_tr_b16 v[60:61], v12 offset:6144
    ds_read_b64_tr_b16 v[62:63], v12 offset:7680
    v_mfma_f32_32x32x16_bf16 v[112:127], v[36:39], v[40:43], v[112:127]
    ds_read_b128 v[56:59], v9 offset:36864
    ds_read_b64_tr_b16 v[64:65], v13 offset:6144
    ds_read_b64_tr_b16 v[66:67], v13 offset:7680
    v_mfma_f32_32x32x16_bf16 v[128:143], v[32:35], v[44:47], v[128:143]
    ds_read_b64_tr_b16 v[68:69], v14 offset:6144
    ds_read_b64_tr_b16 v[70:71], v14 offset:7680
    v_mfma_f32_32x32x16_bf16 v[144:159], v[36:39], v[44:47], v[144:159]
    v_mfma_f32_32x32x16_bf16 v[160:175], v[32:35], v[48:51], v[160:175]
    v_mfma_f32_32x32x16_bf16 v[176:191], v[36:39], v[48:51], v[176:191]
    s_waitcnt lgkmcnt(0)
    v_mfma_f32_32x32x16_bf16 v[96:111], v[52:55], v[60:63], v[96:111]
    s_barrier
    ds_read_b128 v[32:35], v10 offset:32768
    ds_read_b64_tr_b16 v[40:41], v12 offset:12288
    ds_read_b64_tr_b16 v[42:43], v12 offset:13824
    v_mfma_f32_32x32x16_bf16 v[112:127], v[56:59], v[60:63], v[112:127]
    ds_read_b128 v[36:39], v10 offset:36864
    ds_read_b64_tr_b16 v[44:45], v13 offset:12288
    ds_read_b64_tr_b16 v[46:47], v13 offset:13824
    v_mfma_f32_32x32x16_bf16 v[128:143], v[52:55], v[64:67], v[128:143]
    ds_read_b64_tr_b16 v[48:49], v14 offset:12288
    ds_read_b64_tr_b16 v[50:51], v14 offset:13824
    v_mfma_f32_32x32x16_bf16 v[144:159], v[56:59], v[64:67], v[144:159]
    v_mfma_f32_32x32x16_bf16 v[160:175], v[52:55], v[68:71], v[160:175]
    s_waitcnt vmcnt(0)
    s_mov_b32 s47, 1048576
CD_NONCE:
    v_readfirstlane_b32 s74, v30
    s_nop 0
    s_cmp_lg_u32 s74, 0
    s_cbranch_scc1 CD_NONCE_OK
    s_sleep 2
    buffer_load_dword v30, v31, s[68:71], 0 offen sc1
    s_waitcnt vmcnt(0)
    s_sub_u32 s47, s47, 1
    s_cmp_lg_u32 s47, 0
    s_cbranch_scc1 CD_NONCE
CD_NONCE_OK:
    v_mov_b32 v30, s74
    v_mov_b32 v31, s74
    s_mov_b32 s49, 0
    v_mfma_f32_32x32x16_bf16 v[176:191], v[56:59], v[68:71], v[176:191]
    s_waitcnt lgkmcnt(0)
    v_mfma_f32_32x32x16_bf16 v[96:111], v[32:35], v[40:43], v[96:111]
    ds_read_b128 v[52:55], v11 offset:32768
    ds_read_b64_tr_b16 v[60:61], v12 offset:18432
    ds_read_b64_tr_b16 v[62:63], v12 offset:19968
    v_mfma_f32_32x32x16_bf16 v[112:127], v[36:39], v[40:43], v[112:127]
    ds_read_b128 v[56:59], v11 offset:36864
    ds_read_b64_tr_b16 v[64:65], v13 offset:18432
    ds_read_b64_tr_b16 v[66:67], v13 offset:19968
    v_mfma_f32_32x32x16_bf16 v[128:143], v[32:35], v[44:47], v[128:143]
    ds_read_b64_tr_b16 v[68:69], v14 offset:18432
    ds_read_b64_tr_b16 v[70:71], v14 offset:19968
    v_mfma_f32_32x32x16_bf16 v[144:159], v[36:39], v[44:47], v[144:159]
    v_mfma_f32_32x32x16_bf16 v[160:175], v[32:35], v[48:51], v[160:175]
    v_mfma_f32_32x32x16_bf16 v[176:191], v[36:39], v[48:51], v[176:191]
    s_waitcnt lgkmcnt(0)
    v_mfma_f32_32x32x16_bf16 v[96:111], v[52:55], v[60:63], v[96:111]
    s_barrier
    ds_read_b128 v[32:35], v4 offset:0
    ds_read_b64_tr_b16 v[40:41], v15 offset:24576
    ds_read_b64_tr_b16 v[42:43], v15 offset:25088
    v_mfma_f32_32x32x16_bf16 v[112:127], v[56:59], v[60:63], v[112:127]
    ds_read_b128 v[36:39], v4 offset:4096
    ds_read_b64_tr_b16 v[44:45], v16 offset:24576
    ds_read_b64_tr_b16 v[46:47], v16 offset:25088
    v_mfma_f32_32x32x16_bf16 v[128:143], v[52:55], v[64:67], v[128:143]
    v_mfma_f32_32x32x16_bf16 v[144:159], v[56:59], v[64:67], v[144:159]
    v_mfma_f32_32x32x16_bf16 v[160:175], v[52:55], v[68:71], v[160:175]
    v_mfma_f32_32x32x16_bf16 v[176:191], v[56:59], v[68:71], v[176:191]
    s_waitcnt lgkmcnt(0)
    v_mfma_f32_32x32x16_bf16 v[192:207], v[40:43], v[32:35], 0
    s_barrier
    ds_read_b128 v[48:51], v5 offset:0
    ds_read_b64_tr_b16 v[56:57], v15 offset:26624
    ds_read_b64_tr_b16 v[58:59], v15 offset:27136
    ds_read_b128 v[52:55], v5 offset:4096
    s_add_u32 s44, s39, 0
    s_lshl_b32 s44, s44, s42
    s_add_u32 s44, s44, s43
    v_cvt_pk_bf16_f32 v80, v96, v97
    v_cvt_pk_bf16_f32 v81, v98, v99
    v_cvt_pk_bf16_f32 v82, v100, v101
    v_cvt_pk_bf16_f32 v83, v102, v103
    v_cndmask_b32 v80, v80, v18, s[52:53]
    v_cndmask_b32 v81, v81, v18, s[52:53]
    v_cndmask_b32 v82, v82, v18, s[52:53]
    v_cndmask_b32 v83, v83, v18, s[52:53]
    buffer_store_dwordx4 v[80:83], v2, s[24:27], s44 offen offset:2048 sc1
    v_cvt_pk_bf16_f32 v84, v104, v105
    v_cvt_pk_bf16_f32 v85, v106, v107
    v_cvt_pk_bf16_f32 v86, v108, v109
    v_cvt_pk_bf16_f32 v87, v110, v111
    v_cndmask_b32 v84, v84, v18, s[52:53]
    v_cndmask_b32 v85, v85, v18, s[52:53]
    v_cndmask_b32 v86, v86, v18, s[52:53]
    v_cndmask_b32 v87, v87, v18, s[52:53]
    buffer_store_dwordx4 v[84:87], v2, s[24:27], s44 offen offset:3072 sc1
    s_add_u32 s44, s39, 1
    s_lshl_b32 s44, s44, s42
    s_add_u32 s44, s44, s43
    v_cvt_pk_bf16_f32 v88, v112, v113
    v_cvt_pk_bf16_f32 v89, v114, v115
    v_cvt_pk_bf16_f32 v90, v116, v117
    v_cvt_pk_bf16_f32 v91, v118, v119
    v_cndmask_b32 v88, v88, v18, s[52:53]
    v_cndmask_b32 v89, v89, v18, s[52:53]
    v_cndmask_b32 v90, v90, v18, s[52:53]
    v_cndmask_b32 v91, v91, v18, s[52:53]
    buffer_store_dwordx4 v[88:91], v2, s[24:27], s44 offen offset:2048 sc1
    v_cvt_pk_bf16_f32 v92, v120, v121
    v_cvt_pk_bf16_f32 v93, v122, v123
    v_cvt_pk_bf16_f32 v94, v124, v125
    v_cvt_pk_bf16_f32 v95, v126, v127
    v_cndmask_b32 v92, v92, v18, s[52:53]
    v_cndmask_b32 v93, v93, v18, s[52:53]
    v_cndmask_b32 v94, v94, v18, s[52:53]
    v_cndmask_b32 v95, v95, v18, s[52:53]
    buffer_store_dwordx4 v[92:95], v2, s[24:27], s44 offen offset:3072 sc1
    s_add_u32 s44, s39, 64
    s_lshl_b32 s44, s44, s42
    s_add_u32 s44, s44, s43
    v_cvt_pk_bf16_f32 v80, v128, v129
    v_cvt_pk_bf16_f32 v81, v130, v131
    v_cvt_pk_bf16_f32 v82, v132, v133
    v_cvt_pk_bf16_f32 v83, v134, v135
    v_cndmask_b32 v80, v80, v18, s[52:53]
    v_cndmask_b32 v81, v81, v18, s[52:53]
    v_cndmask_b32 v82, v82, v18, s[52:53]
    v_cndmask_b32 v83, v83, v18, s[52:53]
    buffer_store_dwordx4 v[80:83], v2, s[24:27], s44 offen offset:2048 sc1
    v_cvt_pk_bf16_f32 v84, v136, v137
    v_cvt_pk_bf16_f32 v85, v138, v139
    v_cvt_pk_bf16_f32 v86, v140, v141
    v_cvt_pk_bf16_f32 v87, v142, v143
    v_cndmask_b32 v84, v84, v18, s[52:53]
    v_cndmask_b32 v85, v85, v18, s[52:53]
    v_cndmask_b32 v86, v86, v18, s[52:53]
    v_cndmask_b32 v87, v87, v18, s[52:53]
    buffer_store_dwordx4 v[84:87], v2, s[24:27], s44 offen offset:3072 sc1
    s_add_u32 s44, s39, 65
    s_lshl_b32 s44, s44, s42
    s_add_u32 s44, s44, s43
    v_cvt_pk_bf16_f32 v88, v144, v145
    v_cvt_pk_bf16_f32 v89, v146, v147
    v_mfma_f32_32x32x16_bf16 v[208:223], v[40:43], v[36:39], 0
    ds_read_b64_tr_b16 v[60:61], v16 offset:26624
    ds_read_b64_tr_b16 v[62:63], v16 offset:27136
    ds_read_b128 v[64:67], v6 offset:0
    ds_read_b64_tr_b16 v[72:73], v15 offset:32768
    v_cvt_pk_bf16_f32 v90, v148, v149
    v_cvt_pk_bf16_f32 v91, v150, v151
    v_cndmask_b32 v88, v88, v18, s[52:53]
    v_cndmask_b32 v89, v89, v18, s[52:53]
    v_cndmask_b32 v90, v90, v18, s[52:53]
    v_cndmask_b32 v91, v91, v18, s[52:53]
    buffer_store_dwordx4 v[88:91], v2, s[24:27], s44 offen offset:2048 sc1
    v_cvt_pk_bf16_f32 v92, v152, v153
    v_cvt_pk_bf16_f32 v93, v154, v155
    v_cvt_pk_bf16_f32 v94, v156, v157
    v_cvt_pk_bf16_f32 v95, v158, v159
    v_cndmask_b32 v92, v92, v18, s[52:53]
    v_cndmask_b32 v93, v93, v18, s[52:53]
    v_cndmask_b32 v94, v94, v18, s[52:53]
    v_cndmask_b32 v95, v95, v18, s[52:53]
    buffer_store_dwordx4 v[92:95], v2, s[24:27], s44 offen offset:3072 sc1
    s_add_u32 s44, s39, 128
    s_lshl_b32 s44, s44, s42
    s_add_u32 s44, s44, s43
    v_cvt_pk_bf16_f32 v80, v160, v161
    v_cvt_pk_bf16_f32 v81, v162, v163
    v_cvt_pk_bf16_f32 v82, v164, v165
    v_cvt_pk_bf16_f32 v83, v166, v167
    v_cndmask_b32 v80, v80, v18, s[52:53]
    v_cndmask_b32 v81, v81, v18, s[52:53]
    v_cndmask_b32 v82, v82, v18, s[52:53]
    v_cndmask_b32 v83, v83, v18, s[52:53]
    buffer_store_dwordx4 v[80:83], v2, s[24:27], s44 offen offset:2048 sc1
    v_cvt_pk_bf16_f32 v84, v168, v169
    v_cvt_pk_bf16_f32 v85, v170, v171
    v_cvt_pk_bf16_f32 v86, v172, v173
    v_cvt_pk_bf16_f32 v87, v174, v175
    v_cndmask_b32 v84, v84, v18, s[52:53]
    v_cndmask_b32 v85, v85, v18, s[52:53]
    v_cndmask_b32 v86, v86, v18, s[52:53]
    v_cndmask_b32 v87, v87, v18, s[52:53]
    buffer_store_dwordx4 v[84:87], v2, s[24:27], s44 offen offset:3072 sc1
    s_add_u32 s44, s39, 129
    s_lshl_b32 s44, s44, s42
    s_add_u32 s44, s44, s43
    v_cvt_pk_bf16_f32 v88, v176, v177
    v_cvt_pk_bf16_f32 v89, v178, v179
    v_cvt_pk_bf16_f32 v90, v180, v181
    v_cvt_pk_bf16_f32 v91, v182, v183
    v_cndmask_b32 v88, v88, v18, s[52:53]
    v_cndmask_b32 v89, v89, v18, s[52:53]
    v_cndmask_b32 v90, v90, v18, s[52:53]
    v_cndmask_b32 v91, v91, v18, s[52:53]
    buffer_store_dwordx4 v[88:91], v2, s[24:27], s44 offen offset:2048 sc1
    v_cvt_pk_bf16_f32 v92, v184, v185
    v_cvt_pk_bf16_f32 v93, v186, v187
    v_cvt_pk_bf16_f32 v94, v188, v189
    v_cvt_pk_bf16_f32 v95, v190, v191
    v_cndmask_b32 v92, v92, v18, s[52:53]
    v_cndmask_b32 v93, v93, v18, s[52:53]
    v_cndmask_b32 v94, v94, v18, s[52:53]
    v_cndmask_b32 v95, v95, v18, s[52:53]
    buffer_store_dwordx4 v[92:95], v2, s[24:27], s44 offen offset:3072 sc1
    v_mfma_f32_32x32x16_bf16 v[224:239], v[44:47], v[32:35], 0
    ds_read_b64_tr_b16 v[74:75], v15 offset:33280
    ds_read_b128 v[68:71], v6 offset:4096
    ds_read_b64_tr_b16 v[76:77], v16 offset:32768
    ds_read_b64_tr_b16 v[78:79], v16 offset:33280
    v_mfma_f32_32x32x16_bf16 v[240:255], v[44:47], v[36:39], 0
    s_waitcnt lgkmcnt(6)
    v_mfma_f32_32x32x16_bf16 v[192:207], v[56:59], v[48:51], v[192:207]
    ds_read_b128 v[32:35], v7 offset:0
    ds_read_b64_tr_b16 v[40:41], v15 offset:34816
    ds_read_b64_tr_b16 v[42:43], v15 offset:35328
    v_mfma_f32_32x32x16_bf16 v[208:223], v[56:59], v[52:55], v[208:223]
    ds_read_b128 v[36:39], v7 offset:4096
    ds_read_b64_tr_b16 v[44:45], v16 offset:34816
    ds_read_b64_tr_b16 v[46:47], v16 offset:35328
    v_mfma_f32_32x32x16_bf16 v[224:239], v[60:63], v[48:51], v[224:239]
    v_mfma_f32_32x32x16_bf16 v[240:255], v[60:63], v[52:55], v[240:255]
    s_waitcnt lgkmcnt(6)
    v_mfma_f32_32x32x16_bf16 v[192:207], v[72:75], v[64:67], v[192:207]
    s_barrier
    ds_read_b128 v[48:51], v4 offset:16384
    ds_read_b64_tr_b16 v[56:57], v15 offset:40960
    ds_read_b64_tr_b16 v[58:59], v15 offset:41472
    v_mfma_f32_32x32x16_bf16 v[208:223], v[72:75], v[68:71], v[208:223]
    ds_read_b128 v[52:55], v4 offset:20480
    ds_read_b64_tr_b16 v[60:61], v16 offset:40960
    ds_read_b64_tr_b16 v[62:63], v16 offset:41472
    s_getreg_b32 s45, hwreg(HW_REG_IB_STS, 0, 4)
    v_mfma_f32_32x32x16_bf16 v[224:239], v[76:79], v[64:67], v[224:239]
    s_or_b32 s45, s45, s49
    v_mfma_f32_32x32x16_bf16 v[240:255], v[76:79], v[68:71], v[240:255]
    s_cbranch_scc0 CD_PUB30
CD_PUBR30:
    s_waitcnt lgkmcnt(6)
    v_mfma_f32_32x32x16_bf16 v[192:207], v[40:43], v[32:35], v[192:207]
    ds_read_b128 v[64:67], v5 offset:16384
    ds_read_b64_tr_b16 v[72:73], v15 offset:43008
    ds_read_b64_tr_b16 v[74:75], v15 offset:43520
    v_mfma_f32_32x32x16_bf16 v[208:223], v[40:43], v[36:39], v[208:223]
    ds_read_b128 v[68:71], v5 offset:20480
    ds_read_b64_tr_b16 v[76:77], v16 offset:43008
    ds_read_b64_tr_b16 v[78:79], v16 offset:43520
    s_getreg_b32 s45, hwreg(HW_REG_IB_STS, 0, 4)
    v_mfma_f32_32x32x16_bf16 v[224:239], v[44:47], v[32:35], v[224:239]
    s_or_b32 s45, s45, s49
    v_mfma_f32_32x32x16_bf16 v[240:255], v[44:47], v[36:39], v[240:255]
    s_cbranch_scc0 CD_PUB31
CD_PUBR31:
    s_waitcnt lgkmcnt(6)
    v_mfma_f32_32x32x16_bf16 v[192:207], v[56:59], v[48:51], v[192:207]
    s_barrier
    ds_read_b128 v[32:35], v6 offset:16384
    ds_read_b64_tr_b16 v[40:41], v15 offset:0
    ds_read_b64_tr_b16 v[42:43], v15 offset:512
    v_mfma_f32_32x32x16_bf16 v[208:223], v[56:59], v[52:55], v[208:223]
    ds_read_b128 v[36:39], v6 offset:20480
    ds_read_b64_tr_b16 v[44:45], v16 offset:0
    ds_read_b64_tr_b16 v[46:47], v16 offset:512
    s_getreg_b32 s45, hwreg(HW_REG_IB_STS, 0, 4)
    v_mfma_f32_32x32x16_bf16 v[224:239], v[60:63], v[48:51], v[224:239]
    s_or_b32 s45, s45, s49
    v_mfma_f32_32x32x16_bf16 v[240:255], v[60:63], v[52:55], v[240:255]
    s_cbranch_scc0 CD_PUB32
CD_PUBR32:
    s_waitcnt lgkmcnt(6)
    v_mfma_f32_32x32x16_bf16 v[192:207], v[72:75], v[64:67], v[192:207]
    ds_read_b128 v[48:51], v7 offset:16384
    ds_read_b64_tr_b16 v[56:57], v15 offset:2048
    ds_read_b64_tr_b16 v[58:59], v15 offset:2560
    v_mfma_f32_32x32x16_bf16 v[208:223], v[72:75], v[68:71], v[208:223]
    ds_read_b128 v[52:55], v7 offset:20480
    ds_read_b64_tr_b16 v[60:61], v16 offset:2048
    ds_read_b64_tr_b16 v[62:63], v16 offset:2560
    s_getreg_b32 s45, hwreg(HW_REG_IB_STS, 0, 4)
    v_mfma_f32_32x32x16_bf16 v[224:239], v[76:79], v[64:67], v[224:239]
    s_or_b32 s45, s45, s49
    v_mfma_f32_32x32x16_bf16 v[240:255], v[76:79], v[68:71], v[240:255]
    s_cbranch_scc0 CD_PUB33
CD_PUBR33:
    s_waitcnt lgkmcnt(6)
    v_mfma_f32_32x32x16_bf16 v[192:207], v[40:43], v[32:35], v[192:207]
    s_barrier
    ds_read_b128 v[64:67], v4 offset:32768
    ds_read_b64_tr_b16 v[72:73], v15 offset:8192
    ds_read_b64_tr_b16 v[74:75], v15 offset:8704
    v_mfma_f32_32x32x16_bf16 v[208:223], v[40:43], v[36:39], v[208:223]
    ds_read_b128 v[68:71], v4 offset:36864
    ds_read_b64_tr_b16 v[76:77], v16 offset:8192
    ds_read_b64_tr_b16 v[78:79], v16 offset:8704
    s_getreg_b32 s45, hwreg(HW_REG_IB_STS, 0, 4)
    v_mfma_f32_32x32x16_bf16 v[224:239], v[44:47], v[32:35], v[224:239]
    s_or_b32 s45, s45, s49
    v_mfma_f32_32x32x16_bf16 v[240:255], v[44:47], v[36:39], v[240:255]
    s_cbranch_scc0 CD_PUB34
CD_PUBR34:
    s_waitcnt lgkmcnt(6)
    v_mfma_f32_32x32x16_bf16 v[192:207], v[56:59], v[48:51], v[192:207]
    ds_read_b128 v[32:35], v5 offset:32768
    ds_read_b64_tr_b16 v[40:41], v15 offset:10240
    ds_read_b64_tr_b16 v[42:43], v15 offset:10752
    v_mfma_f32_32x32x16_bf16 v[208:223], v[56:59], v[52:55], v[208:223]
    ds_read_b128 v[36:39], v5 offset:36864
    ds_read_b64_tr_b16 v[44:45], v16 offset:10240
    ds_read_b64_tr_b16 v[46:47], v16 offset:10752
    s_getreg_b32 s45, hwreg(HW_REG_IB_STS, 0, 4)
    v_mfma_f32_32x32x16_bf16 v[224:239], v[60:63], v[48:51], v[224:239]
    s_or_b32 s45, s45, s49
    v_mfma_f32_32x32x16_bf16 v[240:255], v[60:63], v[52:55], v[240:255]
    s_cbranch_scc0 CD_PUB35
CD_PUBR35:
    s_waitcnt lgkmcnt(6)
    v_mfma_f32_32x32x16_bf16 v[192:207], v[72:75], v[64:67], v[192:207]
    s_barrier
    ds_read_b128 v[48:51], v6 offset:32768
    ds_read_b64_tr_b16 v[56:57], v15 offset:16384
    ds_read_b64_tr_b16 v[58:59], v15 offset:16896
    v_mfma_f32_32x32x16_bf16 v[208:223], v[72:75], v[68:71], v[208:223]
    ds_read_b128 v[52:55], v6 offset:36864
    ds_read_b64_tr_b16 v[60:61], v16 offset:16384
    ds_read_b64_tr_b16 v[62:63], v16 offset:16896
    s_getreg_b32 s45, hwreg(HW_REG_IB_STS, 0, 4)
    v_mfma_f32_32x32x16_bf16 v[224:239], v[76:79], v[64:67], v[224:239]
    s_or_b32 s45, s45, s49
    v_mfma_f32_32x32x16_bf16 v[240:255], v[76:79], v[68:71], v[240:255]
    s_cbranch_scc0 CD_PUB36
CD_PUBR36:
    s_waitcnt lgkmcnt(6)
    v_mfma_f32_32x32x16_bf16 v[192:207], v[40:43], v[32:35], v[192:207]
    ds_read_b128 v[64:67], v7 offset:32768
    ds_read_b64_tr_b16 v[72:73], v15 offset:18432
    ds_read_b64_tr_b16 v[74:75], v15 offset:18944
    v_mfma_f32_32x32x16_bf16 v[208:223], v[40:43], v[36:39], v[208:223]
    ds_read_b128 v[68:71], v7 offset:36864
    ds_read_b64_tr_b16 v[76:77], v16 offset:18432
    ds_read_b64_tr_b16 v[78:79], v16 offset:18944
    s_getreg_b32 s45, hwreg(HW_REG_IB_STS, 0, 4)
    v_mfma_f32_32x32x16_bf16 v[224:239], v[44:47], v[32:35], v[224:239]
    s_or_b32 s45, s45, s49
    v_mfma_f32_32x32x16_bf16 v[240:255], v[44:47], v[36:39], v[240:255]
    s_cbranch_scc0 CD_PUB37
CD_PUBR37:
    s_waitcnt lgkmcnt(6)
    v_mfma_f32_32x32x16_bf16 v[192:207], v[56:59], v[48:51], v[192:207]
    s_barrier
    ds_read_b128 v[32:35], v4 offset:49152
    ds_read_b64_tr_b16 v[40:41], v15 offset:24576
    ds_read_b64_tr_b16 v[42:43], v15 offset:25088
    v_mfma_f32_32x32x16_bf16 v[208:223], v[56:59], v[52:55], v[208:223]
    ds_read_b128 v[36:39], v4 offset:53248
    ds_read_b64_tr_b16 v[44:45], v16 offset:24576
    ds_read_b64_tr_b16 v[46:47], v16 offset:25088
    s_getreg_b32 s45, hwreg(HW_REG_IB_STS, 0, 4)
    v_mfma_f32_32x32x16_bf16 v[224:239], v[60:63], v[48:51], v[224:239]
    s_or_b32 s45, s45, s49
    v_mfma_f32_32x32x16_bf16 v[240:255], v[60:63], v[52:55], v[240:255]
    s_cbranch_scc0 CD_PUB38
CD_PUBR38:
    s_waitcnt lgkmcnt(6)
    v_mfma_f32_32x32x16_bf16 v[192:207], v[72:75], v[64:67], v[192:207]
    ds_read_b128 v[48:51], v5 offset:49152
    ds_read_b64_tr_b16 v[56:57], v15 offset:26624
    ds_read_b64_tr_b16 v[58:59], v15 offset:27136
    v_mfma_f32_32x32x16_bf16 v[208:223], v[72:75], v[68:71], v[208:223]
    ds_read_b128 v[52:55], v5 offset:53248
    ds_read_b64_tr_b16 v[60:61], v16 offset:26624
    ds_read_b64_tr_b16 v[62:63], v16 offset:27136
    s_getreg_b32 s45, hwreg(HW_REG_IB_STS, 0, 4)
    v_mfma_f32_32x32x16_bf16 v[224:239], v[76:79], v[64:67], v[224:239]
    s_or_b32 s45, s45, s49
    v_mfma_f32_32x32x16_bf16 v[240:255], v[76:79], v[68:71], v[240:255]
    s_cbranch_scc0 CD_PUB39
CD_PUBR39:
    s_waitcnt lgkmcnt(6)
    v_mfma_f32_32x32x16_bf16 v[192:207], v[40:43], v[32:35], v[192:207]
    s_barrier
    ds_read_b128 v[64:67], v6 offset:49152
    ds_read_b64_tr_b16 v[72:73], v15 offset:32768
    ds_read_b64_tr_b16 v[74:75], v15 offset:33280
    v_mfma_f32_32x32x16_bf16 v[208:223], v[40:43], v[36:39], v[208:223]
    ds_read_b128 v[68:71], v6 offset:53248
    ds_read_b64_tr_b16 v[76:77], v16 offset:32768
    ds_read_b64_tr_b16 v[78:79], v16 offset:33280
    s_getreg_b32 s45, hwreg(HW_REG_IB_STS, 0, 4)
    v_mfma_f32_32x32x16_bf16 v[224:239], v[44:47], v[32:35], v[224:239]
    s_or_b32 s45, s45, s49
    v_mfma_f32_32x32x16_bf16 v[240:255], v[44:47], v[36:39], v[240:255]
    s_cbranch_scc0 CD_PUB40
CD_PUBR40:
    s_waitcnt lgkmcnt(6)
    v_mfma_f32_32x32x16_bf16 v[192:207], v[56:59], v[48:51], v[192:207]
    ds_read_b128 v[32:35], v7 offset:49152
    ds_read_b64_tr_b16 v[40:41], v15 offset:34816
    ds_read_b64_tr_b16 v[42:43], v15 offset:35328
    v_mfma_f32_32x32x16_bf16 v[208:223], v[56:59], v[52:55], v[208:223]
    ds_read_b128 v[36:39], v7 offset:53248
    ds_read_b64_tr_b16 v[44:45], v16 offset:34816
    ds_read_b64_tr_b16 v[46:47], v16 offset:35328
    s_getreg_b32 s45, hwreg(HW_REG_IB_STS, 0, 4)
    v_mfma_f32_32x32x16_bf16 v[224:239], v[60:63], v[48:51], v[224:239]
    s_or_b32 s45, s45, s49
    v_mfma_f32_32x32x16_bf16 v[240:255], v[60:63], v[52:55], v[240:255]
    s_cbranch_scc0 CD_PUB41
CD_PUBR41:
    s_waitcnt lgkmcnt(6)
    v_mfma_f32_32x32x16_bf16 v[192:207], v[72:75], v[64:67], v[192:207]
    s_barrier
    ds_read_b128 v[48:51], v8 offset:0
    ds_read_b64_tr_b16 v[56:57], v15 offset:40960
    ds_read_b64_tr_b16 v[58:59], v15 offset:41472
    v_mfma_f32_32x32x16_bf16 v[208:223], v[72:75], v[68:71], v[208:223]
    ds_read_b128 v[52:55], v8 offset:4096
    ds_read_b64_tr_b16 v[60:61], v16 offset:40960
    ds_read_b64_tr_b16 v[62:63], v16 offset:41472
    s_getreg_b32 s45, hwreg(HW_REG_IB_STS, 0, 4)
    v_mfma_f32_32x32x16_bf16 v[224:239], v[76:79], v[64:67], v[224:239]
    s_or_b32 s45, s45, s49
    v_mfma_f32_32x32x16_bf16 v[240:255], v[76:79], v[68:71], v[240:255]
    s_cbranch_scc0 CD_PUB42
CD_PUBR42:
    s_waitcnt lgkmcnt(6)
    v_mfma_f32_32x32x16_bf16 v[192:207], v[40:43], v[32:35], v[192:207]
    ds_read_b128 v[64:67], v9 offset:0
    ds_read_b64_tr_b16 v[72:73], v15 offset:43008
    ds_read_b64_tr_b16 v[74:75], v15 offset:43520
    v_mfma_f32_32x32x16_bf16 v[208:223], v[40:43], v[36:39], v[208:223]
    ds_read_b128 v[68:71], v9 offset:4096
    ds_read_b64_tr_b16 v[76:77], v16 offset:43008
    ds_read_b64_tr_b16 v[78:79], v16 offset:43520
    s_getreg_b32 s45, hwreg(HW_REG_IB_STS, 0, 4)
    v_mfma_f32_32x32x16_bf16 v[224:239], v[44:47], v[32:35], v[224:239]
    s_or_b32 s45, s45, s49
    v_mfma_f32_32x32x16_bf16 v[240:255], v[44:47], v[36:39], v[240:255]
    s_cbranch_scc0 CD_PUB43
CD_PUBR43:
    s_waitcnt lgkmcnt(6)
    v_mfma_f32_32x32x16_bf16 v[192:207], v[56:59], v[48:51], v[192:207]
    s_barrier
    ds_read_b128 v[32:35], v10 offset:0
    ds_read_b64_tr_b16 v[40:41], v15 offset:0
    ds_read_b64_tr_b16 v[42:43], v15 offset:512
    v_mfma_f32_32x32x16_bf16 v[208:223], v[56:59], v[52:55], v[208:223]
    ds_read_b128 v[36:39], v10 offset:4096
    ds_read_b64_tr_b16 v[44:45], v16 offset:0
    ds_read_b64_tr_b16 v[46:47], v16 offset:512
    s_getreg_b32 s45, hwreg(HW_REG_IB_STS, 0, 4)
    v_mfma_f32_32x32x16_bf16 v[224:239], v[60:63], v[48:51], v[224:239]
    s_or_b32 s45, s45, s49
    v_mfma_f32_32x32x16_bf16 v[240:255], v[60:63], v[52:55], v[240:255]
    s_cbranch_scc0 CD_PUB44
CD_PUBR44:
    s_waitcnt lgkmcnt(6)
    v_mfma_f32_32x32x16_bf16 v[192:207], v[72:75], v[64:67], v[192:207]
    ds_read_b128 v[48:51], v11 offset:0
    ds_read_b64_tr_b16 v[56:57], v15 offset:2048
    ds_read_b64_tr_b16 v[58:59], v15 offset:2560
    v_mfma_f32_32x32x16_bf16 v[208:223], v[72:75], v[68:71], v[208:223]
    ds_read_b128 v[52:55], v11 offset:4096
    ds_read_b64_tr_b16 v[60:61], v16 offset:2048
    ds_read_b64_tr_b16 v[62:63], v16 offset:2560
    s_getreg_b32 s45, hwreg(HW_REG_IB_STS, 0, 4)
    v_mfma_f32_32x32x16_bf16 v[224:239], v[76:79], v[64:67], v[224:239]
    s_or_b32 s45, s45, s49
    v_mfma_f32_32x32x16_bf16 v[240:255], v[76:79], v[68:71], v[240:255]
    s_cbranch_scc0 CD_PUB45
CD_PUBR45:
    s_waitcnt lgkmcnt(6)
    v_mfma_f32_32x32x16_bf16 v[192:207], v[40:43], v[32:35], v[192:207]
    s_barrier
    ds_read_b128 v[64:67], v8 offset:16384
    ds_read_b64_tr_b16 v[72:73], v15 offset:8192
    ds_read_b64_tr_b16 v[74:75], v15 offset:8704
    v_mfma_f32_32x32x16_bf16 v[208:223], v[40:43], v[36:39], v[208:223]
    ds_read_b128 v[68:71], v8 offset:20480
    ds_read_b64_tr_b16 v[76:77], v16 offset:8192
    ds_read_b64_tr_b16 v[78:79], v16 offset:8704
    s_getreg_b32 s45, hwreg(HW_REG_IB_STS, 0, 4)
    v_mfma_f32_32x32x16_bf16 v[224:239], v[44:47], v[32:35], v[224:239]
    s_or_b32 s45, s45, s49
    v_mfma_f32_32x32x16_bf16 v[240:255], v[44:47], v[36:39], v[240:255]
    s_cbranch_scc0 CD_PUB46
CD_PUBR46:
    s_waitcnt lgkmcnt(6)
    v_mfma_f32_32x32x16_bf16 v[192:207], v[56:59], v[48:51], v[192:207]
    ds_read_b128 v[32:35], v9 offset:16384
    ds_read_b64_tr_b16 v[40:41], v15 offset:10240
    ds_read_b64_tr_b16 v[42:43], v15 offset:10752
    v_mfma_f32_32x32x16_bf16 v[208:223], v[56:59], v[52:55], v[208:223]
    ds_read_b128 v[36:39], v9 offset:20480
    ds_read_b64_tr_b16 v[44:45], v16 offset:10240
    ds_read_b64_tr_b16 v[46:47], v16 offset:10752
    s_getreg_b32 s45, hwreg(HW_REG_IB_STS, 0, 4)
    v_mfma_f32_32x32x16_bf16 v[224:239], v[60:63], v[48:51], v[224:239]
    s_or_b32 s45, s45, s49
    v_mfma_f32_32x32x16_bf16 v[240:255], v[60:63], v[52:55], v[240:255]
    s_cbranch_scc0 CD_PUB47
CD_PUBR47:
    s_waitcnt lgkmcnt(6)
    v_mfma_f32_32x32x16_bf16 v[192:207], v[72:75], v[64:67], v[192:207]
    s_barrier
    ds_read_b128 v[48:51], v10 offset:16384
    ds_read_b64_tr_b16 v[56:57], v15 offset:16384
    ds_read_b64_tr_b16 v[58:59], v15 offset:16896
    v_mfma_f32_32x32x16_bf16 v[208:223], v[72:75], v[68:71], v[208:223]
    ds_read_b128 v[52:55], v10 offset:20480
    ds_read_b64_tr_b16 v[60:61], v16 offset:16384
    ds_read_b64_tr_b16 v[62:63], v16 offset:16896
    s_getreg_b32 s45, hwreg(HW_REG_IB_STS, 0, 4)
    v_mfma_f32_32x32x16_bf16 v[224:239], v[76:79], v[64:67], v[224:239]
    s_or_b32 s45, s45, s49
    v_mfma_f32_32x32x16_bf16 v[240:255], v[76:79], v[68:71], v[240:255]
    s_cbranch_scc0 CD_PUB48
CD_PUBR48:
    s_waitcnt lgkmcnt(6)
    v_mfma_f32_32x32x16_bf16 v[192:207], v[40:43], v[32:35], v[192:207]
    ds_read_b128 v[64:67], v11 offset:16384
    ds_read_b64_tr_b16 v[72:73], v15 offset:18432
    ds_read_b64_tr_b16 v[74:75], v15 offset:18944
    v_mfma_f32_32x32x16_bf16 v[208:223], v[40:43], v[36:39], v[208:223]
    ds_read_b128 v[68:71], v11 offset:20480
    ds_read_b64_tr_b16 v[76:77], v16 offset:18432
    ds_read_b64_tr_b16 v[78:79], v16 offset:18944
    s_getreg_b32 s45, hwreg(HW_REG_IB_STS, 0, 4)
    v_mfma_f32_32x32x16_bf16 v[224:239], v[44:47], v[32:35], v[224:239]
    s_or_b32 s45, s45, s49
    v_mfma_f32_32x32x16_bf16 v[240:255], v[44:47], v[36:39], v[240:255]
    s_cbranch_scc0 CD_PUB49
CD_PUBR49:
    s_waitcnt lgkmcnt(6)
    v_mfma_f32_32x32x16_bf16 v[192:207], v[56:59], v[48:51], v[192:207]
    s_barrier
    ds_read_b128 v[32:35], v8 offset:32768
    ds_read_b64_tr_b16 v[40:41], v15 offset:24576
    ds_read_b64_tr_b16 v[42:43], v15 offset:25088
    v_mfma_f32_32x32x16_bf16 v[208:223], v[56:59], v[52:55], v[208:223]
    ds_read_b128 v[36:39], v8 offset:36864
    ds_read_b64_tr_b16 v[44:45], v16 offset:24576
    ds_read_b64_tr_b16 v[46:47], v16 offset:25088
    s_getreg_b32 s45, hwreg(HW_REG_IB_STS, 0, 4)
    v_mfma_f32_32x32x16_bf16 v[224:239], v[60:63], v[48:51], v[224:239]
    s_or_b32 s45, s45, s49
    v_mfma_f32_32x32x16_bf16 v[240:255], v[60:63], v[52:55], v[240:255]
    s_cbranch_scc0 CD_PUB50
CD_PUBR50:
    s_waitcnt lgkmcnt(6)
    v_mfma_f32_32x32x16_bf16 v[192:207], v[72:75], v[64:67], v[192:207]
    ds_read_b128 v[48:51], v9 offset:32768
    ds_read_b64_tr_b16 v[56:57], v15 offset:26624
    ds_read_b64_tr_b16 v[58:59], v15 offset:27136
    v_mfma_f32_32x32x16_bf16 v[208:223], v[72:75], v[68:71], v[208:223]
    ds_read_b128 v[52:55], v9 offset:36864
    ds_read_b64_tr_b16 v[60:61], v16 offset:26624
    ds_read_b64_tr_b16 v[62:63], v16 offset:27136
    s_getreg_b32 s45, hwreg(HW_REG_IB_STS, 0, 4)
    v_mfma_f32_32x32x16_bf16 v[224:239], v[76:79], v[64:67], v[224:239]
    s_or_b32 s45, s45, s49
    v_mfma_f32_32x32x16_bf16 v[240:255], v[76:79], v[68:71], v[240:255]
    s_cbranch_scc0 CD_PUB51
CD_PUBR51:
    s_waitcnt lgkmcnt(6)
    v_mfma_f32_32x32x16_bf16 v[192:207], v[40:43], v[32:35], v[192:207]
    s_barrier
    ds_read_b128 v[64:67], v10 offset:32768
    ds_read_b64_tr_b16 v[72:73], v15 offset:32768
    ds_read_b64_tr_b16 v[74:75], v15 offset:33280
    v_mfma_f32_32x32x16_bf16 v[208:223], v[40:43], v[36:39], v[208:223]
    ds_read_b128 v[68:71], v10 offset:36864
    ds_read_b64_tr_b16 v[76:77], v16 offset:32768
    ds_read_b64_tr_b16 v[78:79], v16 offset:33280
    s_getreg_b32 s45, hwreg(HW_REG_IB_STS, 0, 4)
    v_mfma_f32_32x32x16_bf16 v[224:239], v[44:47], v[32:35], v[224:239]
    s_or_b32 s45, s45, s49
    v_mfma_f32_32x32x16_bf16 v[240:255], v[44:47], v[36:39], v[240:255]
    s_cbranch_scc0 CD_PUB52
CD_PUBR52:
    s_waitcnt lgkmcnt(6)
    v_mfma_f32_32x32x16_bf16 v[192:207], v[56:59], v[48:51], v[192:207]
    ds_read_b128 v[32:35], v11 offset:32768
    ds_read_b64_tr_b16 v[40:41], v15 offset:34816
    ds_read_b64_tr_b16 v[42:43], v15 offset:35328
    v_mfma_f32_32x32x16_bf16 v[208:223], v[56:59], v[52:55], v[208:223]
    ds_read_b128 v[36:39], v11 offset:36864
    ds_read_b64_tr_b16 v[44:45], v16 offset:34816
    ds_read_b64_tr_b16 v[46:47], v16 offset:35328
    s_getreg_b32 s45, hwreg(HW_REG_IB_STS, 0, 4)
    v_mfma_f32_32x32x16_bf16 v[224:239], v[60:63], v[48:51], v[224:239]
    s_or_b32 s45, s45, s49
    v_mfma_f32_32x32x16_bf16 v[240:255], v[60:63], v[52:55], v[240:255]
    s_cbranch_scc0 CD_PUB53
CD_PUBR53:
    s_waitcnt lgkmcnt(6)
    v_mfma_f32_32x32x16_bf16 v[192:207], v[72:75], v[64:67], v[192:207]
    v_mfma_f32_32x32x16_bf16 v[208:223], v[72:75], v[68:71], v[208:223]
    s_cmp_lg_u32 s49, 0
    s_cbranch_scc1 CD_W54
    s_waitcnt vmcnt(0)
CD_W54:
    s_getreg_b32 s45, hwreg(HW_REG_IB_STS, 0, 4)
    v_mfma_f32_32x32x16_bf16 v[224:239], v[76:79], v[64:67], v[224:239]
    s_or_b32 s45, s45, s49
    v_mfma_f32_32x32x16_bf16 v[240:255], v[76:79], v[68:71], v[240:255]
    s_cbranch_scc0 CD_PUB54
CD_PUBR54:
    s_waitcnt lgkmcnt(0)
    v_mfma_f32_32x32x16_bf16 v[192:207], v[40:43], v[32:35], v[192:207]
    v_mfma_f32_32x32x16_bf16 v[208:223], v[40:43], v[36:39], v[208:223]
    v_mfma_f32_32x32x16_bf16 v[224:239], v[44:47], v[32:35], v[224:239]
    v_mfma_f32_32x32x16_bf16 v[240:255], v[44:47], v[36:39], v[240:255]
    s_mov_b32 s40, 2147479552
    s_mov_b32 s41, 2147479552
    s_branch ROLE_A
CD_PUB30:
    s_mov_b32 exec_hi, 0xffff
    buffer_store_dwordx2 v[30:31], v17, s[24:27], s48 offen sc1
    s_mov_b64 exec, -1
    s_mov_b32 s49, 1
    s_branch CD_PUBR30
CD_PUB31:
    s_mov_b32 exec_hi, 0xffff
    buffer_store_dwordx2 v[30:31], v17, s[24:27], s48 offen sc1
    s_mov_b64 exec, -1
    s_mov_b32 s49, 1
    s_branch CD_PUBR31
CD_PUB32:
    s_mov_b32 exec_hi, 0xffff
    buffer_store_dwordx2 v[30:31], v17, s[24:27], s48 offen sc1
    s_mov_b64 exec, -1
    s_mov_b32 s49, 1
    s_branch CD_PUBR32
CD_PUB33:
    s_mov_b32 exec_hi, 0xffff
    buffer_store_dwordx2 v[30:31], v17, s[24:27], s48 offen sc1
    s_mov_b64 exec, -1
    s_mov_b32 s49, 1
    s_branch CD_PUBR33
CD_PUB34:
    s_mov_b32 exec_hi, 0xffff
    buffer_store_dwordx2 v[30:31], v17, s[24:27], s48 offen sc1
    s_mov_b64 exec, -1
    s_mov_b32 s49, 1
    s_branch CD_PUBR34
CD_PUB35:
    s_mov_b32 exec_hi, 0xffff
    buffer_store_dwordx2 v[30:31], v17, s[24:27], s48 offen sc1
    s_mov_b64 exec, -1
    s_mov_b32 s49, 1
    s_branch CD_PUBR35
CD_PUB36:
    s_mov_b32 exec_hi, 0xffff
    buffer_store_dwordx2 v[30:31], v17, s[24:27], s48 offen sc1
    s_mov_b64 exec, -1
    s_mov_b32 s49, 1
    s_branch CD_PUBR36
CD_PUB37:
    s_mov_b32 exec_hi, 0xffff
    buffer_store_dwordx2 v[30:31], v17, s[24:27], s48 offen sc1
    s_mov_b64 exec, -1
    s_mov_b32 s49, 1
    s_branch CD_PUBR37
CD_PUB38:
    s_mov_b32 exec_hi, 0xffff
    buffer_store_dwordx2 v[30:31], v17, s[24:27], s48 offen sc1
    s_mov_b64 exec, -1
    s_mov_b32 s49, 1
    s_branch CD_PUBR38
CD_PUB39:
    s_mov_b32 exec_hi, 0xffff
    buffer_store_dwordx2 v[30:31], v17, s[24:27], s48 offen sc1
    s_mov_b64 exec, -1
    s_mov_b32 s49, 1
    s_branch CD_PUBR39
CD_PUB40:
    s_mov_b32 exec_hi, 0xffff
    buffer_store_dwordx2 v[30:31], v17, s[24:27], s48 offen sc1
    s_mov_b64 exec, -1
    s_mov_b32 s49, 1
    s_branch CD_PUBR40
CD_PUB41:
    s_mov_b32 exec_hi, 0xffff
    buffer_store_dwordx2 v[30:31], v17, s[24:27], s48 offen sc1
    s_mov_b64 exec, -1
    s_mov_b32 s49, 1
    s_branch CD_PUBR41
CD_PUB42:
    s_mov_b32 exec_hi, 0xffff
    buffer_store_dwordx2 v[30:31], v17, s[24:27], s48 offen sc1
    s_mov_b64 exec, -1
    s_mov_b32 s49, 1
    s_branch CD_PUBR42
CD_PUB43:
    s_mov_b32 exec_hi, 0xffff
    buffer_store_dwordx2 v[30:31], v17, s[24:27], s48 offen sc1
    s_mov_b64 exec, -1
    s_mov_b32 s49, 1
    s_branch CD_PUBR43
CD_PUB44:
    s_mov_b32 exec_hi, 0xffff
    buffer_store_dwordx2 v[30:31], v17, s[24:27], s48 offen sc1
    s_mov_b64 exec, -1
    s_mov_b32 s49, 1
    s_branch CD_PUBR44
CD_PUB45:
    s_mov_b32 exec_hi, 0xffff
    buffer_store_dwordx2 v[30:31], v17, s[24:27], s48 offen sc1
    s_mov_b64 exec, -1
    s_mov_b32 s49, 1
    s_branch CD_PUBR45
CD_PUB46:
    s_mov_b32 exec_hi, 0xffff
    buffer_store_dwordx2 v[30:31], v17, s[24:27], s48 offen sc1
    s_mov_b64 exec, -1
    s_mov_b32 s49, 1
    s_branch CD_PUBR46
CD_PUB47:
    s_mov_b32 exec_hi, 0xffff
    buffer_store_dwordx2 v[30:31], v17, s[24:27], s48 offen sc1
    s_mov_b64 exec, -1
    s_mov_b32 s49, 1
    s_branch CD_PUBR47
CD_PUB48:
    s_mov_b32 exec_hi, 0xffff
    buffer_store_dwordx2 v[30:31], v17, s[24:27], s48 offen sc1
    s_mov_b64 exec, -1
    s_mov_b32 s49, 1
    s_branch CD_PUBR48
CD_PUB49:
    s_mov_b32 exec_hi, 0xffff
    buffer_store_dwordx2 v[30:31], v17, s[24:27], s48 offen sc1
    s_mov_b64 exec, -1
    s_mov_b32 s49, 1
    s_branch CD_PUBR49
CD_PUB50:
    s_mov_b32 exec_hi, 0xffff
    buffer_store_dwordx2 v[30:31], v17, s[24:27], s48 offen sc1
    s_mov_b64 exec, -1
    s_mov_b32 s49, 1
    s_branch CD_PUBR50
CD_PUB51:
    s_mov_b32 exec_hi, 0xffff
    buffer_store_dwordx2 v[30:31], v17, s[24:27], s48 offen sc1
    s_mov_b64 exec, -1
    s_mov_b32 s49, 1
    s_branch CD_PUBR51
CD_PUB52:
    s_mov_b32 exec_hi, 0xffff
    buffer_store_dwordx2 v[30:31], v17, s[24:27], s48 offen sc1
    s_mov_b64 exec, -1
    s_mov_b32 s49, 1
    s_branch CD_PUBR52
CD_PUB53:
    s_mov_b32 exec_hi, 0xffff
    buffer_store_dwordx2 v[30:31], v17, s[24:27], s48 offen sc1
    s_mov_b64 exec, -1
    s_mov_b32 s49, 1
    s_branch CD_PUBR53
CD_PUB54:
    s_mov_b32 exec_hi, 0xffff
    buffer_store_dwordx2 v[30:31], v17, s[24:27], s48 offen sc1
    s_mov_b64 exec, -1
    s_mov_b32 s49, 1
    s_branch CD_PUBR54
ROLE_A:
    s_setprio 1
    s_nop 7
    v_max_f32 v192, 0, v192
    v_max_f32 v193, 0, v193
    v_max_f32 v194, 0, v194
    v_max_f32 v195, 0, v195
    v_max_f32 v196, 0, v196
    v_max_f32 v197, 0, v197
    v_max_f32 v198, 0, v198
    v_max_f32 v199, 0, v199
    v_pk_mul_f32 v[192:193], v[192:193], v[200:201]
    v_pk_mul_f32 v[194:195], v[194:195], v[202:203]
    v_pk_mul_f32 v[196:197], v[196:197], v[204:205]
    v_pk_mul_f32 v[198:199], v[198:199], v[206:207]
    v_cvt_pk_bf16_f32 v176, v192, v193
    v_cvt_pk_bf16_f32 v177, v194, v195
    v_cvt_pk_bf16_f32 v178, v196, v197
    v_cvt_pk_bf16_f32 v179, v198, v199
    v_max_f32 v208, 0, v208
    v_max_f32 v209, 0, v209
    v_max_f32 v210, 0, v210
    v_max_f32 v211, 0, v211
    v_max_f32 v212, 0, v212
    v_max_f32 v213, 0, v213
    v_max_f32 v214, 0, v214
    v_max_f32 v215, 0, v215
    v_pk_mul_f32 v[208:209], v[208:209], v[216:217]
    v_pk_mul_f32 v[210:211], v[210:211], v[218:219]
    v_pk_mul_f32 v[212:213], v[212:213], v[220:221]
    v_pk_mul_f32 v[214:215], v[214:215], v[222:223]
    v_cvt_pk_bf16_f32 v180, v208, v209
    v_cvt_pk_bf16_f32 v181, v210, v211
    v_cvt_pk_bf16_f32 v182, v212, v213
    v_cvt_pk_bf16_f32 v183, v214, v215
    v_max_f32 v224, 0, v224
    v_max_f32 v225, 0, v225
    v_max_f32 v226, 0, v226
    v_max_f32 v227, 0, v227
    v_max_f32 v228, 0, v228
    v_max_f32 v229, 0, v229
    v_max_f32 v230, 0, v230
    v_max_f32 v231, 0, v231
    v_pk_mul_f32 v[224:225], v[224:225], v[232:233]
    v_pk_mul_f32 v[226:227], v[226:227], v[234:235]
    v_pk_mul_f32 v[228:229], v[228:229], v[236:237]
    v_pk_mul_f32 v[230:231], v[230:231], v[238:239]
    v_cvt_pk_bf16_f32 v184, v224, v225
    v_cvt_pk_bf16_f32 v185, v226, v227
    v_cvt_pk_bf16_f32 v186, v228, v229
    v_cvt_pk_bf16_f32 v187, v230, v231
    v_max_f32 v240, 0, v240
    v_max_f32 v241, 0, v241
    v_max_f32 v242, 0, v242
    v_max_f32 v243, 0, v243
    v_max_f32 v244, 0, v244
    v_max_f32 v245, 0, v245
    v_max_f32 v246, 0, v246
    v_max_f32 v247, 0, v247
    v_pk_mul_f32 v[240:241], v[240:241], v[248:249]
    v_pk_mul_f32 v[242:243], v[242:243], v[250:251]
    v_pk_mul_f32 v[244:245], v[244:245], v[252:253]
    v_pk_mul_f32 v[246:247], v[246:247], v[254:255]
    v_cvt_pk_bf16_f32 v188, v240, v241
    v_cvt_pk_bf16_f32 v189, v242, v243
    v_cvt_pk_bf16_f32 v190, v244, v245
    v_cvt_pk_bf16_f32 v191, v246, v247
    s_mov_b32 s42, 0
    s_mov_b32 s43, 0
    s_mov_b32 s93, 0
    v_mov_b32 v72, 0
    v_mov_b32 v73, 0
    v_mov_b32 v74, 0
    v_mov_b32 v75, 0
    v_mov_b32 v76, 0
    v_mov_b32 v77, 0
    v_mov_b32 v78, 0
    v_mov_b32 v79, 0
    s_barrier
    ds_read_b128 v[144:147], v20 offset:16384
    ds_read_b128 v[96:99], v3 offset:26624
    ds_read_b128 v[148:151], v20 offset:17408
    ds_read_b128 v[100:103], v3 offset:27648
    ds_read_b128 v[152:155], v21 offset:16384
    ds_read_b128 v[156:159], v21 offset:17408
    ds_read_b128 v[160:163], v22 offset:16384
    ds_read_b128 v[164:167], v22 offset:17408
    ds_read_b128 v[168:171], v23 offset:16384
    ds_read_b128 v[172:175], v23 offset:17408
    ds_read_b128 v[104:107], v3 offset:28672
    ds_read_b128 v[108:111], v3 offset:29696
    ds_read_b32 v26, v25 offset:43008
    v_add_u32 v25, 256, v25
    s_waitcnt lgkmcnt(9)
A_RUN:
    v_mfma_f32_32x32x16_bf16 v[32:47], v[96:99], v[144:147], 0
    v_mfma_f32_32x32x16_bf16 v[32:47], v[100:103], v[148:151], v[32:47]
    v_mfma_f32_32x32x16_bf16 v[192:207], v[72:75], v[72:75], 0
    v_mfma_f32_32x32x16_bf16 v[208:223], v[72:75], v[72:75], 0
    v_mfma_f32_32x32x16_bf16 v[224:239], v[72:75], v[72:75], 0
    v_mfma_f32_32x32x16_bf16 v[240:255], v[72:75], v[72:75], 0
    buffer_load_dwordx4 v[112:115], v2, s[24:27], s9 offen offset:0 sc1
    buffer_load_dwordx4 v[116:119], v2, s[24:27], s9 offen offset:1024 sc1
    buffer_load_dwordx4 v[120:123], v2, s[24:27], s9 offen offset:2048 sc1
    buffer_load_dwordx4 v[124:127], v2, s[24:27], s9 offen offset:3072 sc1
    buffer_load_dwordx4 v[128:131], v2, s[24:27], s10 offen offset:0 sc1
    buffer_load_dwordx4 v[132:135], v2, s[24:27], s10 offen offset:1024 sc1
    buffer_load_dwordx4 v[136:139], v2, s[24:27], s10 offen offset:2048 sc1
    buffer_load_dwordx4 v[140:143], v2, s[24:27], s10 offen offset:3072 sc1
    buffer_store_dwordx4 v[80:83], v2, s[24:27], s40 offen offset:0 sc1
    buffer_store_dwordx4 v[84:87], v2, s[24:27], s41 offen offset:0 sc1
    buffer_store_dwordx4 v[88:91], v2, s[24:27], s40 offen offset:1024 sc1
    buffer_store_dwordx4 v[92:95], v2, s[24:27], s41 offen offset:1024 sc1
    s_waitcnt lgkmcnt(0)
    s_add_u32 s4, s3, 1
    s_and_b32 s4, s4, 3
    s_lshl_b32 s5, s4, 14
    s_lshl_b32 s44, s3, 12
    s_add_u32 s5, s5, s44
    v_add_u32 v16, s5, v2
    s_lshl_b32 s4, s4, 12
    s_lshl_b32 s44, s3, 14
    s_add_u32 s4, s4, s44
    v_add_u32 v19, s4, v2
    s_add_u32 s4, s3, 2
    s_and_b32 s4, s4, 3
    s_lshl_b32 s5, s4, 14
    s_lshl_b32 s44, s3, 12
    s_add_u32 s5, s5, s44
    v_add_u32 v17, s5, v2
    s_lshl_b32 s4, s4, 12
    s_lshl_b32 s44, s3, 14
    s_add_u32 s4, s4, s44
    v_add_u32 v20, s4, v2
    s_add_u32 s4, s3, 3
    s_and_b32 s4, s4, 3
    s_lshl_b32 s5, s4, 14
    s_lshl_b32 s44, s3, 12
    s_add_u32 s5, s5, s44
    v_add_u32 v18, s5, v2
    s_lshl_b32 s4, s4, 12
    s_lshl_b32 s44, s3, 14
    s_add_u32 s4, s4, s44
    v_add_u32 v21, s4, v2
    v_mfma_f32_32x32x16_bf16 v[48:63], v[96:99], v[152:155], 0
    ds_add_u32 v25, v27
    v_exp_f32 v32, v32
    v_exp_f32 v33, v33
    v_exp_f32 v34, v34
    v_exp_f32 v35, v35
    v_cvt_pk_bf16_f32 v64, v32, v33
    v_mfma_f32_32x32x16_bf16 v[48:63], v[100:103], v[156:159], v[48:63]
    v_exp_f32 v36, v36
    v_exp_f32 v37, v37
    v_cvt_pk_bf16_f32 v65, v34, v35
    v_exp_f32 v38, v38
    v_exp_f32 v39, v39
    v_cvt_pk_bf16_f32 v66, v36, v37
    v_exp_f32 v40, v40
    v_exp_f32 v41, v41
    v_cvt_pk_bf16_f32 v67, v38, v39
    v_exp_f32 v42, v42
    v_exp_f32 v43, v43
    v_cvt_pk_bf16_f32 v68, v40, v41
    v_exp_f32 v44, v44
    v_exp_f32 v45, v45
    v_cvt_pk_bf16_f32 v69, v42, v43
    v_exp_f32 v46, v46
    v_exp_f32 v47, v47
    v_cvt_pk_bf16_f32 v70, v44, v45
    v_cvt_pk_bf16_f32 v71, v46, v47
    v_mfma_f32_32x32x16_bf16 v[32:47], v[96:99], v[160:163], 0
    buffer_load_dwordx4 v[80:83], v2, s[24:27], s11 offen offset:0 sc1
    v_exp_f32 v48, v48
    v_exp_f32 v49, v49
    v_exp_f32 v50, v50
    v_exp_f32 v51, v51
    v_cvt_pk_bf16_f32 v72, v48, v49
    v_mfma_f32_32x32x16_bf16 v[32:47], v[100:103], v[164:167], v[32:47]
    buffer_load_dwordx4 v[84:87], v2, s[24:27], s11 offen offset:1024 sc1
    v_exp_f32 v52, v52
    v_exp_f32 v53, v53
    v_cvt_pk_bf16_f32 v73, v50, v51
    v_exp_f32 v54, v54
    v_exp_f32 v55, v55
    v_cvt_pk_bf16_f32 v74, v52, v53
    v_mfma_f32_32x32x16_bf16 v[192:207], v[104:107], v[64:67], v[192:207]
    buffer_load_dwordx4 v[88:91], v2, s[24:27], s11 offen offset:2048 sc1
    v_exp_f32 v56, v56
    v_exp_f32 v57, v57
    v_cvt_pk_bf16_f32 v75, v54, v55
    v_exp_f32 v58, v58
    v_exp_f32 v59, v59
    v_cvt_pk_bf16_f32 v76, v56, v57
    v_mfma_f32_32x32x16_bf16 v[192:207], v[108:111], v[68:71], v[192:207]
    buffer_load_dwordx4 v[92:95], v2, s[24:27], s11 offen offset:3072 sc1
    v_exp_f32 v60, v60
    v_exp_f32 v61, v61
    v_cvt_pk_bf16_f32 v77, v58, v59
    v_exp_f32 v62, v62
    v_exp_f32 v63, v63
    v_cvt_pk_bf16_f32 v78, v60, v61
    v_cvt_pk_bf16_f32 v79, v62, v63
    v_mfma_f32_32x32x16_bf16 v[48:63], v[96:99], v[168:171], 0
    v_exp_f32 v32, v32
    v_exp_f32 v33, v33
    v_exp_f32 v34, v34
    v_exp_f32 v35, v35
    v_cvt_pk_bf16_f32 v64, v32, v33
    v_mfma_f32_32x32x16_bf16 v[48:63], v[100:103], v[172:175], v[48:63]
    buffer_store_dwordx4 v[176:179], v2, s[24:27], s54 offen offset:0 sc1
    v_exp_f32 v36, v36
    v_exp_f32 v37, v37
    v_cvt_pk_bf16_f32 v65, v34, v35
    v_exp_f32 v38, v38
    v_exp_f32 v39, v39
    v_cvt_pk_bf16_f32 v66, v36, v37
    v_mfma_f32_32x32x16_bf16 v[208:223], v[104:107], v[72:75], v[208:223]
    v_exp_f32 v40, v40
    v_exp_f32 v41, v41
    v_cvt_pk_bf16_f32 v67, v38, v39
    v_exp_f32 v42, v42
    v_exp_f32 v43, v43
    v_cvt_pk_bf16_f32 v68, v40, v41
    v_mfma_f32_32x32x16_bf16 v[208:223], v[108:111], v[76:79], v[208:223]
    v_exp_f32 v44, v44
    v_exp_f32 v45, v45
    v_cvt_pk_bf16_f32 v69, v42, v43
    v_exp_f32 v46, v46
    v_exp_f32 v47, v47
    v_cvt_pk_bf16_f32 v70, v44, v45
    v_cvt_pk_bf16_f32 v71, v46, v47
    s_waitcnt vmcnt(13)
    v_mfma_f32_32x32x16_bf16 v[32:47], v[112:115], v[144:147], 0
    v_exp_f32 v48, v48
    v_exp_f32 v49, v49
    v_exp_f32 v50, v50
    v_exp_f32 v51, v51
    v_cvt_pk_bf16_f32 v72, v48, v49
    v_mfma_f32_32x32x16_bf16 v[32:47], v[116:119], v[148:151], v[32:47]
    v_exp_f32 v52, v52
    v_exp_f32 v53, v53
    v_cvt_pk_bf16_f32 v73, v50, v51
    v_exp_f32 v54, v54
    v_exp_f32 v55, v55
    v_cvt_pk_bf16_f32 v74, v52, v53
    v_mfma_f32_32x32x16_bf16 v[224:239], v[104:107], v[64:67], v[224:239]
    v_exp_f32 v56, v56
    v_exp_f32 v57, v57
    v_cvt_pk_bf16_f32 v75, v54, v55
    v_exp_f32 v58, v58
    v_exp_f32 v59, v59
    v_cvt_pk_bf16_f32 v76, v56, v57
    v_mfma_f32_32x32x16_bf16 v[224:239], v[108:111], v[68:71], v[224:239]
    v_exp_f32 v60, v60
    v_exp_f32 v61, v61
    v_cvt_pk_bf16_f32 v77, v58, v59
    v_exp_f32 v62, v62
    v_exp_f32 v63, v63
    v_cvt_pk_bf16_f32 v78, v60, v61
    v_cvt_pk_bf16_f32 v79, v62, v63
    v_mfma_f32_32x32x16_bf16 v[48:63], v[112:115], v[152:155], 0
    ds_add_u32 v25, v27
    v_exp_f32 v32, v32
    v_exp_f32 v33, v33
    v_exp_f32 v34, v34
    v_exp_f32 v35, v35
    v_cvt_pk_bf16_f32 v64, v32, v33
    v_mfma_f32_32x32x16_bf16 v[48:63], v[116:119], v[156:159], v[48:63]
    buffer_store_dwordx4 v[180:183], v2, s[24:27], s55 offen offset:0 sc1
    v_exp_f32 v36, v36
    v_exp_f32 v37, v37
    v_cvt_pk_bf16_f32 v65, v34, v35
    v_exp_f32 v38, v38
    v_exp_f32 v39, v39
    v_cvt_pk_bf16_f32 v66, v36, v37
    v_mfma_f32_32x32x16_bf16 v[240:255], v[104:107], v[72:75], v[240:255]
    v_exp_f32 v40, v40
    v_exp_f32 v41, v41
    v_cvt_pk_bf16_f32 v67, v38, v39
    v_exp_f32 v42, v42
    v_exp_f32 v43, v43
    v_cvt_pk_bf16_f32 v68, v40, v41
    v_mfma_f32_32x32x16_bf16 v[240:255], v[108:111], v[76:79], v[240:255]
    v_exp_f32 v44, v44
    v_exp_f32 v45, v45
    v_cvt_pk_bf16_f32 v69, v42, v43
    v_exp_f32 v46, v46
    v_exp_f32 v47, v47
    v_cvt_pk_bf16_f32 v70, v44, v45
    v_cvt_pk_bf16_f32 v71, v46, v47
    v_mfma_f32_32x32x16_bf16 v[32:47], v[112:115], v[160:163], 0
    buffer_load_dwordx4 v[96:99], v2, s[24:27], s12 offen offset:0 sc1
    v_exp_f32 v48, v48
    v_exp_f32 v49, v49
    v_exp_f32 v50, v50
    v_exp_f32 v51, v51
    v_cvt_pk_bf16_f32 v72, v48, v49
    v_mfma_f32_32x32x16_bf16 v[32:47], v[116:119], v[164:167], v[32:47]
    buffer_load_dwordx4 v[100:103], v2, s[24:27], s12 offen offset:1024 sc1
    v_exp_f32 v52, v52
    v_exp_f32 v53, v53
    v_cvt_pk_bf16_f32 v73, v50, v51
    v_exp_f32 v54, v54
    v_exp_f32 v55, v55
    v_cvt_pk_bf16_f32 v74, v52, v53
    v_mfma_f32_32x32x16_bf16 v[192:207], v[120:123], v[64:67], v[192:207]
    buffer_load_dwordx4 v[104:107], v2, s[24:27], s12 offen offset:2048 sc1
    v_exp_f32 v56, v56
    v_exp_f32 v57, v57
    v_cvt_pk_bf16_f32 v75, v54, v55
    v_exp_f32 v58, v58
    v_exp_f32 v59, v59
    v_cvt_pk_bf16_f32 v76, v56, v57
    v_mfma_f32_32x32x16_bf16 v[192:207], v[124:127], v[68:71], v[192:207]
    buffer_load_dwordx4 v[108:111], v2, s[24:27], s12 offen offset:3072 sc1
    v_exp_f32 v60, v60
    v_exp_f32 v61, v61
    v_cvt_pk_bf16_f32 v77, v58, v59
    v_exp_f32 v62, v62
    v_exp_f32 v63, v63
    v_cvt_pk_bf16_f32 v78, v60, v61
    v_cvt_pk_bf16_f32 v79, v62, v63
    v_mfma_f32_32x32x16_bf16 v[48:63], v[112:115], v[168:171], 0
    v_exp_f32 v32, v32
    v_exp_f32 v33, v33
    v_exp_f32 v34, v34
    v_exp_f32 v35, v35
    v_cvt_pk_bf16_f32 v64, v32, v33
    v_mfma_f32_32x32x16_bf16 v[48:63], v[116:119], v[172:175], v[48:63]
    buffer_store_dwordx4 v[184:187], v2, s[24:27], s54 offen offset:1024 sc1
    v_exp_f32 v36, v36
    v_exp_f32 v37, v37
    v_cvt_pk_bf16_f32 v65, v34, v35
    v_exp_f32 v38, v38
    v_exp_f32 v39, v39
    v_cvt_pk_bf16_f32 v66, v36, v37
    v_mfma_f32_32x32x16_bf16 v[208:223], v[120:123], v[72:75], v[208:223]
    v_exp_f32 v40, v40
    v_exp_f32 v41, v41
    v_cvt_pk_bf16_f32 v67, v38, v39
    v_exp_f32 v42, v42
    v_exp_f32 v43, v43
    v_cvt_pk_bf16_f32 v68, v40, v41
    v_mfma_f32_32x32x16_bf16 v[208:223], v[124:127], v[76:79], v[208:223]
    v_exp_f32 v44, v44
    v_exp_f32 v45, v45
    v_cvt_pk_bf16_f32 v69, v42, v43
    v_exp_f32 v46, v46
    v_exp_f32 v47, v47
    v_cvt_pk_bf16_f32 v70, v44, v45
    v_cvt_pk_bf16_f32 v71, v46, v47
    s_waitcnt vmcnt(15)
    v_mfma_f32_32x32x16_bf16 v[32:47], v[128:131], v[144:147], 0
    v_exp_f32 v48, v48
    v_exp_f32 v49, v49
    v_exp_f32 v50, v50
    v_exp_f32 v51, v51
    v_cvt_pk_bf16_f32 v72, v48, v49
    v_mfma_f32_32x32x16_bf16 v[32:47], v[132:135], v[148:151], v[32:47]
    v_exp_f32 v52, v52
    v_exp_f32 v53, v53
    v_cvt_pk_bf16_f32 v73, v50, v51
    v_exp_f32 v54, v54
    v_exp_f32 v55, v55
    v_cvt_pk_bf16_f32 v74, v52, v53
    v_mfma_f32_32x32x16_bf16 v[224:239], v[120:123], v[64:67], v[224:239]
    v_exp_f32 v56, v56
    v_exp_f32 v57, v57
    v_cvt_pk_bf16_f32 v75, v54, v55
    v_exp_f32 v58, v58
    v_exp_f32 v59, v59
    v_cvt_pk_bf16_f32 v76, v56, v57
    v_mfma_f32_32x32x16_bf16 v[224:239], v[124:127], v[68:71], v[224:239]
    v_exp_f32 v60, v60
    v_exp_f32 v61, v61
    v_cvt_pk_bf16_f32 v77, v58, v59
    v_exp_f32 v62, v62
    v_exp_f32 v63, v63
    v_cvt_pk_bf16_f32 v78, v60, v61
    v_cvt_pk_bf16_f32 v79, v62, v63
    v_mfma_f32_32x32x16_bf16 v[48:63], v[128:131], v[152:155], 0
    ds_add_u32 v25, v27
    v_exp_f32 v32, v32
    v_exp_f32 v33, v33
    v_exp_f32 v34, v34
    v_exp_f32 v35, v35
    v_cvt_pk_bf16_f32 v64, v32, v33
    v_mfma_f32_32x32x16_bf16 v[48:63], v[132:135], v[156:159], v[48:63]
    buffer_store_dwordx4 v[188:191], v2, s[24:27], s55 offen offset:1024 sc1
    v_exp_f32 v36, v36
    v_exp_f32 v37, v37
    v_cvt_pk_bf16_f32 v65, v34, v35
    v_exp_f32 v38, v38
    v_exp_f32 v39, v39
    v_cvt_pk_bf16_f32 v66, v36, v37
    v_mfma_f32_32x32x16_bf16 v[240:255], v[120:123], v[72:75], v[240:255]
    v_exp_f32 v40, v40
    v_exp_f32 v41, v41
    v_cvt_pk_bf16_f32 v67, v38, v39
    v_exp_f32 v42, v42
    v_exp_f32 v43, v43
    v_cvt_pk_bf16_f32 v68, v40, v41
    v_mfma_f32_32x32x16_bf16 v[240:255], v[124:127], v[76:79], v[240:255]
    v_exp_f32 v44, v44
    v_exp_f32 v45, v45
    v_cvt_pk_bf16_f32 v69, v42, v43
    v_exp_f32 v46, v46
    v_exp_f32 v47, v47
    v_cvt_pk_bf16_f32 v70, v44, v45
    v_cvt_pk_bf16_f32 v71, v46, v47
    v_mfma_f32_32x32x16_bf16 v[32:47], v[128:131], v[160:163], 0
    buffer_load_dwordx4 v[112:115], v2, s[24:27], s13 offen offset:0 sc1
    v_exp_f32 v48, v48
    v_exp_f32 v49, v49
    v_exp_f32 v50, v50
    v_exp_f32 v51, v51
    v_cvt_pk_bf16_f32 v72, v48, v49
    v_mfma_f32_32x32x16_bf16 v[32:47], v[132:135], v[164:167], v[32:47]
    buffer_load_dwordx4 v[116:119], v2, s[24:27], s13 offen offset:1024 sc1
    v_exp_f32 v52, v52
    v_exp_f32 v53, v53
    v_cvt_pk_bf16_f32 v73, v50, v51
    v_exp_f32 v54, v54
    v_exp_f32 v55, v55
    v_cvt_pk_bf16_f32 v74, v52, v53
    v_mfma_f32_32x32x16_bf16 v[192:207], v[136:139], v[64:67], v[192:207]
    buffer_load_dwordx4 v[120:123], v2, s[24:27], s13 offen offset:2048 sc1
    v_exp_f32 v56, v56
    v_exp_f32 v57, v57
    v_cvt_pk_bf16_f32 v75, v54, v55
    v_exp_f32 v58, v58
    v_exp_f32 v59, v59
    v_cvt_pk_bf16_f32 v76, v56, v57
    v_mfma_f32_32x32x16_bf16 v[192:207], v[140:143], v[68:71], v[192:207]
    buffer_load_dwordx4 v[124:127], v2, s[24:27], s13 offen offset:3072 sc1
    v_exp_f32 v60, v60
    v_exp_f32 v61, v61
    v_cvt_pk_bf16_f32 v77, v58, v59
    v_exp_f32 v62, v62
    v_exp_f32 v63, v63
    v_cvt_pk_bf16_f32 v78, v60, v61
    v_cvt_pk_bf16_f32 v79, v62, v63
    v_mfma_f32_32x32x16_bf16 v[48:63], v[128:131], v[168:171], 0
    v_exp_f32 v32, v32
    v_exp_f32 v33, v33
    v_exp_f32 v34, v34
    v_exp_f32 v35, v35
    v_cvt_pk_bf16_f32 v64, v32, v33
    v_mfma_f32_32x32x16_bf16 v[48:63], v[132:135], v[172:175], v[48:63]
    v_exp_f32 v36, v36
    v_exp_f32 v37, v37
    v_cvt_pk_bf16_f32 v65, v34, v35
    v_exp_f32 v38, v38
    v_exp_f32 v39, v39
    v_cvt_pk_bf16_f32 v66, v36, v37
    v_mfma_f32_32x32x16_bf16 v[208:223], v[136:139], v[72:75], v[208:223]
    v_exp_f32 v40, v40
    v_exp_f32 v41, v41
    v_cvt_pk_bf16_f32 v67, v38, v39
    v_exp_f32 v42, v42
    v_exp_f32 v43, v43
    v_cvt_pk_bf16_f32 v68, v40, v41
    v_mfma_f32_32x32x16_bf16 v[208:223], v[140:143], v[76:79], v[208:223]
    v_exp_f32 v44, v44
    v_exp_f32 v45, v45
    v_cvt_pk_bf16_f32 v69, v42, v43
    v_exp_f32 v46, v46
    v_exp_f32 v47, v47
    v_cvt_pk_bf16_f32 v70, v44, v45
    v_cvt_pk_bf16_f32 v71, v46, v47
    s_waitcnt vmcnt(12)
    v_mfma_f32_32x32x16_bf16 v[32:47], v[80:83], v[144:147], 0
    v_exp_f32 v48, v48
    v_exp_f32 v49, v49
    v_exp_f32 v50, v50
    v_exp_f32 v51, v51
    v_cvt_pk_bf16_f32 v72, v48, v49
    v_mfma_f32_32x32x16_bf16 v[32:47], v[84:87], v[148:151], v[32:47]
    v_exp_f32 v52, v52
    v_exp_f32 v53, v53
    v_cvt_pk_bf16_f32 v73, v50, v51
    v_exp_f32 v54, v54
    v_exp_f32 v55, v55
    v_cvt_pk_bf16_f32 v74, v52, v53
    v_mfma_f32_32x32x16_bf16 v[224:239], v[136:139], v[64:67], v[224:239]
    v_exp_f32 v56, v56
    v_exp_f32 v57, v57
    v_cvt_pk_bf16_f32 v75, v54, v55
    v_exp_f32 v58, v58
    v_exp_f32 v59, v59
    v_cvt_pk_bf16_f32 v76, v56, v57
    v_mfma_f32_32x32x16_bf16 v[224:239], v[140:143], v[68:71], v[224:239]
    v_exp_f32 v60, v60
    v_exp_f32 v61, v61
    v_cvt_pk_bf16_f32 v77, v58, v59
    v_exp_f32 v62, v62
    v_exp_f32 v63, v63
    v_cvt_pk_bf16_f32 v78, v60, v61
    v_cvt_pk_bf16_f32 v79, v62, v63
    v_mfma_f32_32x32x16_bf16 v[48:63], v[80:83], v[152:155], 0
    ds_add_u32 v25, v27
    v_exp_f32 v32, v32
    v_exp_f32 v33, v33
    v_exp_f32 v34, v34
    v_exp_f32 v35, v35
    v_cvt_pk_bf16_f32 v64, v32, v33
    v_mfma_f32_32x32x16_bf16 v[48:63], v[84:87], v[156:159], v[48:63]
    v_exp_f32 v36, v36
    v_exp_f32 v37, v37
    v_cvt_pk_bf16_f32 v65, v34, v35
    v_exp_f32 v38, v38
    v_exp_f32 v39, v39
    v_cvt_pk_bf16_f32 v66, v36, v37
    v_mfma_f32_32x32x16_bf16 v[240:255], v[136:139], v[72:75], v[240:255]
    v_exp_f32 v40, v40
    v_exp_f32 v41, v41
    v_cvt_pk_bf16_f32 v67, v38, v39
    v_exp_f32 v42, v42
    v_exp_f32 v43, v43
    v_cvt_pk_bf16_f32 v68, v40, v41
    v_mfma_f32_32x32x16_bf16 v[240:255], v[140:143], v[76:79], v[240:255]
    v_exp_f32 v44, v44
    v_exp_f32 v45, v45
    v_cvt_pk_bf16_f32 v69, v42, v43
    v_exp_f32 v46, v46
    v_exp_f32 v47, v47
    v_cvt_pk_bf16_f32 v70, v44, v45
    v_cvt_pk_bf16_f32 v71, v46, v47
    v_mfma_f32_32x32x16_bf16 v[32:47], v[80:83], v[160:163], 0
    buffer_load_dwordx4 v[128:131], v2, s[24:27], s14 offen offset:0 sc1
    v_exp_f32 v48, v48
    v_exp_f32 v49, v49
    v_exp_f32 v50, v50
    v_exp_f32 v51, v51
    v_cvt_pk_bf16_f32 v72, v48, v49
    v_mfma_f32_32x32x16_bf16 v[32:47], v[84:87], v[164:167], v[32:47]
    buffer_load_dwordx4 v[132:135], v2, s[24:27], s14 offen offset:1024 sc1
    v_exp_f32 v52, v52
    v_exp_f32 v53, v53
    v_cvt_pk_bf16_f32 v73, v50, v51
    v_exp_f32 v54, v54
    v_exp_f32 v55, v55
    v_cvt_pk_bf16_f32 v74, v52, v53
    v_mfma_f32_32x32x16_bf16 v[192:207], v[88:91], v[64:67], v[192:207]
    buffer_load_dwordx4 v[136:139], v2, s[24:27], s14 offen offset:2048 sc1
    v_exp_f32 v56, v56
    v_exp_f32 v57, v57
    v_cvt_pk_bf16_f32 v75, v54, v55
    v_exp_f32 v58, v58
    v_exp_f32 v59, v59
    v_cvt_pk_bf16_f32 v76, v56, v57
    v_mfma_f32_32x32x16_bf16 v[192:207], v[92:95], v[68:71], v[192:207]
    buffer_load_dwordx4 v[140:143], v2, s[24:27], s14 offen offset:3072 sc1
    v_exp_f32 v60, v60
    v_exp_f32 v61, v61
    v_cvt_pk_bf16_f32 v77, v58, v59
    v_exp_f32 v62, v62
    v_exp_f32 v63, v63
    v_cvt_pk_bf16_f32 v78, v60, v61
    v_cvt_pk_bf16_f32 v79, v62, v63
    v_mfma_f32_32x32x16_bf16 v[48:63], v[80:83], v[168:171], 0
    v_exp_f32 v32, v32
    v_exp_f32 v33, v33
    v_exp_f32 v34, v34
    v_exp_f32 v35, v35
    v_cvt_pk_bf16_f32 v64, v32, v33
    v_mfma_f32_32x32x16_bf16 v[48:63], v[84:87], v[172:175], v[48:63]
    v_exp_f32 v36, v36
    v_exp_f32 v37, v37
    v_cvt_pk_bf16_f32 v65, v34, v35
    v_exp_f32 v38, v38
    v_exp_f32 v39, v39
    v_cvt_pk_bf16_f32 v66, v36, v37
    v_mfma_f32_32x32x16_bf16 v[208:223], v[88:91], v[72:75], v[208:223]
    v_exp_f32 v40, v40
    v_exp_f32 v41, v41
    v_cvt_pk_bf16_f32 v67, v38, v39
    v_exp_f32 v42, v42
    v_exp_f32 v43, v43
    v_cvt_pk_bf16_f32 v68, v40, v41
    v_mfma_f32_32x32x16_bf16 v[208:223], v[92:95], v[76:79], v[208:223]
    v_exp_f32 v44, v44
    v_exp_f32 v45, v45
    v_cvt_pk_bf16_f32 v69, v42, v43
    v_exp_f32 v46, v46
    v_exp_f32 v47, v47
    v_cvt_pk_bf16_f32 v70, v44, v45
    v_cvt_pk_bf16_f32 v71, v46, v47
    s_waitcnt vmcnt(10)
    s_waitcnt vmcnt(8)
    v_mfma_f32_32x32x16_bf16 v[32:47], v[96:99], v[144:147], 0
    s_mov_b32 exec_hi, 0
    buffer_store_dword v30, v24, s[24:27], s98 offen sc1
    s_mov_b64 exec, -1
    v_exp_f32 v48, v48
    v_exp_f32 v49, v49
    v_exp_f32 v50, v50
    v_exp_f32 v51, v51
    v_cvt_pk_bf16_f32 v72, v48, v49
    v_mfma_f32_32x32x16_bf16 v[32:47], v[100:103], v[148:151], v[32:47]
    v_exp_f32 v52, v52
    v_exp_f32 v53, v53
    v_cvt_pk_bf16_f32 v73, v50, v51
    v_exp_f32 v54, v54
    v_exp_f32 v55, v55
    v_cvt_pk_bf16_f32 v74, v52, v53
    v_mfma_f32_32x32x16_bf16 v[224:239], v[88:91], v[64:67], v[224:239]
    v_exp_f32 v56, v56
    v_exp_f32 v57, v57
    v_cvt_pk_bf16_f32 v75, v54, v55
    v_exp_f32 v58, v58
    v_exp_f32 v59, v59
    v_cvt_pk_bf16_f32 v76, v56, v57
    v_mfma_f32_32x32x16_bf16 v[224:239], v[92:95], v[68:71], v[224:239]
    v_exp_f32 v60, v60
    v_exp_f32 v61, v61
    v_cvt_pk_bf16_f32 v77, v58, v59
    v_exp_f32 v62, v62
    v_exp_f32 v63, v63
    v_cvt_pk_bf16_f32 v78, v60, v61
    v_cvt_pk_bf16_f32 v79, v62, v63
    v_mfma_f32_32x32x16_bf16 v[48:63], v[96:99], v[152:155], 0
    ds_add_u32 v25, v27
    v_exp_f32 v32, v32
    v_exp_f32 v33, v33
    v_exp_f32 v34, v34
    v_exp_f32 v35, v35
    v_cvt_pk_bf16_f32 v64, v32, v33
    v_mfma_f32_32x32x16_bf16 v[48:63], v[100:103], v[156:159], v[48:63]
    v_exp_f32 v36, v36
    v_exp_f32 v37, v37
    v_cvt_pk_bf16_f32 v65, v34, v35
    v_exp_f32 v38, v38
    v_exp_f32 v39, v39
    v_cvt_pk_bf16_f32 v66, v36, v37
    v_mfma_f32_32x32x16_bf16 v[240:255], v[88:91], v[72:75], v[240:255]
    v_exp_f32 v40, v40
    v_exp_f32 v41, v41
    v_cvt_pk_bf16_f32 v67, v38, v39
    v_exp_f32 v42, v42
    v_exp_f32 v43, v43
    v_cvt_pk_bf16_f32 v68, v40, v41
    v_mfma_f32_32x32x16_bf16 v[240:255], v[92:95], v[76:79], v[240:255]
    v_exp_f32 v44, v44
    v_exp_f32 v45, v45
    v_cvt_pk_bf16_f32 v69, v42, v43
    v_exp_f32 v46, v46
    v_exp_f32 v47, v47
    v_cvt_pk_bf16_f32 v70, v44, v45
    v_cvt_pk_bf16_f32 v71, v46, v47
    v_mfma_f32_32x32x16_bf16 v[32:47], v[96:99], v[160:163], 0
    buffer_load_dwordx4 v[80:83], v2, s[24:27], s15 offen offset:0 sc1
    v_exp_f32 v48, v48
    v_exp_f32 v49, v49
    v_exp_f32 v50, v50
    v_exp_f32 v51, v51
    v_cvt_pk_bf16_f32 v72, v48, v49
    v_mfma_f32_32x32x16_bf16 v[32:47], v[100:103], v[164:167], v[32:47]
    buffer_load_dwordx4 v[84:87], v2, s[24:27], s15 offen offset:1024 sc1
    v_exp_f32 v52, v52
    v_exp_f32 v53, v53
    v_cvt_pk_bf16_f32 v73, v50, v51
    v_exp_f32 v54, v54
    v_exp_f32 v55, v55
    v_cvt_pk_bf16_f32 v74, v52, v53
    v_mfma_f32_32x32x16_bf16 v[192:207], v[104:107], v[64:67], v[192:207]
    buffer_load_dwordx4 v[88:91], v2, s[24:27], s15 offen offset:2048 sc1
    v_exp_f32 v56, v56
    v_exp_f32 v57, v57
    v_cvt_pk_bf16_f32 v75, v54, v55
    v_exp_f32 v58, v58
    v_exp_f32 v59, v59
    v_cvt_pk_bf16_f32 v76, v56, v57
    v_mfma_f32_32x32x16_bf16 v[192:207], v[108:111], v[68:71], v[192:207]
    buffer_load_dwordx4 v[92:95], v2, s[24:27], s15 offen offset:3072 sc1
    v_exp_f32 v60, v60
    v_exp_f32 v61, v61
    v_cvt_pk_bf16_f32 v77, v58, v59
    v_exp_f32 v62, v62
    v_exp_f32 v63, v63
    v_cvt_pk_bf16_f32 v78, v60, v61
    v_cvt_pk_bf16_f32 v79, v62, v63
    v_mfma_f32_32x32x16_bf16 v[48:63], v[96:99], v[168:171], 0
    v_exp_f32 v32, v32
    v_exp_f32 v33, v33
    v_exp_f32 v34, v34
    v_exp_f32 v35, v35
    v_cvt_pk_bf16_f32 v64, v32, v33
    v_mfma_f32_32x32x16_bf16 v[48:63], v[100:103], v[172:175], v[48:63]
    v_exp_f32 v36, v36
    v_exp_f32 v37, v37
    v_cvt_pk_bf16_f32 v65, v34, v35
    v_exp_f32 v38, v38
    v_exp_f32 v39, v39
    v_cvt_pk_bf16_f32 v66, v36, v37
    v_mfma_f32_32x32x16_bf16 v[208:223], v[104:107], v[72:75], v[208:223]
    v_exp_f32 v40, v40
    v_exp_f32 v41, v41
    v_cvt_pk_bf16_f32 v67, v38, v39
    v_exp_f32 v42, v42
    v_exp_f32 v43, v43
    v_cvt_pk_bf16_f32 v68, v40, v41
    v_mfma_f32_32x32x16_bf16 v[208:223], v[108:111], v[76:79], v[208:223]
    v_exp_f32 v44, v44
    v_exp_f32 v45, v45
    v_cvt_pk_bf16_f32 v69, v42, v43
    v_exp_f32 v46, v46
    v_exp_f32 v47, v47
    v_cvt_pk_bf16_f32 v70, v44, v45
    v_cvt_pk_bf16_f32 v71, v46, v47
    s_waitcnt vmcnt(9)
    v_mfma_f32_32x32x16_bf16 v[32:47], v[112:115], v[144:147], 0
    v_exp_f32 v48, v48
    v_exp_f32 v49, v49
    v_exp_f32 v50, v50
    v_exp_f32 v51, v51
    v_cvt_pk_bf16_f32 v72, v48, v49
    v_mfma_f32_32x32x16_bf16 v[32:47], v[116:119], v[148:151], v[32:47]
    v_exp_f32 v52, v52
    v_exp_f32 v53, v53
    v_cvt_pk_bf16_f32 v73, v50, v51
    v_exp_f32 v54, v54
    v_exp_f32 v55, v55
    v_cvt_pk_bf16_f32 v74, v52, v53
    v_mfma_f32_32x32x16_bf16 v[224:239], v[104:107], v[64:67], v[224:239]
    v_exp_f32 v56, v56
    v_exp_f32 v57, v57
    v_cvt_pk_bf16_f32 v75, v54, v55
    v_exp_f32 v58, v58
    v_exp_f32 v59, v59
    v_cvt_pk_bf16_f32 v76, v56, v57
    v_mfma_f32_32x32x16_bf16 v[224:239], v[108:111], v[68:71], v[224:239]
    v_exp_f32 v60, v60
    v_exp_f32 v61, v61
    v_cvt_pk_bf16_f32 v77, v58, v59
    v_exp_f32 v62, v62
    v_exp_f32 v63, v63
    v_cvt_pk_bf16_f32 v78, v60, v61
    v_cvt_pk_bf16_f32 v79, v62, v63
    v_mfma_f32_32x32x16_bf16 v[48:63], v[112:115], v[152:155], 0
    ds_add_u32 v25, v27
    v_exp_f32 v32, v32
    v_exp_f32 v33, v33
    v_exp_f32 v34, v34
    v_exp_f32 v35, v35
    v_cvt_pk_bf16_f32 v64, v32, v33
    v_mfma_f32_32x32x16_bf16 v[48:63], v[116:119], v[156:159], v[48:63]
    v_exp_f32 v36, v36
    v_exp_f32 v37, v37
    v_cvt_pk_bf16_f32 v65, v34, v35
    v_exp_f32 v38, v38
    v_exp_f32 v39, v39
    v_cvt_pk_bf16_f32 v66, v36, v37
    v_mfma_f32_32x32x16_bf16 v[240:255], v[104:107], v[72:75], v[240:255]
    v_exp_f32 v40, v40
    v_exp_f32 v41, v41
    v_cvt_pk_bf16_f32 v67, v38, v39
    v_exp_f32 v42, v42
    v_exp_f32 v43, v43
    v_cvt_pk_bf16_f32 v68, v40, v41
    v_mfma_f32_32x32x16_bf16 v[240:255], v[108:111], v[76:79], v[240:255]
    v_exp_f32 v44, v44
    v_exp_f32 v45, v45
    v_cvt_pk_bf16_f32 v69, v42, v43
    v_exp_f32 v46, v46
    v_exp_f32 v47, v47
    v_cvt_pk_bf16_f32 v70, v44, v45
    v_cvt_pk_bf16_f32 v71, v46, v47
    v_mfma_f32_32x32x16_bf16 v[32:47], v[112:115], v[160:163], 0
    buffer_load_dwordx4 v[96:99], v2, s[24:27], s28 offen offset:0 sc1
    v_exp_f32 v48, v48
    v_exp_f32 v49, v49
    v_exp_f32 v50, v50
    v_exp_f32 v51, v51
    v_cvt_pk_bf16_f32 v72, v48, v49
    v_mfma_f32_32x32x16_bf16 v[32:47], v[116:119], v[164:167], v[32:47]
    buffer_load_dwordx4 v[100:103], v2, s[24:27], s28 offen offset:1024 sc1
    v_exp_f32 v52, v52
    v_exp_f32 v53, v53
    v_cvt_pk_bf16_f32 v73, v50, v51
    v_exp_f32 v54, v54
    v_exp_f32 v55, v55
    v_cvt_pk_bf16_f32 v74, v52, v53
    v_mfma_f32_32x32x16_bf16 v[192:207], v[120:123], v[64:67], v[192:207]
    buffer_load_dwordx4 v[104:107], v2, s[24:27], s28 offen offset:2048 sc1
    v_exp_f32 v56, v56
    v_exp_f32 v57, v57
    v_cvt_pk_bf16_f32 v75, v54, v55
    v_exp_f32 v58, v58
    v_exp_f32 v59, v59
    v_cvt_pk_bf16_f32 v76, v56, v57
    v_mfma_f32_32x32x16_bf16 v[192:207], v[124:127], v[68:71], v[192:207]
    buffer_load_dwordx4 v[108:111], v2, s[24:27], s28 offen offset:3072 sc1
    v_exp_f32 v60, v60
    v_exp_f32 v61, v61
    v_cvt_pk_bf16_f32 v77, v58, v59
    v_exp_f32 v62, v62
    v_exp_f32 v63, v63
    v_cvt_pk_bf16_f32 v78, v60, v61
    v_cvt_pk_bf16_f32 v79, v62, v63
    v_mfma_f32_32x32x16_bf16 v[48:63], v[112:115], v[168:171], 0
    v_exp_f32 v32, v32
    v_exp_f32 v33, v33
    v_exp_f32 v34, v34
    v_exp_f32 v35, v35
    v_cvt_pk_bf16_f32 v64, v32, v33
    v_mfma_f32_32x32x16_bf16 v[48:63], v[116:119], v[172:175], v[48:63]
    v_exp_f32 v36, v36
    v_exp_f32 v37, v37
    v_cvt_pk_bf16_f32 v65, v34, v35
    v_exp_f32 v38, v38
    v_exp_f32 v39, v39
    v_cvt_pk_bf16_f32 v66, v36, v37
    v_mfma_f32_32x32x16_bf16 v[208:223], v[120:123], v[72:75], v[208:223]
    v_exp_f32 v40, v40
    v_exp_f32 v41, v41
    v_cvt_pk_bf16_f32 v67, v38, v39
    v_exp_f32 v42, v42
    v_exp_f32 v43, v43
    v_cvt_pk_bf16_f32 v68, v40, v41
    v_mfma_f32_32x32x16_bf16 v[208:223], v[124:127], v[76:79], v[208:223]
    v_exp_f32 v44, v44
    v_exp_f32 v45, v45
    v_cvt_pk_bf16_f32 v69, v42, v43
    v_exp_f32 v46, v46
    v_exp_f32 v47, v47
    v_cvt_pk_bf16_f32 v70, v44, v45
    v_cvt_pk_bf16_f32 v71, v46, v47
    s_waitcnt vmcnt(9)
    v_mfma_f32_32x32x16_bf16 v[32:47], v[128:131], v[144:147], 0
    v_exp_f32 v48, v48
    v_exp_f32 v49, v49
    v_exp_f32 v50, v50
    v_exp_f32 v51, v51
    v_cvt_pk_bf16_f32 v72, v48, v49
    v_mfma_f32_32x32x16_bf16 v[32:47], v[132:135], v[148:151], v[32:47]
    v_exp_f32 v52, v52
    v_exp_f32 v53, v53
    v_cvt_pk_bf16_f32 v73, v50, v51
    v_exp_f32 v54, v54
    v_exp_f32 v55, v55
    v_cvt_pk_bf16_f32 v74, v52, v53
    v_mfma_f32_32x32x16_bf16 v[224:239], v[120:123], v[64:67], v[224:239]
    v_exp_f32 v56, v56
    v_exp_f32 v57, v57
    v_cvt_pk_bf16_f32 v75, v54, v55
    v_exp_f32 v58, v58
    v_exp_f32 v59, v59
    v_cvt_pk_bf16_f32 v76, v56, v57
    v_mfma_f32_32x32x16_bf16 v[224:239], v[124:127], v[68:71], v[224:239]
    v_exp_f32 v60, v60
    v_exp_f32 v61, v61
    v_cvt_pk_bf16_f32 v77, v58, v59
    v_exp_f32 v62, v62
    v_exp_f32 v63, v63
    v_cvt_pk_bf16_f32 v78, v60, v61
    v_cvt_pk_bf16_f32 v79, v62, v63
    v_mfma_f32_32x32x16_bf16 v[48:63], v[128:131], v[152:155], 0
    ds_add_u32 v25, v27
    v_exp_f32 v32, v32
    v_exp_f32 v33, v33
    v_exp_f32 v34, v34
    v_exp_f32 v35, v35
    v_cvt_pk_bf16_f32 v64, v32, v33
    v_mfma_f32_32x32x16_bf16 v[48:63], v[132:135], v[156:159], v[48:63]
    v_exp_f32 v36, v36
    v_exp_f32 v37, v37
    v_cvt_pk_bf16_f32 v65, v34, v35
    v_exp_f32 v38, v38
    v_exp_f32 v39, v39
    v_cvt_pk_bf16_f32 v66, v36, v37
    v_mfma_f32_32x32x16_bf16 v[240:255], v[120:123], v[72:75], v[240:255]
    v_exp_f32 v40, v40
    v_exp_f32 v41, v41
    v_cvt_pk_bf16_f32 v67, v38, v39
    v_exp_f32 v42, v42
    v_exp_f32 v43, v43
    v_cvt_pk_bf16_f32 v68, v40, v41
    v_mfma_f32_32x32x16_bf16 v[240:255], v[124:127], v[76:79], v[240:255]
    v_exp_f32 v44, v44
    v_exp_f32 v45, v45
    v_cvt_pk_bf16_f32 v69, v42, v43
    v_exp_f32 v46, v46
    v_exp_f32 v47, v47
    v_cvt_pk_bf16_f32 v70, v44, v45
    v_cvt_pk_bf16_f32 v71, v46, v47
    v_mfma_f32_32x32x16_bf16 v[32:47], v[128:131], v[160:163], 0
    buffer_load_dwordx4 v[112:115], v2, s[24:27], s29 offen offset:0 sc1
    v_exp_f32 v48, v48
    v_exp_f32 v49, v49
    v_exp_f32 v50, v50
    v_exp_f32 v51, v51
    v_cvt_pk_bf16_f32 v72, v48, v49
    v_mfma_f32_32x32x16_bf16 v[32:47], v[132:135], v[164:167], v[32:47]
    buffer_load_dwordx4 v[116:119], v2, s[24:27], s29 offen offset:1024 sc1
    v_exp_f32 v52, v52
    v_exp_f32 v53, v53
    v_cvt_pk_bf16_f32 v73, v50, v51
    v_exp_f32 v54, v54
    v_exp_f32 v55, v55
    v_cvt_pk_bf16_f32 v74, v52, v53
    v_mfma_f32_32x32x16_bf16 v[192:207], v[136:139], v[64:67], v[192:207]
    buffer_load_dwordx4 v[120:123], v2, s[24:27], s29 offen offset:2048 sc1
    v_exp_f32 v56, v56
    v_exp_f32 v57, v57
    v_cvt_pk_bf16_f32 v75, v54, v55
    v_exp_f32 v58, v58
    v_exp_f32 v59, v59
    v_cvt_pk_bf16_f32 v76, v56, v57
    v_mfma_f32_32x32x16_bf16 v[192:207], v[140:143], v[68:71], v[192:207]
    buffer_load_dwordx4 v[124:127], v2, s[24:27], s29 offen offset:3072 sc1
    v_exp_f32 v60, v60
    v_exp_f32 v61, v61
    v_cvt_pk_bf16_f32 v77, v58, v59
    v_exp_f32 v62, v62
    v_exp_f32 v63, v63
    v_cvt_pk_bf16_f32 v78, v60, v61
    v_cvt_pk_bf16_f32 v79, v62, v63
    v_mfma_f32_32x32x16_bf16 v[48:63], v[128:131], v[168:171], 0
    v_exp_f32 v32, v32
    v_exp_f32 v33, v33
    v_exp_f32 v34, v34
    v_exp_f32 v35, v35
    v_cvt_pk_bf16_f32 v64, v32, v33
    v_mfma_f32_32x32x16_bf16 v[48:63], v[132:135], v[172:175], v[48:63]
    v_exp_f32 v36, v36
    v_exp_f32 v37, v37
    v_cvt_pk_bf16_f32 v65, v34, v35
    v_exp_f32 v38, v38
    v_exp_f32 v39, v39
    v_cvt_pk_bf16_f32 v66, v36, v37
    v_mfma_f32_32x32x16_bf16 v[208:223], v[136:139], v[72:75], v[208:223]
    v_exp_f32 v40, v40
    v_exp_f32 v41, v41
    v_cvt_pk_bf16_f32 v67, v38, v39
    v_exp_f32 v42, v42
    v_exp_f32 v43, v43
    v_cvt_pk_bf16_f32 v68, v40, v41
    v_mfma_f32_32x32x16_bf16 v[208:223], v[140:143], v[76:79], v[208:223]
    v_exp_f32 v44, v44
    v_exp_f32 v45, v45
    v_cvt_pk_bf16_f32 v69, v42, v43
    v_exp_f32 v46, v46
    v_exp_f32 v47, v47
    v_cvt_pk_bf16_f32 v70, v44, v45
    v_cvt_pk_bf16_f32 v71, v46, v47
    s_waitcnt vmcnt(8)
    v_mfma_f32_32x32x16_bf16 v[32:47], v[80:83], v[144:147], 0
    v_exp_f32 v48, v48
    v_exp_f32 v49, v49
    v_exp_f32 v50, v50
    v_exp_f32 v51, v51
    v_cvt_pk_bf16_f32 v72, v48, v49
    v_mfma_f32_32x32x16_bf16 v[32:47], v[84:87], v[148:151], v[32:47]
    v_exp_f32 v52, v52
    v_exp_f32 v53, v53
    v_cvt_pk_bf16_f32 v73, v50, v51
    v_exp_f32 v54, v54
    v_exp_f32 v55, v55
    v_cvt_pk_bf16_f32 v74, v52, v53
    v_mfma_f32_32x32x16_bf16 v[224:239], v[136:139], v[64:67], v[224:239]
    v_exp_f32 v56, v56
    v_exp_f32 v57, v57
    v_cvt_pk_bf16_f32 v75, v54, v55
    v_exp_f32 v58, v58
    v_exp_f32 v59, v59
    v_cvt_pk_bf16_f32 v76, v56, v57
    v_mfma_f32_32x32x16_bf16 v[224:239], v[140:143], v[68:71], v[224:239]
    v_exp_f32 v60, v60
    v_exp_f32 v61, v61
    v_cvt_pk_bf16_f32 v77, v58, v59
    v_exp_f32 v62, v62
    v_exp_f32 v63, v63
    v_cvt_pk_bf16_f32 v78, v60, v61
    v_cvt_pk_bf16_f32 v79, v62, v63
    v_mfma_f32_32x32x16_bf16 v[48:63], v[80:83], v[152:155], 0
    ds_add_u32 v25, v27
    v_exp_f32 v32, v32
    v_exp_f32 v33, v33
    v_exp_f32 v34, v34
    v_exp_f32 v35, v35
    v_cvt_pk_bf16_f32 v64, v32, v33
    v_mfma_f32_32x32x16_bf16 v[48:63], v[84:87], v[156:159], v[48:63]
    v_exp_f32 v36, v36
    v_exp_f32 v37, v37
    v_cvt_pk_bf16_f32 v65, v34, v35
    v_exp_f32 v38, v38
    v_exp_f32 v39, v39
    v_cvt_pk_bf16_f32 v66, v36, v37
    v_mfma_f32_32x32x16_bf16 v[240:255], v[136:139], v[72:75], v[240:255]
    v_exp_f32 v40, v40
    v_exp_f32 v41, v41
    v_cvt_pk_bf16_f32 v67, v38, v39
    v_exp_f32 v42, v42
    v_exp_f32 v43, v43
    v_cvt_pk_bf16_f32 v68, v40, v41
    v_mfma_f32_32x32x16_bf16 v[240:255], v[140:143], v[76:79], v[240:255]
    v_exp_f32 v44, v44
    v_exp_f32 v45, v45
    v_cvt_pk_bf16_f32 v69, v42, v43
    v_exp_f32 v46, v46
    v_exp_f32 v47, v47
    v_cvt_pk_bf16_f32 v70, v44, v45
    v_cvt_pk_bf16_f32 v71, v46, v47
    v_mfma_f32_32x32x16_bf16 v[32:47], v[80:83], v[160:163], 0
    buffer_load_dwordx4 v[128:131], v2, s[24:27], s30 offen offset:0 sc1
    v_exp_f32 v48, v48
    v_exp_f32 v49, v49
    v_exp_f32 v50, v50
    v_exp_f32 v51, v51
    v_cvt_pk_bf16_f32 v72, v48, v49
    v_mfma_f32_32x32x16_bf16 v[32:47], v[84:87], v[164:167], v[32:47]
    buffer_load_dwordx4 v[132:135], v2, s[24:27], s30 offen offset:1024 sc1
    v_exp_f32 v52, v52
    v_exp_f32 v53, v53
    v_cvt_pk_bf16_f32 v73, v50, v51
    v_exp_f32 v54, v54
    v_exp_f32 v55, v55
    v_cvt_pk_bf16_f32 v74, v52, v53
    v_mfma_f32_32x32x16_bf16 v[192:207], v[88:91], v[64:67], v[192:207]
    buffer_load_dwordx4 v[136:139], v2, s[24:27], s30 offen offset:2048 sc1
    v_exp_f32 v56, v56
    v_exp_f32 v57, v57
    v_cvt_pk_bf16_f32 v75, v54, v55
    v_exp_f32 v58, v58
    v_exp_f32 v59, v59
    v_cvt_pk_bf16_f32 v76, v56, v57
    v_mfma_f32_32x32x16_bf16 v[192:207], v[92:95], v[68:71], v[192:207]
    buffer_load_dwordx4 v[140:143], v2, s[24:27], s30 offen offset:3072 sc1
    v_exp_f32 v60, v60
    v_exp_f32 v61, v61
    v_cvt_pk_bf16_f32 v77, v58, v59
    v_exp_f32 v62, v62
    v_exp_f32 v63, v63
    v_cvt_pk_bf16_f32 v78, v60, v61
    v_cvt_pk_bf16_f32 v79, v62, v63
    v_mfma_f32_32x32x16_bf16 v[48:63], v[80:83], v[168:171], 0
    v_exp_f32 v32, v32
    v_exp_f32 v33, v33
    v_exp_f32 v34, v34
    v_exp_f32 v35, v35
    v_cvt_pk_bf16_f32 v64, v32, v33
    v_mfma_f32_32x32x16_bf16 v[48:63], v[84:87], v[172:175], v[48:63]
    v_exp_f32 v36, v36
    v_exp_f32 v37, v37
    v_cvt_pk_bf16_f32 v65, v34, v35
    v_exp_f32 v38, v38
    v_exp_f32 v39, v39
    v_cvt_pk_bf16_f32 v66, v36, v37
    v_mfma_f32_32x32x16_bf16 v[208:223], v[88:91], v[72:75], v[208:223]
    v_exp_f32 v40, v40
    v_exp_f32 v41, v41
    v_cvt_pk_bf16_f32 v67, v38, v39
    v_exp_f32 v42, v42
    v_exp_f32 v43, v43
    v_cvt_pk_bf16_f32 v68, v40, v41
    v_mfma_f32_32x32x16_bf16 v[208:223], v[92:95], v[76:79], v[208:223]
    v_exp_f32 v44, v44
    v_exp_f32 v45, v45
    v_cvt_pk_bf16_f32 v69, v42, v43
    v_exp_f32 v46, v46
    v_exp_f32 v47, v47
    v_cvt_pk_bf16_f32 v70, v44, v45
    v_cvt_pk_bf16_f32 v71, v46, v47
    s_waitcnt vmcnt(8)
    v_mfma_f32_32x32x16_bf16 v[32:47], v[96:99], v[144:147], 0
    v_exp_f32 v48, v48
    v_exp_f32 v49, v49
    v_exp_f32 v50, v50
    v_exp_f32 v51, v51
    v_cvt_pk_bf16_f32 v72, v48, v49
    v_mfma_f32_32x32x16_bf16 v[32:47], v[100:103], v[148:151], v[32:47]
    v_exp_f32 v52, v52
    v_exp_f32 v53, v53
    v_cvt_pk_bf16_f32 v73, v50, v51
    v_exp_f32 v54, v54
    v_exp_f32 v55, v55
    v_cvt_pk_bf16_f32 v74, v52, v53
    v_mfma_f32_32x32x16_bf16 v[224:239], v[88:91], v[64:67], v[224:239]
    v_exp_f32 v56, v56
    v_exp_f32 v57, v57
    v_cvt_pk_bf16_f32 v75, v54, v55
    v_exp_f32 v58, v58
    v_exp_f32 v59, v59
    v_cvt_pk_bf16_f32 v76, v56, v57
    v_mfma_f32_32x32x16_bf16 v[224:239], v[92:95], v[68:71], v[224:239]
    v_exp_f32 v60, v60
    v_exp_f32 v61, v61
    v_cvt_pk_bf16_f32 v77, v58, v59
    v_exp_f32 v62, v62
    v_exp_f32 v63, v63
    v_cvt_pk_bf16_f32 v78, v60, v61
    v_cvt_pk_bf16_f32 v79, v62, v63
    v_mfma_f32_32x32x16_bf16 v[48:63], v[96:99], v[152:155], 0
    ds_add_u32 v25, v27
    v_exp_f32 v32, v32
    v_exp_f32 v33, v33
    v_exp_f32 v34, v34
    v_exp_f32 v35, v35
    v_cvt_pk_bf16_f32 v64, v32, v33
    v_mfma_f32_32x32x16_bf16 v[48:63], v[100:103], v[156:159], v[48:63]
    v_exp_f32 v36, v36
    v_exp_f32 v37, v37
    v_cvt_pk_bf16_f32 v65, v34, v35
    v_exp_f32 v38, v38
    v_exp_f32 v39, v39
    v_cvt_pk_bf16_f32 v66, v36, v37
    v_mfma_f32_32x32x16_bf16 v[240:255], v[88:91], v[72:75], v[240:255]
    v_exp_f32 v40, v40
    v_exp_f32 v41, v41
    v_cvt_pk_bf16_f32 v67, v38, v39
    v_exp_f32 v42, v42
    v_exp_f32 v43, v43
    v_cvt_pk_bf16_f32 v68, v40, v41
    v_mfma_f32_32x32x16_bf16 v[240:255], v[92:95], v[76:79], v[240:255]
    v_exp_f32 v44, v44
    v_exp_f32 v45, v45
    v_cvt_pk_bf16_f32 v69, v42, v43
    v_exp_f32 v46, v46
    v_exp_f32 v47, v47
    v_cvt_pk_bf16_f32 v70, v44, v45
    v_cvt_pk_bf16_f32 v71, v46, v47
    v_mfma_f32_32x32x16_bf16 v[32:47], v[96:99], v[160:163], 0
    buffer_load_dwordx4 v[80:83], v2, s[24:27], s31 offen offset:0 sc1
    v_exp_f32 v48, v48
    v_exp_f32 v49, v49
    v_exp_f32 v50, v50
    v_exp_f32 v51, v51
    v_cvt_pk_bf16_f32 v72, v48, v49
    v_mfma_f32_32x32x16_bf16 v[32:47], v[100:103], v[164:167], v[32:47]
    buffer_load_dwordx4 v[84:87], v2, s[24:27], s31 offen offset:1024 sc1
    v_exp_f32 v52, v52
    v_exp_f32 v53, v53
    v_cvt_pk_bf16_f32 v73, v50, v51
    v_exp_f32 v54, v54
    v_exp_f32 v55, v55
    v_cvt_pk_bf16_f32 v74, v52, v53
    v_mfma_f32_32x32x16_bf16 v[192:207], v[104:107], v[64:67], v[192:207]
    buffer_load_dwordx4 v[88:91], v2, s[24:27], s31 offen offset:2048 sc1
    v_exp_f32 v56, v56
    v_exp_f32 v57, v57
    v_cvt_pk_bf16_f32 v75, v54, v55
    v_exp_f32 v58, v58
    v_exp_f32 v59, v59
    v_cvt_pk_bf16_f32 v76, v56, v57
    v_mfma_f32_32x32x16_bf16 v[192:207], v[108:111], v[68:71], v[192:207]
    buffer_load_dwordx4 v[92:95], v2, s[24:27], s31 offen offset:3072 sc1
    v_exp_f32 v60, v60
    v_exp_f32 v61, v61
    v_cvt_pk_bf16_f32 v77, v58, v59
    v_exp_f32 v62, v62
    v_exp_f32 v63, v63
    v_cvt_pk_bf16_f32 v78, v60, v61
    v_cvt_pk_bf16_f32 v79, v62, v63
    v_mfma_f32_32x32x16_bf16 v[48:63], v[96:99], v[168:171], 0
    v_exp_f32 v32, v32
    v_exp_f32 v33, v33
    v_exp_f32 v34, v34
    v_exp_f32 v35, v35
    v_cvt_pk_bf16_f32 v64, v32, v33
    v_mfma_f32_32x32x16_bf16 v[48:63], v[100:103], v[172:175], v[48:63]
    v_exp_f32 v36, v36
    v_exp_f32 v37, v37
    v_cvt_pk_bf16_f32 v65, v34, v35
    v_exp_f32 v38, v38
    v_exp_f32 v39, v39
    v_cvt_pk_bf16_f32 v66, v36, v37
    v_mfma_f32_32x32x16_bf16 v[208:223], v[104:107], v[72:75], v[208:223]
    v_exp_f32 v40, v40
    v_exp_f32 v41, v41
    v_cvt_pk_bf16_f32 v67, v38, v39
    v_exp_f32 v42, v42
    v_exp_f32 v43, v43
    v_cvt_pk_bf16_f32 v68, v40, v41
    v_mfma_f32_32x32x16_bf16 v[208:223], v[108:111], v[76:79], v[208:223]
    v_exp_f32 v44, v44
    v_exp_f32 v45, v45
    v_cvt_pk_bf16_f32 v69, v42, v43
    v_exp_f32 v46, v46
    v_exp_f32 v47, v47
    v_cvt_pk_bf16_f32 v70, v44, v45
    v_cvt_pk_bf16_f32 v71, v46, v47
    s_waitcnt vmcnt(8)
    v_mfma_f32_32x32x16_bf16 v[32:47], v[112:115], v[144:147], 0
    v_exp_f32 v48, v48
    v_exp_f32 v49, v49
    v_exp_f32 v50, v50
    v_exp_f32 v51, v51
    v_cvt_pk_bf16_f32 v72, v48, v49
    v_mfma_f32_32x32x16_bf16 v[32:47], v[116:119], v[148:151], v[32:47]
    v_exp_f32 v52, v52
    v_exp_f32 v53, v53
    v_cvt_pk_bf16_f32 v73, v50, v51
    v_exp_f32 v54, v54
    v_exp_f32 v55, v55
    v_cvt_pk_bf16_f32 v74, v52, v53
    v_mfma_f32_32x32x16_bf16 v[224:239], v[104:107], v[64:67], v[224:239]
    v_exp_f32 v56, v56
    v_exp_f32 v57, v57
    v_cvt_pk_bf16_f32 v75, v54, v55
    v_exp_f32 v58, v58
    v_exp_f32 v59, v59
    v_cvt_pk_bf16_f32 v76, v56, v57
    v_mfma_f32_32x32x16_bf16 v[224:239], v[108:111], v[68:71], v[224:239]
    v_exp_f32 v60, v60
    v_exp_f32 v61, v61
    v_cvt_pk_bf16_f32 v77, v58, v59
    v_exp_f32 v62, v62
    v_exp_f32 v63, v63
    v_cvt_pk_bf16_f32 v78, v60, v61
    v_cvt_pk_bf16_f32 v79, v62, v63
    v_mfma_f32_32x32x16_bf16 v[48:63], v[112:115], v[152:155], 0
    ds_add_u32 v25, v27
    v_exp_f32 v32, v32
    v_exp_f32 v33, v33
    v_exp_f32 v34, v34
    v_exp_f32 v35, v35
    v_cvt_pk_bf16_f32 v64, v32, v33
    v_mfma_f32_32x32x16_bf16 v[48:63], v[116:119], v[156:159], v[48:63]
    v_exp_f32 v36, v36
    v_exp_f32 v37, v37
    v_cvt_pk_bf16_f32 v65, v34, v35
    v_exp_f32 v38, v38
    v_exp_f32 v39, v39
    v_cvt_pk_bf16_f32 v66, v36, v37
    v_mfma_f32_32x32x16_bf16 v[240:255], v[104:107], v[72:75], v[240:255]
    v_exp_f32 v40, v40
    v_exp_f32 v41, v41
    v_cvt_pk_bf16_f32 v67, v38, v39
    v_exp_f32 v42, v42
    v_exp_f32 v43, v43
    v_cvt_pk_bf16_f32 v68, v40, v41
    v_mfma_f32_32x32x16_bf16 v[240:255], v[108:111], v[76:79], v[240:255]
    v_exp_f32 v44, v44
    v_exp_f32 v45, v45
    v_cvt_pk_bf16_f32 v69, v42, v43
    v_exp_f32 v46, v46
    v_exp_f32 v47, v47
    v_cvt_pk_bf16_f32 v70, v44, v45
    v_cvt_pk_bf16_f32 v71, v46, v47
    v_mfma_f32_32x32x16_bf16 v[32:47], v[112:115], v[160:163], 0
    buffer_load_dwordx4 v[96:99], v2, s[24:27], s64 offen offset:0 sc1
    v_exp_f32 v48, v48
    v_exp_f32 v49, v49
    v_exp_f32 v50, v50
    v_exp_f32 v51, v51
    v_cvt_pk_bf16_f32 v72, v48, v49
    v_mfma_f32_32x32x16_bf16 v[32:47], v[116:119], v[164:167], v[32:47]
    buffer_load_dwordx4 v[100:103], v2, s[24:27], s64 offen offset:1024 sc1
    v_exp_f32 v52, v52
    v_exp_f32 v53, v53
    v_cvt_pk_bf16_f32 v73, v50, v51
    v_exp_f32 v54, v54
    v_exp_f32 v55, v55
    v_cvt_pk_bf16_f32 v74, v52, v53
    v_mfma_f32_32x32x16_bf16 v[192:207], v[120:123], v[64:67], v[192:207]
    buffer_load_dwordx4 v[104:107], v2, s[24:27], s64 offen offset:2048 sc1
    v_exp_f32 v56, v56
    v_exp_f32 v57, v57
    v_cvt_pk_bf16_f32 v75, v54, v55
    v_exp_f32 v58, v58
    v_exp_f32 v59, v59
    v_cvt_pk_bf16_f32 v76, v56, v57
    v_mfma_f32_32x32x16_bf16 v[192:207], v[124:127], v[68:71], v[192:207]
    buffer_load_dwordx4 v[108:111], v2, s[24:27], s64 offen offset:3072 sc1
    v_exp_f32 v60, v60
    v_exp_f32 v61, v61
    v_cvt_pk_bf16_f32 v77, v58, v59
    v_exp_f32 v62, v62
    v_exp_f32 v63, v63
    v_cvt_pk_bf16_f32 v78, v60, v61
    v_cvt_pk_bf16_f32 v79, v62, v63
    v_mfma_f32_32x32x16_bf16 v[48:63], v[112:115], v[168:171], 0
    v_exp_f32 v32, v32
    v_exp_f32 v33, v33
    v_exp_f32 v34, v34
    v_exp_f32 v35, v35
    v_cvt_pk_bf16_f32 v64, v32, v33
    v_mfma_f32_32x32x16_bf16 v[48:63], v[116:119], v[172:175], v[48:63]
    v_exp_f32 v36, v36
    v_exp_f32 v37, v37
    v_cvt_pk_bf16_f32 v65, v34, v35
    v_exp_f32 v38, v38
    v_exp_f32 v39, v39
    v_cvt_pk_bf16_f32 v66, v36, v37
    v_mfma_f32_32x32x16_bf16 v[208:223], v[120:123], v[72:75], v[208:223]
    v_exp_f32 v40, v40
    v_exp_f32 v41, v41
    v_cvt_pk_bf16_f32 v67, v38, v39
    v_exp_f32 v42, v42
    v_exp_f32 v43, v43
    v_cvt_pk_bf16_f32 v68, v40, v41
    v_mfma_f32_32x32x16_bf16 v[208:223], v[124:127], v[76:79], v[208:223]
    v_exp_f32 v44, v44
    v_exp_f32 v45, v45
    v_cvt_pk_bf16_f32 v69, v42, v43
    v_exp_f32 v46, v46
    v_exp_f32 v47, v47
    v_cvt_pk_bf16_f32 v70, v44, v45
    v_cvt_pk_bf16_f32 v71, v46, v47
    s_waitcnt vmcnt(8)
    v_mfma_f32_32x32x16_bf16 v[32:47], v[128:131], v[144:147], 0
    v_exp_f32 v48, v48
    v_exp_f32 v49, v49
    v_exp_f32 v50, v50
    v_exp_f32 v51, v51
    v_cvt_pk_bf16_f32 v72, v48, v49
    v_mfma_f32_32x32x16_bf16 v[32:47], v[132:135], v[148:151], v[32:47]
    v_exp_f32 v52, v52
    v_exp_f32 v53, v53
    v_cvt_pk_bf16_f32 v73, v50, v51
    v_exp_f32 v54, v54
    v_exp_f32 v55, v55
    v_cvt_pk_bf16_f32 v74, v52, v53
    v_mfma_f32_32x32x16_bf16 v[224:239], v[120:123], v[64:67], v[224:239]
    v_exp_f32 v56, v56
    v_exp_f32 v57, v57
    v_cvt_pk_bf16_f32 v75, v54, v55
    v_exp_f32 v58, v58
    v_exp_f32 v59, v59
    v_cvt_pk_bf16_f32 v76, v56, v57
    v_mfma_f32_32x32x16_bf16 v[224:239], v[124:127], v[68:71], v[224:239]
    v_exp_f32 v60, v60
    v_exp_f32 v61, v61
    v_cvt_pk_bf16_f32 v77, v58, v59
    v_exp_f32 v62, v62
    v_exp_f32 v63, v63
    v_cvt_pk_bf16_f32 v78, v60, v61
    v_cvt_pk_bf16_f32 v79, v62, v63
    v_mfma_f32_32x32x16_bf16 v[48:63], v[128:131], v[152:155], 0
    ds_add_u32 v25, v27
    v_exp_f32 v32, v32
    v_exp_f32 v33, v33
    v_exp_f32 v34, v34
    v_exp_f32 v35, v35
    v_cvt_pk_bf16_f32 v64, v32, v33
    v_mfma_f32_32x32x16_bf16 v[48:63], v[132:135], v[156:159], v[48:63]
    v_exp_f32 v36, v36
    v_exp_f32 v37, v37
    v_cvt_pk_bf16_f32 v65, v34, v35
    v_exp_f32 v38, v38
    v_exp_f32 v39, v39
    v_cvt_pk_bf16_f32 v66, v36, v37
    v_mfma_f32_32x32x16_bf16 v[240:255], v[120:123], v[72:75], v[240:255]
    v_exp_f32 v40, v40
    v_exp_f32 v41, v41
    v_cvt_pk_bf16_f32 v67, v38, v39
    v_exp_f32 v42, v42
    v_exp_f32 v43, v43
    v_cvt_pk_bf16_f32 v68, v40, v41
    v_mfma_f32_32x32x16_bf16 v[240:255], v[124:127], v[76:79], v[240:255]
    v_exp_f32 v44, v44
    v_exp_f32 v45, v45
    v_cvt_pk_bf16_f32 v69, v42, v43
    v_exp_f32 v46, v46
    v_exp_f32 v47, v47
    v_cvt_pk_bf16_f32 v70, v44, v45
    v_cvt_pk_bf16_f32 v71, v46, v47
    v_mfma_f32_32x32x16_bf16 v[32:47], v[128:131], v[160:163], 0
    buffer_load_dwordx4 v[112:115], v2, s[24:27], s65 offen offset:0 sc1
    v_exp_f32 v48, v48
    v_exp_f32 v49, v49
    v_exp_f32 v50, v50
    v_exp_f32 v51, v51
    v_cvt_pk_bf16_f32 v72, v48, v49
    v_mfma_f32_32x32x16_bf16 v[32:47], v[132:135], v[164:167], v[32:47]
    buffer_load_dwordx4 v[116:119], v2, s[24:27], s65 offen offset:1024 sc1
    v_exp_f32 v52, v52
    v_exp_f32 v53, v53
    v_cvt_pk_bf16_f32 v73, v50, v51
    v_exp_f32 v54, v54
    v_exp_f32 v55, v55
    v_cvt_pk_bf16_f32 v74, v52, v53
    v_mfma_f32_32x32x16_bf16 v[192:207], v[136:139], v[64:67], v[192:207]
    buffer_load_dwordx4 v[120:123], v2, s[24:27], s65 offen offset:2048 sc1
    v_exp_f32 v56, v56
    v_exp_f32 v57, v57
    v_cvt_pk_bf16_f32 v75, v54, v55
    v_exp_f32 v58, v58
    v_exp_f32 v59, v59
    v_cvt_pk_bf16_f32 v76, v56, v57
    v_mfma_f32_32x32x16_bf16 v[192:207], v[140:143], v[68:71], v[192:207]
    buffer_load_dwordx4 v[124:127], v2, s[24:27], s65 offen offset:3072 sc1
    v_exp_f32 v60, v60
    v_exp_f32 v61, v61
    v_cvt_pk_bf16_f32 v77, v58, v59
    v_exp_f32 v62, v62
    v_exp_f32 v63, v63
    v_cvt_pk_bf16_f32 v78, v60, v61
    v_cvt_pk_bf16_f32 v79, v62, v63
    v_mfma_f32_32x32x16_bf16 v[48:63], v[128:131], v[168:171], 0
    v_exp_f32 v32, v32
    v_exp_f32 v33, v33
    v_exp_f32 v34, v34
    v_exp_f32 v35, v35
    v_cvt_pk_bf16_f32 v64, v32, v33
    v_mfma_f32_32x32x16_bf16 v[48:63], v[132:135], v[172:175], v[48:63]
    v_exp_f32 v36, v36
    v_exp_f32 v37, v37
    v_cvt_pk_bf16_f32 v65, v34, v35
    v_exp_f32 v38, v38
    v_exp_f32 v39, v39
    v_cvt_pk_bf16_f32 v66, v36, v37
    v_mfma_f32_32x32x16_bf16 v[208:223], v[136:139], v[72:75], v[208:223]
    v_exp_f32 v40, v40
    v_exp_f32 v41, v41
    v_cvt_pk_bf16_f32 v67, v38, v39
    v_exp_f32 v42, v42
    v_exp_f32 v43, v43
    v_cvt_pk_bf16_f32 v68, v40, v41
    v_mfma_f32_32x32x16_bf16 v[208:223], v[140:143], v[76:79], v[208:223]
    v_exp_f32 v44, v44
    v_exp_f32 v45, v45
    v_cvt_pk_bf16_f32 v69, v42, v43
    v_exp_f32 v46, v46
    v_exp_f32 v47, v47
    v_cvt_pk_bf16_f32 v70, v44, v45
    v_cvt_pk_bf16_f32 v71, v46, v47
    s_waitcnt vmcnt(8)
    v_mfma_f32_32x32x16_bf16 v[32:47], v[80:83], v[144:147], 0
    v_exp_f32 v48, v48
    v_exp_f32 v49, v49
    v_exp_f32 v50, v50
    v_exp_f32 v51, v51
    v_cvt_pk_bf16_f32 v72, v48, v49
    v_mfma_f32_32x32x16_bf16 v[32:47], v[84:87], v[148:151], v[32:47]
    v_exp_f32 v52, v52
    v_exp_f32 v53, v53
    v_cvt_pk_bf16_f32 v73, v50, v51
    v_exp_f32 v54, v54
    v_exp_f32 v55, v55
    v_cvt_pk_bf16_f32 v74, v52, v53
    v_mfma_f32_32x32x16_bf16 v[224:239], v[136:139], v[64:67], v[224:239]
    v_exp_f32 v56, v56
    v_exp_f32 v57, v57
    v_cvt_pk_bf16_f32 v75, v54, v55
    v_exp_f32 v58, v58
    v_exp_f32 v59, v59
    v_cvt_pk_bf16_f32 v76, v56, v57
    v_mfma_f32_32x32x16_bf16 v[224:239], v[140:143], v[68:71], v[224:239]
    v_exp_f32 v60, v60
    v_exp_f32 v61, v61
    v_cvt_pk_bf16_f32 v77, v58, v59
    v_exp_f32 v62, v62
    v_exp_f32 v63, v63
    v_cvt_pk_bf16_f32 v78, v60, v61
    v_cvt_pk_bf16_f32 v79, v62, v63
    v_mfma_f32_32x32x16_bf16 v[48:63], v[80:83], v[152:155], 0
    ds_add_u32 v25, v27
    v_exp_f32 v32, v32
    v_exp_f32 v33, v33
    v_exp_f32 v34, v34
    v_exp_f32 v35, v35
    v_cvt_pk_bf16_f32 v64, v32, v33
    v_mfma_f32_32x32x16_bf16 v[48:63], v[84:87], v[156:159], v[48:63]
    v_exp_f32 v36, v36
    v_exp_f32 v37, v37
    v_cvt_pk_bf16_f32 v65, v34, v35
    v_exp_f32 v38, v38
    v_exp_f32 v39, v39
    v_cvt_pk_bf16_f32 v66, v36, v37
    v_mfma_f32_32x32x16_bf16 v[240:255], v[136:139], v[72:75], v[240:255]
    v_exp_f32 v40, v40
    v_exp_f32 v41, v41
    v_cvt_pk_bf16_f32 v67, v38, v39
    v_exp_f32 v42, v42
    v_exp_f32 v43, v43
    v_cvt_pk_bf16_f32 v68, v40, v41
    v_mfma_f32_32x32x16_bf16 v[240:255], v[140:143], v[76:79], v[240:255]
    v_exp_f32 v44, v44
    v_exp_f32 v45, v45
    v_cvt_pk_bf16_f32 v69, v42, v43
    v_exp_f32 v46, v46
    v_exp_f32 v47, v47
    v_cvt_pk_bf16_f32 v70, v44, v45
    v_cvt_pk_bf16_f32 v71, v46, v47
    v_mfma_f32_32x32x16_bf16 v[32:47], v[80:83], v[160:163], 0
    buffer_load_dwordx4 v[128:131], v2, s[24:27], s66 offen offset:0 sc1
    v_exp_f32 v48, v48
    v_exp_f32 v49, v49
    v_exp_f32 v50, v50
    v_exp_f32 v51, v51
    v_cvt_pk_bf16_f32 v72, v48, v49
    v_mfma_f32_32x32x16_bf16 v[32:47], v[84:87], v[164:167], v[32:47]
    buffer_load_dwordx4 v[132:135], v2, s[24:27], s66 offen offset:1024 sc1
    v_exp_f32 v52, v52
    v_exp_f32 v53, v53
    v_cvt_pk_bf16_f32 v73, v50, v51
    v_exp_f32 v54, v54
    v_exp_f32 v55, v55
    v_cvt_pk_bf16_f32 v74, v52, v53
    v_mfma_f32_32x32x16_bf16 v[192:207], v[88:91], v[64:67], v[192:207]
    buffer_load_dwordx4 v[136:139], v2, s[24:27], s66 offen offset:2048 sc1
    v_exp_f32 v56, v56
    v_exp_f32 v57, v57
    v_cvt_pk_bf16_f32 v75, v54, v55
    v_exp_f32 v58, v58
    v_exp_f32 v59, v59
    v_cvt_pk_bf16_f32 v76, v56, v57
    v_mfma_f32_32x32x16_bf16 v[192:207], v[92:95], v[68:71], v[192:207]
    buffer_load_dwordx4 v[140:143], v2, s[24:27], s66 offen offset:3072 sc1
    v_exp_f32 v60, v60
    v_exp_f32 v61, v61
    v_cvt_pk_bf16_f32 v77, v58, v59
    v_exp_f32 v62, v62
    v_exp_f32 v63, v63
    v_cvt_pk_bf16_f32 v78, v60, v61
    v_cvt_pk_bf16_f32 v79, v62, v63
    v_mfma_f32_32x32x16_bf16 v[48:63], v[80:83], v[168:171], 0
    v_exp_f32 v32, v32
    v_exp_f32 v33, v33
    v_exp_f32 v34, v34
    v_exp_f32 v35, v35
    v_cvt_pk_bf16_f32 v64, v32, v33
    v_mfma_f32_32x32x16_bf16 v[48:63], v[84:87], v[172:175], v[48:63]
    v_exp_f32 v36, v36
    v_exp_f32 v37, v37
    v_cvt_pk_bf16_f32 v65, v34, v35
    v_exp_f32 v38, v38
    v_exp_f32 v39, v39
    v_cvt_pk_bf16_f32 v66, v36, v37
    v_mfma_f32_32x32x16_bf16 v[208:223], v[88:91], v[72:75], v[208:223]
    v_exp_f32 v40, v40
    v_exp_f32 v41, v41
    v_cvt_pk_bf16_f32 v67, v38, v39
    v_exp_f32 v42, v42
    v_exp_f32 v43, v43
    v_cvt_pk_bf16_f32 v68, v40, v41
    v_mfma_f32_32x32x16_bf16 v[208:223], v[92:95], v[76:79], v[208:223]
    v_exp_f32 v44, v44
    v_exp_f32 v45, v45
    v_cvt_pk_bf16_f32 v69, v42, v43
    v_exp_f32 v46, v46
    v_exp_f32 v47, v47
    v_cvt_pk_bf16_f32 v70, v44, v45
    v_cvt_pk_bf16_f32 v71, v46, v47
    s_waitcnt vmcnt(8)
    v_mfma_f32_32x32x16_bf16 v[32:47], v[96:99], v[144:147], 0
    v_exp_f32 v48, v48
    v_exp_f32 v49, v49
    v_exp_f32 v50, v50
    v_exp_f32 v51, v51
    v_cvt_pk_bf16_f32 v72, v48, v49
    v_mfma_f32_32x32x16_bf16 v[32:47], v[100:103], v[148:151], v[32:47]
    v_exp_f32 v52, v52
    v_exp_f32 v53, v53
    v_cvt_pk_bf16_f32 v73, v50, v51
    v_exp_f32 v54, v54
    v_exp_f32 v55, v55
    v_cvt_pk_bf16_f32 v74, v52, v53
    v_mfma_f32_32x32x16_bf16 v[224:239], v[88:91], v[64:67], v[224:239]
    v_exp_f32 v56, v56
    v_exp_f32 v57, v57
    v_cvt_pk_bf16_f32 v75, v54, v55
    v_exp_f32 v58, v58
    v_exp_f32 v59, v59
    v_cvt_pk_bf16_f32 v76, v56, v57
    v_mfma_f32_32x32x16_bf16 v[224:239], v[92:95], v[68:71], v[224:239]
    v_exp_f32 v60, v60
    v_exp_f32 v61, v61
    v_cvt_pk_bf16_f32 v77, v58, v59
    v_exp_f32 v62, v62
    v_exp_f32 v63, v63
    v_cvt_pk_bf16_f32 v78, v60, v61
    v_cvt_pk_bf16_f32 v79, v62, v63
    v_mfma_f32_32x32x16_bf16 v[48:63], v[96:99], v[152:155], 0
    ds_add_u32 v25, v27
    v_exp_f32 v32, v32
    v_exp_f32 v33, v33
    v_exp_f32 v34, v34
    v_exp_f32 v35, v35
    v_cvt_pk_bf16_f32 v64, v32, v33
    v_mfma_f32_32x32x16_bf16 v[48:63], v[100:103], v[156:159], v[48:63]
    v_exp_f32 v36, v36
    v_exp_f32 v37, v37
    v_cvt_pk_bf16_f32 v65, v34, v35
    v_exp_f32 v38, v38
    v_exp_f32 v39, v39
    v_cvt_pk_bf16_f32 v66, v36, v37
    v_mfma_f32_32x32x16_bf16 v[240:255], v[88:91], v[72:75], v[240:255]
    v_exp_f32 v40, v40
    v_exp_f32 v41, v41
    v_cvt_pk_bf16_f32 v67, v38, v39
    v_exp_f32 v42, v42
    v_exp_f32 v43, v43
    v_cvt_pk_bf16_f32 v68, v40, v41
    v_mfma_f32_32x32x16_bf16 v[240:255], v[92:95], v[76:79], v[240:255]
    v_exp_f32 v44, v44
    v_exp_f32 v45, v45
    v_cvt_pk_bf16_f32 v69, v42, v43
    v_exp_f32 v46, v46
    v_exp_f32 v47, v47
    v_cvt_pk_bf16_f32 v70, v44, v45
    v_cvt_pk_bf16_f32 v71, v46, v47
    v_mfma_f32_32x32x16_bf16 v[32:47], v[96:99], v[160:163], 0
    buffer_load_dwordx4 v[80:83], v2, s[24:27], s67 offen offset:0 sc1
    v_exp_f32 v48, v48
    v_exp_f32 v49, v49
    v_exp_f32 v50, v50
    v_exp_f32 v51, v51
    v_cvt_pk_bf16_f32 v72, v48, v49
    v_mfma_f32_32x32x16_bf16 v[32:47], v[100:103], v[164:167], v[32:47]
    buffer_load_dwordx4 v[84:87], v2, s[24:27], s67 offen offset:1024 sc1
    v_exp_f32 v52, v52
    v_exp_f32 v53, v53
    v_cvt_pk_bf16_f32 v73, v50, v51
    v_exp_f32 v54, v54
    v_exp_f32 v55, v55
    v_cvt_pk_bf16_f32 v74, v52, v53
    v_mfma_f32_32x32x16_bf16 v[192:207], v[104:107], v[64:67], v[192:207]
    buffer_load_dwordx4 v[88:91], v2, s[24:27], s67 offen offset:2048 sc1
    v_exp_f32 v56, v56
    v_exp_f32 v57, v57
    v_cvt_pk_bf16_f32 v75, v54, v55
    v_exp_f32 v58, v58
    v_exp_f32 v59, v59
    v_cvt_pk_bf16_f32 v76, v56, v57
    v_mfma_f32_32x32x16_bf16 v[192:207], v[108:111], v[68:71], v[192:207]
    buffer_load_dwordx4 v[92:95], v2, s[24:27], s67 offen offset:3072 sc1
    v_exp_f32 v60, v60
    v_exp_f32 v61, v61
    v_cvt_pk_bf16_f32 v77, v58, v59
    v_exp_f32 v62, v62
    v_exp_f32 v63, v63
    v_cvt_pk_bf16_f32 v78, v60, v61
    v_cvt_pk_bf16_f32 v79, v62, v63
    v_mfma_f32_32x32x16_bf16 v[48:63], v[96:99], v[168:171], 0
    v_exp_f32 v32, v32
    v_exp_f32 v33, v33
    v_exp_f32 v34, v34
    v_exp_f32 v35, v35
    v_cvt_pk_bf16_f32 v64, v32, v33
    v_mfma_f32_32x32x16_bf16 v[48:63], v[100:103], v[172:175], v[48:63]
    v_exp_f32 v36, v36
    v_exp_f32 v37, v37
    v_cvt_pk_bf16_f32 v65, v34, v35
    v_exp_f32 v38, v38
    v_exp_f32 v39, v39
    v_cvt_pk_bf16_f32 v66, v36, v37
    v_mfma_f32_32x32x16_bf16 v[208:223], v[104:107], v[72:75], v[208:223]
    v_exp_f32 v40, v40
    v_exp_f32 v41, v41
    v_cvt_pk_bf16_f32 v67, v38, v39
    v_exp_f32 v42, v42
    v_exp_f32 v43, v43
    v_cvt_pk_bf16_f32 v68, v40, v41
    v_mfma_f32_32x32x16_bf16 v[208:223], v[108:111], v[76:79], v[208:223]
    v_exp_f32 v44, v44
    v_exp_f32 v45, v45
    v_cvt_pk_bf16_f32 v69, v42, v43
    v_exp_f32 v46, v46
    v_exp_f32 v47, v47
    v_cvt_pk_bf16_f32 v70, v44, v45
    v_cvt_pk_bf16_f32 v71, v46, v47
    s_waitcnt vmcnt(8)
    v_mfma_f32_32x32x16_bf16 v[32:47], v[112:115], v[144:147], 0
    v_exp_f32 v48, v48
    v_exp_f32 v49, v49
    v_exp_f32 v50, v50
    v_exp_f32 v51, v51
    v_cvt_pk_bf16_f32 v72, v48, v49
    v_mfma_f32_32x32x16_bf16 v[32:47], v[116:119], v[148:151], v[32:47]
    v_exp_f32 v52, v52
    v_exp_f32 v53, v53
    v_cvt_pk_bf16_f32 v73, v50, v51
    v_exp_f32 v54, v54
    v_exp_f32 v55, v55
    v_cvt_pk_bf16_f32 v74, v52, v53
    v_mfma_f32_32x32x16_bf16 v[224:239], v[104:107], v[64:67], v[224:239]
    v_exp_f32 v56, v56
    v_exp_f32 v57, v57
    v_cvt_pk_bf16_f32 v75, v54, v55
    v_exp_f32 v58, v58
    v_exp_f32 v59, v59
    v_cvt_pk_bf16_f32 v76, v56, v57
    v_mfma_f32_32x32x16_bf16 v[224:239], v[108:111], v[68:71], v[224:239]
    v_exp_f32 v60, v60
    v_exp_f32 v61, v61
    v_cvt_pk_bf16_f32 v77, v58, v59
    v_exp_f32 v62, v62
    v_exp_f32 v63, v63
    v_cvt_pk_bf16_f32 v78, v60, v61
    v_cvt_pk_bf16_f32 v79, v62, v63
    v_mfma_f32_32x32x16_bf16 v[48:63], v[112:115], v[152:155], 0
    ds_add_u32 v25, v27
    v_exp_f32 v32, v32
    v_exp_f32 v33, v33
    v_exp_f32 v34, v34
    v_exp_f32 v35, v35
    v_cvt_pk_bf16_f32 v64, v32, v33
    v_mfma_f32_32x32x16_bf16 v[48:63], v[116:119], v[156:159], v[48:63]
    v_exp_f32 v36, v36
    v_exp_f32 v37, v37
    v_cvt_pk_bf16_f32 v65, v34, v35
    v_exp_f32 v38, v38
    v_exp_f32 v39, v39
    v_cvt_pk_bf16_f32 v66, v36, v37
    v_mfma_f32_32x32x16_bf16 v[240:255], v[104:107], v[72:75], v[240:255]
    v_exp_f32 v40, v40
    v_exp_f32 v41, v41
    v_cvt_pk_bf16_f32 v67, v38, v39
    v_exp_f32 v42, v42
    v_exp_f32 v43, v43
    v_cvt_pk_bf16_f32 v68, v40, v41
    v_mfma_f32_32x32x16_bf16 v[240:255], v[108:111], v[76:79], v[240:255]
    v_exp_f32 v44, v44
    v_exp_f32 v45, v45
    v_cvt_pk_bf16_f32 v69, v42, v43
    v_exp_f32 v46, v46
    v_exp_f32 v47, v47
    v_cvt_pk_bf16_f32 v70, v44, v45
    v_cvt_pk_bf16_f32 v71, v46, v47
    v_mfma_f32_32x32x16_bf16 v[32:47], v[112:115], v[160:163], 0
    v_exp_f32 v48, v48
    v_exp_f32 v49, v49
    v_exp_f32 v50, v50
    v_exp_f32 v51, v51
    v_cvt_pk_bf16_f32 v72, v48, v49
    v_mfma_f32_32x32x16_bf16 v[32:47], v[116:119], v[164:167], v[32:47]
    v_exp_f32 v52, v52
    v_exp_f32 v53, v53
    v_cvt_pk_bf16_f32 v73, v50, v51
    v_exp_f32 v54, v54
    v_exp_f32 v55, v55
    v_cvt_pk_bf16_f32 v74, v52, v53
    v_mfma_f32_32x32x16_bf16 v[192:207], v[120:123], v[64:67], v[192:207]
    v_exp_f32 v56, v56
    v_exp_f32 v57, v57
    v_cvt_pk_bf16_f32 v75, v54, v55
    v_exp_f32 v58, v58
    v_exp_f32 v59, v59
    v_cvt_pk_bf16_f32 v76, v56, v57
    v_mfma_f32_32x32x16_bf16 v[192:207], v[124:127], v[68:71], v[192:207]
    v_exp_f32 v60, v60
    v_exp_f32 v61, v61
    v_cvt_pk_bf16_f32 v77, v58, v59
    v_exp_f32 v62, v62
    v_exp_f32 v63, v63
    v_cvt_pk_bf16_f32 v78, v60, v61
    v_cvt_pk_bf16_f32 v79, v62, v63
    v_mfma_f32_32x32x16_bf16 v[48:63], v[112:115], v[168:171], 0
    v_exp_f32 v32, v32
    v_exp_f32 v33, v33
    v_exp_f32 v34, v34
    v_exp_f32 v35, v35
    v_cvt_pk_bf16_f32 v64, v32, v33
    v_mfma_f32_32x32x16_bf16 v[48:63], v[116:119], v[172:175], v[48:63]
    v_exp_f32 v36, v36
    v_exp_f32 v37, v37
    v_cvt_pk_bf16_f32 v65, v34, v35
    v_exp_f32 v38, v38
    v_exp_f32 v39, v39
    v_cvt_pk_bf16_f32 v66, v36, v37
    v_mfma_f32_32x32x16_bf16 v[208:223], v[120:123], v[72:75], v[208:223]
    v_exp_f32 v40, v40
    v_exp_f32 v41, v41
    v_cvt_pk_bf16_f32 v67, v38, v39
    v_exp_f32 v42, v42
    v_exp_f32 v43, v43
    v_cvt_pk_bf16_f32 v68, v40, v41
    v_mfma_f32_32x32x16_bf16 v[208:223], v[124:127], v[76:79], v[208:223]
    v_exp_f32 v44, v44
    v_exp_f32 v45, v45
    v_cvt_pk_bf16_f32 v69, v42, v43
    v_exp_f32 v46, v46
    v_exp_f32 v47, v47
    v_cvt_pk_bf16_f32 v70, v44, v45
    v_cvt_pk_bf16_f32 v71, v46, v47
    s_waitcnt vmcnt(4)
    v_mfma_f32_32x32x16_bf16 v[32:47], v[128:131], v[144:147], 0
    v_exp_f32 v48, v48
    v_exp_f32 v49, v49
    v_exp_f32 v50, v50
    v_exp_f32 v51, v51
    v_cvt_pk_bf16_f32 v72, v48, v49
    v_mfma_f32_32x32x16_bf16 v[32:47], v[132:135], v[148:151], v[32:47]
    v_exp_f32 v52, v52
    v_exp_f32 v53, v53
    v_cvt_pk_bf16_f32 v73, v50, v51
    v_exp_f32 v54, v54
    v_exp_f32 v55, v55
    v_cvt_pk_bf16_f32 v74, v52, v53
    v_mfma_f32_32x32x16_bf16 v[224:239], v[120:123], v[64:67], v[224:239]
    v_exp_f32 v56, v56
    v_exp_f32 v57, v57
    v_cvt_pk_bf16_f32 v75, v54, v55
    v_exp_f32 v58, v58
    v_exp_f32 v59, v59
    v_cvt_pk_bf16_f32 v76, v56, v57
    v_mfma_f32_32x32x16_bf16 v[224:239], v[124:127], v[68:71], v[224:239]
    v_exp_f32 v60, v60
    v_exp_f32 v61, v61
    v_cvt_pk_bf16_f32 v77, v58, v59
    v_exp_f32 v62, v62
    v_exp_f32 v63, v63
    v_cvt_pk_bf16_f32 v78, v60, v61
    v_cvt_pk_bf16_f32 v79, v62, v63
    v_mfma_f32_32x32x16_bf16 v[48:63], v[128:131], v[152:155], 0
    ds_add_u32 v25, v27
    v_exp_f32 v32, v32
    v_exp_f32 v33, v33
    v_exp_f32 v34, v34
    v_exp_f32 v35, v35
    v_cvt_pk_bf16_f32 v64, v32, v33
    v_mfma_f32_32x32x16_bf16 v[48:63], v[132:135], v[156:159], v[48:63]
    v_exp_f32 v36, v36
    v_exp_f32 v37, v37
    v_cvt_pk_bf16_f32 v65, v34, v35
    v_exp_f32 v38, v38
    v_exp_f32 v39, v39
    v_cvt_pk_bf16_f32 v66, v36, v37
    v_mfma_f32_32x32x16_bf16 v[240:255], v[120:123], v[72:75], v[240:255]
    v_exp_f32 v40, v40
    v_exp_f32 v41, v41
    v_cvt_pk_bf16_f32 v67, v38, v39
    v_exp_f32 v42, v42
    v_exp_f32 v43, v43
    v_cvt_pk_bf16_f32 v68, v40, v41
    v_mfma_f32_32x32x16_bf16 v[240:255], v[124:127], v[76:79], v[240:255]
    v_exp_f32 v44, v44
    v_exp_f32 v45, v45
    v_cvt_pk_bf16_f32 v69, v42, v43
    v_exp_f32 v46, v46
    v_exp_f32 v47, v47
    v_cvt_pk_bf16_f32 v70, v44, v45
    v_cvt_pk_bf16_f32 v71, v46, v47
    v_mfma_f32_32x32x16_bf16 v[32:47], v[128:131], v[160:163], 0
    v_exp_f32 v48, v48
    v_exp_f32 v49, v49
    v_exp_f32 v50, v50
    v_exp_f32 v51, v51
    v_cvt_pk_bf16_f32 v72, v48, v49
    v_mfma_f32_32x32x16_bf16 v[32:47], v[132:135], v[164:167], v[32:47]
    v_exp_f32 v52, v52
    v_exp_f32 v53, v53
    v_cvt_pk_bf16_f32 v73, v50, v51
    v_exp_f32 v54, v54
    v_exp_f32 v55, v55
    v_cvt_pk_bf16_f32 v74, v52, v53
    v_mfma_f32_32x32x16_bf16 v[192:207], v[136:139], v[64:67], v[192:207]
    v_exp_f32 v56, v56
    v_exp_f32 v57, v57
    v_cvt_pk_bf16_f32 v75, v54, v55
    v_exp_f32 v58, v58
    v_exp_f32 v59, v59
    v_cvt_pk_bf16_f32 v76, v56, v57
    v_mfma_f32_32x32x16_bf16 v[192:207], v[140:143], v[68:71], v[192:207]
    v_exp_f32 v60, v60
    v_exp_f32 v61, v61
    v_cvt_pk_bf16_f32 v77, v58, v59
    v_exp_f32 v62, v62
    v_exp_f32 v63, v63
    v_cvt_pk_bf16_f32 v78, v60, v61
    v_cvt_pk_bf16_f32 v79, v62, v63
    v_mfma_f32_32x32x16_bf16 v[48:63], v[128:131], v[168:171], 0
    v_exp_f32 v32, v32
    v_exp_f32 v33, v33
    v_exp_f32 v34, v34
    v_exp_f32 v35, v35
    v_cvt_pk_bf16_f32 v64, v32, v33
    v_mfma_f32_32x32x16_bf16 v[48:63], v[132:135], v[172:175], v[48:63]
    v_exp_f32 v36, v36
    v_exp_f32 v37, v37
    v_cvt_pk_bf16_f32 v65, v34, v35
    v_exp_f32 v38, v38
    v_exp_f32 v39, v39
    v_cvt_pk_bf16_f32 v66, v36, v37
    v_mfma_f32_32x32x16_bf16 v[208:223], v[136:139], v[72:75], v[208:223]
    v_exp_f32 v40, v40
    v_exp_f32 v41, v41
    v_cvt_pk_bf16_f32 v67, v38, v39
    v_exp_f32 v42, v42
    v_exp_f32 v43, v43
    v_cvt_pk_bf16_f32 v68, v40, v41
    v_mfma_f32_32x32x16_bf16 v[208:223], v[140:143], v[76:79], v[208:223]
    v_exp_f32 v44, v44
    v_exp_f32 v45, v45
    v_cvt_pk_bf16_f32 v69, v42, v43
    v_exp_f32 v46, v46
    v_exp_f32 v47, v47
    v_cvt_pk_bf16_f32 v70, v44, v45
    v_cvt_pk_bf16_f32 v71, v46, v47
    s_waitcnt vmcnt(0)
    v_mfma_f32_32x32x16_bf16 v[32:47], v[80:83], v[144:147], 0
    v_exp_f32 v48, v48
    v_exp_f32 v49, v49
    v_exp_f32 v50, v50
    v_exp_f32 v51, v51
    v_cvt_pk_bf16_f32 v72, v48, v49
    v_mfma_f32_32x32x16_bf16 v[32:47], v[84:87], v[148:151], v[32:47]
    v_exp_f32 v52, v52
    v_exp_f32 v53, v53
    v_cvt_pk_bf16_f32 v73, v50, v51
    v_exp_f32 v54, v54
    v_exp_f32 v55, v55
    v_cvt_pk_bf16_f32 v74, v52, v53
    v_mfma_f32_32x32x16_bf16 v[224:239], v[136:139], v[64:67], v[224:239]
    v_exp_f32 v56, v56
    v_exp_f32 v57, v57
    v_cvt_pk_bf16_f32 v75, v54, v55
    v_exp_f32 v58, v58
    v_exp_f32 v59, v59
    v_cvt_pk_bf16_f32 v76, v56, v57
    v_mfma_f32_32x32x16_bf16 v[224:239], v[140:143], v[68:71], v[224:239]
    v_exp_f32 v60, v60
    v_exp_f32 v61, v61
    v_cvt_pk_bf16_f32 v77, v58, v59
    v_exp_f32 v62, v62
    v_exp_f32 v63, v63
    v_cvt_pk_bf16_f32 v78, v60, v61
    v_cvt_pk_bf16_f32 v79, v62, v63
    v_mfma_f32_32x32x16_bf16 v[48:63], v[80:83], v[152:155], 0
    ds_add_u32 v25, v27
    v_exp_f32 v32, v32
    v_exp_f32 v33, v33
    v_exp_f32 v34, v34
    v_exp_f32 v35, v35
    v_cvt_pk_bf16_f32 v64, v32, v33
    v_mfma_f32_32x32x16_bf16 v[48:63], v[84:87], v[156:159], v[48:63]
    v_exp_f32 v36, v36
    v_exp_f32 v37, v37
    v_cvt_pk_bf16_f32 v65, v34, v35
    v_exp_f32 v38, v38
    v_exp_f32 v39, v39
    v_cvt_pk_bf16_f32 v66, v36, v37
    v_mfma_f32_32x32x16_bf16 v[240:255], v[136:139], v[72:75], v[240:255]
    v_exp_f32 v40, v40
    v_exp_f32 v41, v41
    v_cvt_pk_bf16_f32 v67, v38, v39
    v_exp_f32 v42, v42
    v_exp_f32 v43, v43
    v_cvt_pk_bf16_f32 v68, v40, v41
    v_mfma_f32_32x32x16_bf16 v[240:255], v[140:143], v[76:79], v[240:255]
    v_exp_f32 v44, v44
    v_exp_f32 v45, v45
    v_cvt_pk_bf16_f32 v69, v42, v43
    v_exp_f32 v46, v46
    v_exp_f32 v47, v47
    v_cvt_pk_bf16_f32 v70, v44, v45
    v_cvt_pk_bf16_f32 v71, v46, v47
    v_mfma_f32_32x32x16_bf16 v[32:47], v[80:83], v[160:163], 0
    v_exp_f32 v48, v48
    v_exp_f32 v49, v49
    v_exp_f32 v50, v50
    v_exp_f32 v51, v51
    v_cvt_pk_bf16_f32 v72, v48, v49
    v_mfma_f32_32x32x16_bf16 v[32:47], v[84:87], v[164:167], v[32:47]
    v_exp_f32 v52, v52
    v_exp_f32 v53, v53
    v_cvt_pk_bf16_f32 v73, v50, v51
    v_exp_f32 v54, v54
    v_exp_f32 v55, v55
    v_cvt_pk_bf16_f32 v74, v52, v53
    v_mfma_f32_32x32x16_bf16 v[192:207], v[88:91], v[64:67], v[192:207]
    v_exp_f32 v56, v56
    v_exp_f32 v57, v57
    v_cvt_pk_bf16_f32 v75, v54, v55
    v_exp_f32 v58, v58
    v_exp_f32 v59, v59
    v_cvt_pk_bf16_f32 v76, v56, v57
    v_mfma_f32_32x32x16_bf16 v[192:207], v[92:95], v[68:71], v[192:207]
    v_exp_f32 v60, v60
    v_exp_f32 v61, v61
    v_cvt_pk_bf16_f32 v77, v58, v59
    v_exp_f32 v62, v62
    v_exp_f32 v63, v63
    v_cvt_pk_bf16_f32 v78, v60, v61
    v_cvt_pk_bf16_f32 v79, v62, v63
    v_mfma_f32_32x32x16_bf16 v[48:63], v[80:83], v[168:171], 0
    v_exp_f32 v32, v32
    v_exp_f32 v33, v33
    v_exp_f32 v34, v34
    v_exp_f32 v35, v35
    v_cvt_pk_bf16_f32 v64, v32, v33
    ds_write_b128 v16, v[192:195] offset:0
    v_mfma_f32_32x32x16_bf16 v[48:63], v[84:87], v[172:175], v[48:63]
    v_exp_f32 v36, v36
    v_exp_f32 v37, v37
    v_cvt_pk_bf16_f32 v65, v34, v35
    v_exp_f32 v38, v38
    v_exp_f32 v39, v39
    v_cvt_pk_bf16_f32 v66, v36, v37
    ds_write_b128 v16, v[196:199] offset:1024
    v_mfma_f32_32x32x16_bf16 v[208:223], v[88:91], v[72:75], v[208:223]
    v_exp_f32 v40, v40
    v_exp_f32 v41, v41
    v_cvt_pk_bf16_f32 v67, v38, v39
    v_exp_f32 v42, v42
    v_exp_f32 v43, v43
    v_cvt_pk_bf16_f32 v68, v40, v41
    ds_write_b128 v16, v[200:203] offset:2048
    v_mfma_f32_32x32x16_bf16 v[208:223], v[92:95], v[76:79], v[208:223]
    v_exp_f32 v44, v44
    v_exp_f32 v45, v45
    v_cvt_pk_bf16_f32 v69, v42, v43
    v_exp_f32 v46, v46
    v_exp_f32 v47, v47
    v_cvt_pk_bf16_f32 v70, v44, v45
    ds_write_b128 v16, v[204:207] offset:3072
    v_cvt_pk_bf16_f32 v71, v46, v47
    v_exp_f32 v48, v48
    v_exp_f32 v49, v49
    v_exp_f32 v50, v50
    v_exp_f32 v51, v51
    v_cvt_pk_bf16_f32 v72, v48, v49
    ds_write_b128 v17, v[208:211] offset:0
    v_exp_f32 v52, v52
    v_exp_f32 v53, v53
    v_cvt_pk_bf16_f32 v73, v50, v51
    v_exp_f32 v54, v54
    v_exp_f32 v55, v55
    v_cvt_pk_bf16_f32 v74, v52, v53
    ds_write_b128 v17, v[212:215] offset:1024
    v_mfma_f32_32x32x16_bf16 v[224:239], v[88:91], v[64:67], v[224:239]
    v_exp_f32 v56, v56
    v_exp_f32 v57, v57
    v_cvt_pk_bf16_f32 v75, v54, v55
    v_exp_f32 v58, v58
    v_exp_f32 v59, v59
    v_cvt_pk_bf16_f32 v76, v56, v57
    ds_write_b128 v17, v[216:219] offset:2048
    v_mfma_f32_32x32x16_bf16 v[224:239], v[92:95], v[68:71], v[224:239]
    v_exp_f32 v60, v60
    v_exp_f32 v61, v61
    v_cvt_pk_bf16_f32 v77, v58, v59
    v_exp_f32 v62, v62
    v_exp_f32 v63, v63
    v_cvt_pk_bf16_f32 v78, v60, v61
    ds_write_b128 v17, v[220:223] offset:3072
    v_cvt_pk_bf16_f32 v79, v62, v63
    s_nop 0
    v_mfma_f32_32x32x16_bf16 v[240:255], v[88:91], v[72:75], v[240:255]
    v_mfma_f32_32x32x16_bf16 v[240:255], v[92:95], v[76:79], v[240:255]
    s_nop 3
    ds_write_b128 v18, v[224:227] offset:0
    ds_write_b128 v18, v[228:231] offset:1024
    ds_write_b128 v18, v[232:235] offset:2048
    ds_write_b128 v18, v[236:239] offset:3072
    s_waitcnt lgkmcnt(0)
    s_mov_b64 exec, 1
    ds_add_u32 v28, v27
    s_mov_b64 exec, -1
    s_add_u32 s43, s43, 4
A_BAR1:
    ds_read_b32 v29, v28
    s_waitcnt lgkmcnt(0)
    v_readfirstlane_b32 s4, v29
    s_nop 0
    s_and_b32 s5, s4, 0xffff
    s_cmp_lt_u32 s5, s43
    s_cbranch_scc1 A_BAR1
    ds_read_b128 v[32:35], v19 offset:0
    ds_read_b128 v[36:39], v19 offset:1024
    ds_read_b128 v[40:43], v19 offset:2048
    ds_read_b128 v[44:47], v19 offset:3072
    ds_read_b128 v[48:51], v20 offset:0
    ds_read_b128 v[52:55], v20 offset:1024
    ds_read_b128 v[56:59], v20 offset:2048
    ds_read_b128 v[60:63], v20 offset:3072
    ds_read_b128 v[64:67], v21 offset:0
    ds_read_b128 v[68:71], v21 offset:1024
    ds_read_b128 v[72:75], v21 offset:2048
    ds_read_b128 v[76:79], v21 offset:3072
    s_waitcnt lgkmcnt(8)
    v_pk_add_f32 v[240:241], v[240:241], v[32:33]
    v_pk_add_f32 v[242:243], v[242:243], v[34:35]
    v_pk_add_f32 v[244:245], v[244:245], v[36:37]
    v_pk_add_f32 v[246:247], v[246:247], v[38:39]
    v_pk_add_f32 v[248:249], v[248:249], v[40:41]
    v_pk_add_f32 v[250:251], v[250:251], v[42:43]
    v_pk_add_f32 v[252:253], v[252:253], v[44:45]
    v_pk_add_f32 v[254:255], v[254:255], v[46:47]
    s_waitcnt lgkmcnt(0)
    v_pk_add_f32 v[48:49], v[48:49], v[64:65]
    v_pk_add_f32 v[50:51], v[50:51], v[66:67]
    v_pk_add_f32 v[52:53], v[52:53], v[68:69]
    v_pk_add_f32 v[54:55], v[54:55], v[70:71]
    v_pk_add_f32 v[56:57], v[56:57], v[72:73]
    v_pk_add_f32 v[58:59], v[58:59], v[74:75]
    v_pk_add_f32 v[60:61], v[60:61], v[76:77]
    v_pk_add_f32 v[62:63], v[62:63], v[78:79]
    v_pk_add_f32 v[252:253], v[252:253], v[60:61]
    v_pk_add_f32 v[240:241], v[240:241], v[48:49]
    v_pk_add_f32 v[242:243], v[242:243], v[50:51]
    v_pk_add_f32 v[244:245], v[244:245], v[52:53]
    v_pk_add_f32 v[246:247], v[246:247], v[54:55]
    v_pk_add_f32 v[248:249], v[248:249], v[56:57]
    v_pk_add_f32 v[250:251], v[250:251], v[58:59]
    v_pk_add_f32 v[254:255], v[254:255], v[62:63]
    v_mov_b32 v11, v252
    v_mov_b32 v12, v252
    v_pk_add_f32 v[32:33], v[240:241], v[248:249]
    v_pk_add_f32 v[34:35], v[242:243], v[250:251]
    v_pk_add_f32 v[36:37], v[244:245], v[252:253]
    v_pk_add_f32 v[38:39], v[246:247], v[254:255]
    v_permlane32_swap_b32 v11, v12
    v_pk_add_f32 v[32:33], v[32:33], v[36:37]
    v_rcp_f32 v14, v12
    v_pk_add_f32 v[34:35], v[34:35], v[38:39]
    v_mul_f32 v14, v14, v26
    v_pk_add_f32 v[32:33], v[32:33], v[34:35]
    v_mov_b32 v15, v14
    s_mov_b32 s4, 0x71800000
    v_add_f32 v13, v32, v33
    v_cmp_nlt_f32 s[44:45], v12, s4
    v_cmp_ngt_f32 s[6:7], v12, 0.5
    s_movk_i32 s4, 0x207
    v_cmp_class_f32 vcc, v13, s4
    v_pk_mul_f32 v[240:241], v[240:241], v[14:15]
    v_pk_mul_f32 v[242:243], v[242:243], v[14:15]
    v_pk_mul_f32 v[244:245], v[244:245], v[14:15]
    v_pk_mul_f32 v[246:247], v[246:247], v[14:15]
    v_pk_mul_f32 v[248:249], v[248:249], v[14:15]
    v_pk_mul_f32 v[250:251], v[250:251], v[14:15]
    v_pk_mul_f32 v[252:253], v[252:253], v[14:15]
    v_pk_mul_f32 v[254:255], v[254:255], v[14:15]
    s_or_b64 s[44:45], s[44:45], vcc
    s_or_b64 s[44:45], s[44:45], s[6:7]
    s_cmp_lg_u64 s[44:45], 0
    s_cselect_b32 s53, 0x10001, 1
    v_cvt_pk_bf16_f32 v48, v240, v241
    v_cvt_pk_bf16_f32 v49, v242, v243
    v_cvt_pk_bf16_f32 v50, v244, v245
    v_cvt_pk_bf16_f32 v51, v246, v247
    v_mov_b32 v15, s53
    s_cmp_lg_u32 s42, 0
    s_cselect_b32 s53, 1, s53
    s_add_u32 s53, s53, s93
    s_cmp_lg_u32 s53, 1
    s_cselect_b32 s4, 2147479552, s96
    buffer_store_dwordx4 v[48:51], v2, s[24:27], s4 offen sc1
    v_cvt_pk_bf16_f32 v52, v248, v249
    v_cvt_pk_bf16_f32 v53, v250, v251
    v_cvt_pk_bf16_f32 v54, v252, v253
    v_cvt_pk_bf16_f32 v55, v254, v255
    v_cndmask_b32 v54, v54, 0, s[50:51]
    v_cndmask_b32 v55, v55, 0, s[50:51]
    buffer_store_dwordx4 v[52:55], v2, s[24:27], s4 offen offset:1024 sc1
    s_cmp_lg_u32 s53, 1
    s_cbranch_scc1 A_NOPUB
    s_waitcnt vmcnt(0)
    s_mov_b32 exec_hi, 0
    buffer_store_dword v30, v24, s[24:27], s97 offen sc1
    s_mov_b64 exec, -1
    s_mov_b32 s93, 1
A_NOPUB:
    s_waitcnt lgkmcnt(0)
    s_mov_b64 exec, 1
    ds_add_u32 v28, v15
    s_mov_b64 exec, -1
    s_add_u32 s43, s43, 4
A_BAR2:
    ds_read_b32 v29, v28
    s_waitcnt lgkmcnt(0)
    v_readfirstlane_b32 s4, v29
    s_nop 0
    s_and_b32 s5, s4, 0xffff
    s_cmp_lt_u32 s5, s43
    s_cbranch_scc1 A_BAR2
    s_lshr_b32 s4, s4, 16
    s_cmp_gt_u32 s4, s42
    s_cbranch_scc1 A_FALLBACK
    s_endpgm
A_FALLBACK:
    s_mov_b32 s42, 0xffff
    s_mov_b32 s54, 2147479552
    s_mov_b32 s55, 2147479552
    s_mov_b32 s40, 2147479552
    s_mov_b32 s41, 2147479552
    s_mov_b32 s98, 2147479552
    s_mov_b32 s100, 2147479552
    v_cndmask_b32 v150, v150, 0, s[50:51]
    v_cndmask_b32 v151, v151, 0, s[50:51]
    v_mov_b32 v4, 0xff800000
    v_cndmask_b32 v158, v158, 0, s[50:51]
    v_cndmask_b32 v159, v159, 0, s[50:51]
    v_mov_b32 v5, 0xff800000
    v_cndmask_b32 v166, v166, 0, s[50:51]
    v_cndmask_b32 v167, v167, 0, s[50:51]
    v_mov_b32 v6, 0xff800000
    v_cndmask_b32 v174, v174, 0, s[50:51]
    v_cndmask_b32 v175, v175, 0, s[50:51]
    v_mov_b32 v7, 0xff800000
    s_mov_b32 s47, s99
    s_mov_b32 s48, 0
A_FB_LOOP:
    buffer_load_dwordx4 v[32:35], v2, s[24:27], s47 offen offset:0 sc1
    buffer_load_dwordx4 v[36:39], v2, s[24:27], s47 offen offset:1024 sc1
    s_waitcnt vmcnt(0)
    v_mfma_f32_32x32x16_bf16 v[192:207], v[32:35], v[144:147], 0
    v_mfma_f32_32x32x16_bf16 v[192:207], v[36:39], v[148:151], v[192:207]
    v_mfma_f32_32x32x16_bf16 v[208:223], v[32:35], v[152:155], 0
    v_mfma_f32_32x32x16_bf16 v[208:223], v[36:39], v[156:159], v[208:223]
    v_mfma_f32_32x32x16_bf16 v[224:239], v[32:35], v[160:163], 0
    v_mfma_f32_32x32x16_bf16 v[224:239], v[36:39], v[164:167], v[224:239]
    v_mfma_f32_32x32x16_bf16 v[240:255], v[32:35], v[168:171], 0
    v_mfma_f32_32x32x16_bf16 v[240:255], v[36:39], v[172:175], v[240:255]
    s_nop 11
    v_max3_f32 v4, v4, v192, v193
    v_max3_f32 v4, v4, v194, v195
    v_max3_f32 v4, v4, v196, v197
    v_max3_f32 v4, v4, v198, v199
    v_max3_f32 v4, v4, v200, v201
    v_max3_f32 v4, v4, v202, v203
    v_max3_f32 v4, v4, v204, v205
    v_max3_f32 v4, v4, v206, v207
    v_max3_f32 v5, v5, v208, v209
    v_max3_f32 v5, v5, v210, v211
    v_max3_f32 v5, v5, v212, v213
    v_max3_f32 v5, v5, v214, v215
    v_max3_f32 v5, v5, v216, v217
    v_max3_f32 v5, v5, v218, v219
    v_max3_f32 v5, v5, v220, v221
    v_max3_f32 v5, v5, v222, v223
    v_max3_f32 v6, v6, v224, v225
    v_max3_f32 v6, v6, v226, v227
    v_max3_f32 v6, v6, v228, v229
    v_max3_f32 v6, v6, v230, v231
    v_max3_f32 v6, v6, v232, v233
    v_max3_f32 v6, v6, v234, v235
    v_max3_f32 v6, v6, v236, v237
    v_max3_f32 v6, v6, v238, v239
    v_max3_f32 v7, v7, v240, v241
    v_max3_f32 v7, v7, v242, v243
    v_max3_f32 v7, v7, v244, v245
    v_max3_f32 v7, v7, v246, v247
    v_max3_f32 v7, v7, v248, v249
    v_max3_f32 v7, v7, v250, v251
    v_max3_f32 v7, v7, v252, v253
    v_max3_f32 v7, v7, v254, v255
    s_add_u32 s47, s47, 4096
    s_add_u32 s48, s48, 1
    s_cmp_lt_u32 s48, 16
    s_cbranch_scc1 A_FB_LOOP
    v_mov_b32 v12, v4
    v_mov_b32 v13, v5
    v_mov_b32 v14, v6
    v_mov_b32 v15, v7
    s_nop 1
    v_permlane32_swap_b32 v4, v12
    v_permlane32_swap_b32 v5, v13
    v_permlane32_swap_b32 v6, v14
    v_permlane32_swap_b32 v7, v15
    v_max_f32 v4, v4, v12
    v_max_f32 v5, v5, v13
    v_max_f32 v6, v6, v14
    v_max_f32 v7, v7, v15
    s_lshl_b32 s5, s3, 8
    s_add_u32 s4, s3, 1
    s_and_b32 s4, s4, 3
    s_lshl_b32 s4, s4, 10
    v_add_u32 v8, s4, v24
    v_add_u32 v12, s5, v8
    ds_write_b32 v12, v4 offset:20480
    s_add_u32 s4, s3, 2
    s_and_b32 s4, s4, 3
    s_lshl_b32 s4, s4, 10
    v_add_u32 v9, s4, v24
    v_add_u32 v12, s5, v9
    ds_write_b32 v12, v5 offset:20480
    s_add_u32 s4, s3, 3
    s_and_b32 s4, s4, 3
    s_lshl_b32 s4, s4, 10
    v_add_u32 v10, s4, v24
    v_add_u32 v12, s5, v10
    ds_write_b32 v12, v6 offset:20480
    s_add_u32 s4, s3, 4
    s_and_b32 s4, s4, 3
    s_lshl_b32 s4, s4, 10
    v_add_u32 v11, s4, v24
    v_add_u32 v12, s5, v11
    ds_write_b32 v12, v7 offset:20480
    s_waitcnt lgkmcnt(0)
    s_mov_b64 exec, 1
    ds_add_u32 v28, v27
    s_mov_b64 exec, -1
    s_add_u32 s43, s43, 4
A_BAR3:
    ds_read_b32 v29, v28
    s_waitcnt lgkmcnt(0)
    v_readfirstlane_b32 s4, v29
    s_nop 0
    s_and_b32 s5, s4, 0xffff
    s_cmp_lt_u32 s5, s43
    s_cbranch_scc1 A_BAR3
    ds_read_b32 v192, v8 offset:20480
    ds_read_b32 v196, v8 offset:20736
    ds_read_b32 v200, v8 offset:20992
    ds_read_b32 v204, v8 offset:21248
    ds_read_b32 v193, v9 offset:20480
    ds_read_b32 v197, v9 offset:20736
    ds_read_b32 v201, v9 offset:20992
    ds_read_b32 v205, v9 offset:21248
    ds_read_b32 v194, v10 offset:20480
    ds_read_b32 v198, v10 offset:20736
    ds_read_b32 v202, v10 offset:20992
    ds_read_b32 v206, v10 offset:21248
    ds_read_b32 v195, v11 offset:20480
    ds_read_b32 v199, v11 offset:20736
    ds_read_b32 v203, v11 offset:20992
    ds_read_b32 v207, v11 offset:21248
    v_mov_b32 v72, 0
    v_mov_b32 v73, 0
    v_mov_b32 v74, 0
    v_mov_b32 v75, 0
    v_mov_b32 v76, 0
    v_mov_b32 v77, 0
    v_mov_b32 v78, 0
    v_mov_b32 v79, 0
    buffer_load_dwordx4 v[96:99], v2, s[24:27], s8 offen offset:0 sc1
    buffer_load_dwordx4 v[100:103], v2, s[24:27], s8 offen offset:1024 sc1
    buffer_load_dwordx4 v[104:107], v2, s[24:27], s8 offen offset:2048 sc1
    buffer_load_dwordx4 v[108:111], v2, s[24:27], s8 offen offset:3072 sc1
    s_waitcnt vmcnt(0) lgkmcnt(0)
    v_max3_f32 v4, v192, v196, v200
    v_max_f32 v4, v4, v204
    v_max3_f32 v5, v193, v197, v201
    v_max_f32 v5, v5, v205
    v_max3_f32 v6, v194, v198, v202
    v_max_f32 v6, v6, v206
    v_max3_f32 v7, v195, v199, v203
    v_max_f32 v7, v7, v207
    v_sub_f32 v4, 0, v4
    v_sub_f32 v5, 0, v5
    v_sub_f32 v6, 0, v6
    v_sub_f32 v7, 0, v7
    v_cvt_pk_bf16_f32 v12, v4, v4
    v_cvt_pk_bf16_f32 v15, v5, v5
    v_cvt_pk_bf16_f32 v18, v6, v6
    v_cvt_pk_bf16_f32 v21, v7, v7
    v_lshlrev_b32 v12, 16, v12
    v_lshlrev_b32 v15, 16, v15
    v_lshlrev_b32 v18, 16, v18
    v_lshlrev_b32 v21, 16, v21
    v_sub_f32 v12, v4, v12
    v_sub_f32 v15, v5, v15
    v_sub_f32 v18, v6, v18
    v_sub_f32 v21, v7, v21
    v_cvt_pk_bf16_f32 v13, v4, v12
    v_cvt_pk_bf16_f32 v16, v5, v15
    v_cvt_pk_bf16_f32 v19, v6, v18
    v_cvt_pk_bf16_f32 v22, v7, v21
    v_and_b32 v14, 0xffff0000, v13
    v_and_b32 v17, 0xffff0000, v16
    v_and_b32 v20, 0xffff0000, v19
    v_and_b32 v23, 0xffff0000, v22
    v_sub_f32 v14, v12, v14
    v_sub_f32 v17, v15, v17
    v_sub_f32 v20, v18, v20
    v_sub_f32 v23, v21, v23
    v_cvt_pk_bf16_f32 v14, v14, 0
    v_cvt_pk_bf16_f32 v17, v17, 0
    v_cvt_pk_bf16_f32 v20, v20, 0
    v_cvt_pk_bf16_f32 v23, v23, 0
    v_cndmask_b32 v150, v150, v13, s[50:51]
    v_cndmask_b32 v151, v151, v14, s[50:51]
    v_cndmask_b32 v158, v158, v16, s[50:51]
    v_cndmask_b32 v159, v159, v17, s[50:51]
    v_cndmask_b32 v166, v166, v19, s[50:51]
    v_cndmask_b32 v167, v167, v20, s[50:51]
    v_cndmask_b32 v174, v174, v22, s[50:51]
    v_cndmask_b32 v175, v175, v23, s[50:51]
    s_nop 1
    s_branch A_RUN
K_END:
    s_endpgm
.section .rodata,"a"
.p2align 6
.amdhsa_kernel gated_mix__mha_block__glu_gated_reglu__prompt_kernel
  .amdhsa_next_free_vgpr 256
  .amdhsa_next_free_sgpr 102
  .amdhsa_accum_offset 256
  .amdhsa_group_segment_fixed_size 0
  .amdhsa_kernarg_size 88
  .amdhsa_user_sgpr_count 2
  .amdhsa_user_sgpr_kernarg_segment_ptr 1
  .amdhsa_system_sgpr_workgroup_id_x 1
.end_amdhsa_kernel
```
